```python
import torch

def _softmax(x, axis=-1):
    return torch.softmax(x, dim=axis)

def _gelu(x):
    return torch.nn.functional.gelu(x, approximate='tanh')

def _silu(x):
    return torch.nn.functional.silu(x)

def _sigmoid(x):
    return torch.sigmoid(x)

def _layernorm(x, axis=-1, eps=1e-05):
    m = x.mean(dim=axis, keepdim=True)
    v = x.var(dim=axis, keepdim=True, unbiased=False)
    return (x - m) / torch.sqrt(v + eps)

def _scatter_add(tgt, idx, src, axis=0):
    return tgt.clone().index_add_(axis, idx, src)

def _segment_sum(src, seg, n):
    out = torch.zeros((n,) + src.shape[1:], dtype=src.dtype)
    return out.index_add_(0, seg, src)

def _pad(x, pw):
    flat = tuple((v for pair in reversed(pw) for v in pair))
    return torch.nn.functional.pad(x, flat)
kernel_name = 'adaLN_cond__linear_kernel_hedgehog__glu_gated_bilinear__prompt'

def setup_inputs():

    _w = lambda a: (lambda t: t.to(torch.bfloat16) if t.is_floating_point() else t)(torch.as_tensor(a))

    def _A_setup():
        B, S, D, H = (1, 2048, 448, 16)
        Dh = D // H
        return {'x': _w((lambda *s: torch.randn(*s, dtype=torch.bfloat16) * 0.05)(B, S, D)), 'wqkv': _w((lambda *s: torch.randn(*s, dtype=torch.bfloat16) * 0.4)(D, 3 * D)), 'w_phi': _w((lambda *s: torch.randn(*s, dtype=torch.bfloat16) * 0.4)(H, Dh, Dh) * Dh ** (-0.5)), 'wo': _w((lambda *s: torch.randn(*s, dtype=torch.bfloat16) * 0.05)(D, D))}
    _A_in = _A_setup()

    def _B_setup():
        B, S, D, F = (1, 2048, 448, 1792)
        return {'x': _w((lambda *s: torch.randn(*s, dtype=torch.bfloat16) * 0.05)(B, S, D)), 'w_gate': _w((lambda *s: torch.randn(*s, dtype=torch.bfloat16) * 1.6)(D, F) * D ** (-0.5)), 'w_up': _w((lambda *s: torch.randn(*s, dtype=torch.bfloat16) * 1.6)(D, F) * D ** (-0.5)), 'w_down': _w((lambda *s: torch.randn(*s, dtype=torch.bfloat16) * 1.6)(F, D) * F ** (-0.5))}
    _B_in = _B_setup()
    return {'A_x': _A_in['x'], 'A_wqkv': _A_in['wqkv'], 'A_w_phi': _A_in['w_phi'], 'A_wo': _A_in['wo'], 'B_x': _B_in['x'], 'B_w_gate': _B_in['w_gate'], 'B_w_up': _B_in['w_up'], 'B_w_down': _B_in['w_down'], 'c': _w((lambda *s: torch.randn(*s, dtype=torch.bfloat16) * 0.1)(1, 448) * 8.0), 'w_mod': _w((lambda *s: torch.randn(*s, dtype=torch.bfloat16) * 0.1)(448, 6 * 448) * 448 ** (-0.5) * 8.0)}

def reference(A_x, A_wqkv, A_w_phi, A_wo, B_x, B_w_gate, B_w_up, B_w_down, c, w_mod):

    def _A_ref(x, wqkv, w_phi, wo):
        B, S, D = x.shape
        H = 16
        Dh = D // H
        qkv = (lambda x, *d: x.permute(*d))((x @ wqkv).reshape(B, S, 3, H, Dh), 2, 0, 3, 1, 4)
        q, k, v = (qkv[0], qkv[1], qkv[2])
        pq = torch.einsum('bhsd,hdf->bhsf', q, w_phi)
        pk = torch.einsum('bhsd,hdf->bhsf', k, w_phi)
        phi_q = torch.concatenate([_softmax(pq, axis=-1), _softmax(-pq, axis=-1)], axis=-1)
        phi_k = torch.concatenate([_softmax(pk, axis=-1), _softmax(-pk, axis=-1)], axis=-1)
        kv = torch.einsum('bhsf,bhsd->bhfd', phi_k, v)
        z = torch.einsum('bhsf->bhf', phi_k)
        num = torch.einsum('bhqf,bhfd->bhqd', phi_q, kv)
        den = torch.einsum('bhqf,bhf->bhq', phi_q, z)[..., None] + 1e-06
        o = num / den
        return (lambda x, *d: x.permute(*d))(o, 0, 2, 1, 3).reshape(B, S, D) @ wo

    def _B_ref(x, w_gate, w_up, w_down):
        g = torch.einsum('bsd,df->bsf', x, w_gate)
        u = torch.einsum('bsd,df->bsf', x, w_up)
        h = g * u
        return torch.einsum('bsf,fd->bsd', h, w_down)
    x = A_x
    mod = (_silu(c) @ w_mod).reshape(c.shape[0], 6, 1, -1)
    sa, ca, ga, sb, cb, gb = (mod[:, 0].clone(), mod[:, 1].clone(), mod[:, 2].clone(), mod[:, 3].clone(), mod[:, 4].clone(), mod[:, 5].clone())
    h = _layernorm(x, axis=-1) * (1 + ca) + sa
    x = x + ga * _A_ref(h, A_wqkv, A_w_phi, A_wo)
    h = _layernorm(x, axis=-1) * (1 + cb) + sb
    x = x + gb * _B_ref(h, B_w_gate, B_w_up, B_w_down)
    return x
```

```asm
; @launch grid=(256,1,1) block=(256,1,1) lds=163840
.amdgcn_target "amdgcn-amd-amdhsa--gfx950"
.text
.p2align 8
.globl adaLN_cond__linear_kernel_hedgehog__glu_gated_bilinear__prompt_kernel
.type adaLN_cond__linear_kernel_hedgehog__glu_gated_bilinear__prompt_kernel,@function
adaLN_cond__linear_kernel_hedgehog__glu_gated_bilinear__prompt_kernel:
    s_cmp_ge_u32 s2, 256
    s_cbranch_scc1 adaLN_cond__linear_kernel_hedgehog__glu_gated_bilinear__prompt_kernel_path_1
    s_load_dwordx2 s[4:5], s[0:1], 96
    s_load_dwordx8 s[48:55], s[0:1], 0
    s_load_dwordx8 s[56:63], s[0:1], 32
    s_load_dwordx8 s[64:71], s[0:1], 64
    v_lshrrev_b32 v1, 6, v0
    s_nop 0
    v_readfirstlane_b32 s3, v1
    v_and_b32 v1, 63, v0
    v_lshlrev_b32 v1, 4, v1
    v_and_b32 v2, 31, v0
    v_bfe_u32 v3, v0, 5, 1
    s_and_b32 s32, s2, 7
    s_lshr_b32 s33, s2, 3
    s_getpc_b64 s[20:21]
L_pc_here:
    s_and_b32 s21, s21, 0xffff
    s_mov_b32 s22, L_code_end-L_pc_here
    s_mov_b32 s23, 0x20000
    s_lshl_b32 s34, s33, 2
    s_add_u32 s34, s34, s3
    s_lshl_b32 s34, s34, 10
    s_cmp_lt_u32 s34, s22
    s_cbranch_scc0 adaLN_cond__linear_kernel_hedgehog__glu_gated_bilinear__prompt_kernel_skip_2
    buffer_load_dwordx4 a[252:255], v1, s[20:23], s34 offen
adaLN_cond__linear_kernel_hedgehog__glu_gated_bilinear__prompt_kernel_skip_2:
    s_lshr_b32 s29, s32, 1
    s_lshl_b32 s29, s29, 2
    s_lshr_b32 s34, s33, 3
    s_add_u32 s29, s29, s34
    s_and_b32 s30, s32, 1
    s_lshl_b32 s30, s30, 3
    s_and_b32 s34, s33, 7
    s_add_u32 s30, s30, s34
    s_lshl_b32 s31, s29, 2
    s_add_u32 s31, s31, s3
    s_waitcnt lgkmcnt(0)
    s_load_dword s6, s[4:5], 0x0
    s_mov_b32 s8, s4
    s_and_b32 s9, s5, 0xffff
    s_mov_b32 s10, 0x10000000
    s_mov_b32 s11, 0x20000
    s_mov_b32 s12, s48
    s_and_b32 s13, s49, 0xffff
    s_mov_b32 s14, 0x1c0000
    s_mov_b32 s15, 0x20000
    s_mov_b32 s16, s50
    s_and_b32 s17, s51, 0xffff
    s_mov_b32 s18, 0x126000
    s_mov_b32 s19, 0x20000
    s_mov_b32 s20, s54
    s_and_b32 s21, s55, 0xffff
    s_mov_b32 s22, 0x0
    s_mov_b32 s23, 0x20000
    s_mov_b32 s24, s54
    s_and_b32 s25, s55, 0xffff
    s_mov_b32 s26, 0x0
    s_mov_b32 s27, 0x20000
    s_cmp_lt_u32 s2, 28
    s_cbranch_scc0 adaLN_cond__linear_kernel_hedgehog__glu_gated_bilinear__prompt_kernel_skip_3
    s_mov_b32 s20, s66
    s_and_b32 s21, s67, 0xffff
    s_mov_b32 s22, 0x24c000
    s_mov_b32 s23, 0x20000
    s_mov_b32 s24, s64
    s_and_b32 s25, s65, 0xffff
    s_mov_b32 s26, 0x380
    s_mov_b32 s27, 0x20000
    v_lshrrev_b32 v5, 3, v0
    v_and_b32 v6, 7, v0
    v_mul_u32_u24 v4, 5376, v5
    v_lshl_add_u32 v4, v6, 4, v4
    v_lshlrev_b32 v5, 1, v5
    s_and_b32 s35, s2, 1
    s_mul_i32 s34, s35, 1204224
    s_lshl_b32 s36, s2, 6
    s_and_b32 s36, s36, 0xff80
    s_add_u32 s34, s34, s36
    s_mul_i32 s35, s35, 448
    buffer_load_dwordx4 v[16:19], v4, s[20:23], s34 offen
    s_add_u32 s34, s34, 172032
    buffer_load_dwordx4 v[20:23], v4, s[20:23], s34 offen
    s_add_u32 s34, s34, 172032
    buffer_load_dwordx4 v[24:27], v4, s[20:23], s34 offen
    s_add_u32 s34, s34, 172032
    buffer_load_dwordx4 v[28:31], v4, s[20:23], s34 offen
    s_add_u32 s34, s34, 172032
    buffer_load_dwordx4 v[32:35], v4, s[20:23], s34 offen
    s_add_u32 s34, s34, 172032
    buffer_load_dwordx4 v[36:39], v4, s[20:23], s34 offen
    s_add_u32 s34, s34, 172032
    buffer_load_dwordx4 v[40:43], v4, s[20:23], s34 offen
    buffer_load_ushort v48, v5, s[24:27], s35 offen offset:0
    buffer_load_ushort v49, v5, s[24:27], s35 offen offset:64
    buffer_load_ushort v50, v5, s[24:27], s35 offen offset:128
    buffer_load_ushort v51, v5, s[24:27], s35 offen offset:192
    buffer_load_ushort v52, v5, s[24:27], s35 offen offset:256
    buffer_load_ushort v53, v5, s[24:27], s35 offen offset:320
    buffer_load_ushort v54, v5, s[24:27], s35 offen offset:384
adaLN_cond__linear_kernel_hedgehog__glu_gated_bilinear__prompt_kernel_skip_3:
    s_lshl_b32 s33, s29, 1
    s_add_u32 s33, s33, s30
    s_mul_i32 s34, s33, 9363
    s_lshr_b32 s34, s34, 16
    s_mul_i32 s34, s34, 7
    s_sub_u32 s101, s33, s34
    v_lshrrev_b32 v8, 7, v1
    v_mul_u32_u24 v8, 896, v8
    v_lshrrev_b32 v9, 8, v1
    v_and_b32 v11, 7, v0
    v_xor_b32 v11, v9, v11
    v_lshl_add_u32 v10, v11, 4, v8
    v_xor_b32 v11, 4, v11
    v_lshl_add_u32 v11, v11, 4, v8
    s_mul_i32 s97, s31, 28672
    s_mul_i32 s39, s3, 28672
    s_lshl_b32 s96, s101, 7
    s_add_u32 s33, s97, s96
    s_add_u32 m0, s39, 0
    s_add_u32 s34, s33, 0
    buffer_load_dwordx4 v10, s[12:15], s34 offen lds
    s_add_u32 m0, s39, 7168
    s_add_u32 s34, s33, 7168
    buffer_load_dwordx4 v11, s[12:15], s34 offen lds
    s_add_u32 m0, s39, 14336
    s_add_u32 s34, s33, 14336
    buffer_load_dwordx4 v10, s[12:15], s34 offen lds
    s_add_u32 m0, s39, 21504
    s_add_u32 s34, s33, 21504
    buffer_load_dwordx4 v11, s[12:15], s34 offen lds
    s_add_u32 s96, s96, 128
    s_cmp_eq_u32 s96, 896
    s_cmov_b32 s96, 0
    s_add_u32 s33, s97, s96
    s_add_u32 m0, s39, 1024
    s_add_u32 s34, s33, 0
    buffer_load_dwordx4 v10, s[12:15], s34 offen lds
    s_add_u32 m0, s39, 8192
    s_add_u32 s34, s33, 7168
    buffer_load_dwordx4 v11, s[12:15], s34 offen lds
    s_add_u32 m0, s39, 15360
    s_add_u32 s34, s33, 14336
    buffer_load_dwordx4 v10, s[12:15], s34 offen lds
    s_add_u32 m0, s39, 22528
    s_add_u32 s34, s33, 21504
    buffer_load_dwordx4 v11, s[12:15], s34 offen lds
    s_cmp_lt_u32 s2, 28
    s_cbranch_scc0 adaLN_cond__linear_kernel_hedgehog__glu_gated_bilinear__prompt_kernel_skip_4
    s_waitcnt lgkmcnt(0)
    s_mul_i32 s28, s6, 0x9e3779b1
    s_add_u32 s28, s28, 0x7f4a7c15
    s_mul_i32 s100, s28, 0x85ebca6b
    s_xor_b32 s100, s100, 0x5bd1e995
    s_waitcnt vmcnt(14)
    v_lshlrev_b32 v48, 16, v48
    v_mul_f32 v64, 0xbfb8aa3b, v48
    s_waitcnt vmcnt(13)
    v_lshlrev_b32 v49, 16, v49
    v_mul_f32 v65, 0xbfb8aa3b, v49
    s_waitcnt vmcnt(12)
    v_lshlrev_b32 v50, 16, v50
    v_mul_f32 v66, 0xbfb8aa3b, v50
    s_waitcnt vmcnt(11)
    v_lshlrev_b32 v51, 16, v51
    v_mul_f32 v67, 0xbfb8aa3b, v51
    s_waitcnt vmcnt(10)
    v_lshlrev_b32 v52, 16, v52
    v_mul_f32 v68, 0xbfb8aa3b, v52
    s_waitcnt vmcnt(9)
    v_lshlrev_b32 v53, 16, v53
    v_mul_f32 v69, 0xbfb8aa3b, v53
    s_waitcnt vmcnt(8)
    v_lshlrev_b32 v54, 16, v54
    v_mul_f32 v70, 0xbfb8aa3b, v54
    v_exp_f32 v64, v64
    v_exp_f32 v65, v65
    v_exp_f32 v66, v66
    v_exp_f32 v67, v67
    v_exp_f32 v68, v68
    v_exp_f32 v69, v69
    v_exp_f32 v70, v70
    v_add_f32 v64, 1.0, v64
    v_add_f32 v65, 1.0, v65
    v_add_f32 v66, 1.0, v66
    v_add_f32 v67, 1.0, v67
    v_add_f32 v68, 1.0, v68
    v_add_f32 v69, 1.0, v69
    v_add_f32 v70, 1.0, v70
    v_rcp_f32 v64, v64
    v_rcp_f32 v65, v65
    v_rcp_f32 v66, v66
    v_rcp_f32 v67, v67
    v_rcp_f32 v68, v68
    v_rcp_f32 v69, v69
    v_rcp_f32 v70, v70
    v_mul_f32 v64, v64, v48
    v_mul_f32 v65, v65, v49
    v_mul_f32 v66, v66, v50
    v_mul_f32 v67, v67, v51
    v_mul_f32 v68, v68, v52
    v_mul_f32 v69, v69, v53
    v_mul_f32 v70, v70, v54
    v_cvt_pk_bf16_f32 v64, v64, v65
    v_lshlrev_b32 v48, 16, v64
    v_and_b32 v49, 0xffff0000, v64
    v_cvt_pk_bf16_f32 v66, v66, v67
    v_lshlrev_b32 v50, 16, v66
    v_and_b32 v51, 0xffff0000, v66
    v_cvt_pk_bf16_f32 v68, v68, v69
    v_lshlrev_b32 v52, 16, v68
    v_and_b32 v53, 0xffff0000, v68
    v_cvt_pk_bf16_f32 v70, v70, v71
    v_lshlrev_b32 v54, 16, v70
    v_and_b32 v55, 0xffff0000, v70
    v_lshlrev_b32 v64, 16, v16
    v_and_b32 v65, 0xffff0000, v16
    v_pk_mul_f32 v[56:57], v[64:65], v[48:49] op_sel_hi:[1,0]
    v_lshlrev_b32 v66, 16, v17
    v_and_b32 v67, 0xffff0000, v17
    v_pk_mul_f32 v[58:59], v[66:67], v[48:49] op_sel_hi:[1,0]
    v_lshlrev_b32 v68, 16, v18
    v_and_b32 v69, 0xffff0000, v18
    v_pk_mul_f32 v[60:61], v[68:69], v[48:49] op_sel_hi:[1,0]
    v_lshlrev_b32 v70, 16, v19
    v_and_b32 v71, 0xffff0000, v19
    v_pk_mul_f32 v[62:63], v[70:71], v[48:49] op_sel_hi:[1,0]
    v_lshlrev_b32 v64, 16, v20
    v_and_b32 v65, 0xffff0000, v20
    v_pk_fma_f32 v[56:57], v[64:65], v[48:49], v[56:57] op_sel:[0,1,0] op_sel_hi:[1,1,1]
    v_lshlrev_b32 v66, 16, v21
    v_and_b32 v67, 0xffff0000, v21
    v_pk_fma_f32 v[58:59], v[66:67], v[48:49], v[58:59] op_sel:[0,1,0] op_sel_hi:[1,1,1]
    v_lshlrev_b32 v68, 16, v22
    v_and_b32 v69, 0xffff0000, v22
    v_pk_fma_f32 v[60:61], v[68:69], v[48:49], v[60:61] op_sel:[0,1,0] op_sel_hi:[1,1,1]
    v_lshlrev_b32 v70, 16, v23
    v_and_b32 v71, 0xffff0000, v23
    v_pk_fma_f32 v[62:63], v[70:71], v[48:49], v[62:63] op_sel:[0,1,0] op_sel_hi:[1,1,1]
    v_lshlrev_b32 v64, 16, v24
    v_and_b32 v65, 0xffff0000, v24
    v_pk_fma_f32 v[56:57], v[64:65], v[50:51], v[56:57] op_sel_hi:[1,0,1]
    v_lshlrev_b32 v66, 16, v25
    v_and_b32 v67, 0xffff0000, v25
    v_pk_fma_f32 v[58:59], v[66:67], v[50:51], v[58:59] op_sel_hi:[1,0,1]
    v_lshlrev_b32 v68, 16, v26
    v_and_b32 v69, 0xffff0000, v26
    v_pk_fma_f32 v[60:61], v[68:69], v[50:51], v[60:61] op_sel_hi:[1,0,1]
    v_lshlrev_b32 v70, 16, v27
    v_and_b32 v71, 0xffff0000, v27
    v_pk_fma_f32 v[62:63], v[70:71], v[50:51], v[62:63] op_sel_hi:[1,0,1]
    v_lshlrev_b32 v64, 16, v28
    v_and_b32 v65, 0xffff0000, v28
    v_pk_fma_f32 v[56:57], v[64:65], v[50:51], v[56:57] op_sel:[0,1,0] op_sel_hi:[1,1,1]
    v_lshlrev_b32 v66, 16, v29
    v_and_b32 v67, 0xffff0000, v29
    v_pk_fma_f32 v[58:59], v[66:67], v[50:51], v[58:59] op_sel:[0,1,0] op_sel_hi:[1,1,1]
    v_lshlrev_b32 v68, 16, v30
    v_and_b32 v69, 0xffff0000, v30
    v_pk_fma_f32 v[60:61], v[68:69], v[50:51], v[60:61] op_sel:[0,1,0] op_sel_hi:[1,1,1]
    v_lshlrev_b32 v70, 16, v31
    v_and_b32 v71, 0xffff0000, v31
    v_pk_fma_f32 v[62:63], v[70:71], v[50:51], v[62:63] op_sel:[0,1,0] op_sel_hi:[1,1,1]
    v_lshlrev_b32 v64, 16, v32
    v_and_b32 v65, 0xffff0000, v32
    v_pk_fma_f32 v[56:57], v[64:65], v[52:53], v[56:57] op_sel_hi:[1,0,1]
    v_lshlrev_b32 v66, 16, v33
    v_and_b32 v67, 0xffff0000, v33
    v_pk_fma_f32 v[58:59], v[66:67], v[52:53], v[58:59] op_sel_hi:[1,0,1]
    v_lshlrev_b32 v68, 16, v34
    v_and_b32 v69, 0xffff0000, v34
    v_pk_fma_f32 v[60:61], v[68:69], v[52:53], v[60:61] op_sel_hi:[1,0,1]
    v_lshlrev_b32 v70, 16, v35
    v_and_b32 v71, 0xffff0000, v35
    v_pk_fma_f32 v[62:63], v[70:71], v[52:53], v[62:63] op_sel_hi:[1,0,1]
    v_lshlrev_b32 v64, 16, v36
    v_and_b32 v65, 0xffff0000, v36
    v_pk_fma_f32 v[56:57], v[64:65], v[52:53], v[56:57] op_sel:[0,1,0] op_sel_hi:[1,1,1]
    v_lshlrev_b32 v66, 16, v37
    v_and_b32 v67, 0xffff0000, v37
    v_pk_fma_f32 v[58:59], v[66:67], v[52:53], v[58:59] op_sel:[0,1,0] op_sel_hi:[1,1,1]
    v_lshlrev_b32 v68, 16, v38
    v_and_b32 v69, 0xffff0000, v38
    v_pk_fma_f32 v[60:61], v[68:69], v[52:53], v[60:61] op_sel:[0,1,0] op_sel_hi:[1,1,1]
    v_lshlrev_b32 v70, 16, v39
    v_and_b32 v71, 0xffff0000, v39
    v_pk_fma_f32 v[62:63], v[70:71], v[52:53], v[62:63] op_sel:[0,1,0] op_sel_hi:[1,1,1]
    v_lshlrev_b32 v64, 16, v40
    v_and_b32 v65, 0xffff0000, v40
    v_pk_fma_f32 v[56:57], v[64:65], v[54:55], v[56:57] op_sel_hi:[1,0,1]
    v_lshlrev_b32 v66, 16, v41
    v_and_b32 v67, 0xffff0000, v41
    v_pk_fma_f32 v[58:59], v[66:67], v[54:55], v[58:59] op_sel_hi:[1,0,1]
    v_lshlrev_b32 v68, 16, v42
    v_and_b32 v69, 0xffff0000, v42
    v_pk_fma_f32 v[60:61], v[68:69], v[54:55], v[60:61] op_sel_hi:[1,0,1]
    v_lshlrev_b32 v70, 16, v43
    v_and_b32 v71, 0xffff0000, v43
    v_pk_fma_f32 v[62:63], v[70:71], v[54:55], v[62:63] op_sel_hi:[1,0,1]
    v_lshlrev_b32 v4, 5, v0
    v_add_u32 v4, 151552, v4
    ds_write_b128 v4, v[56:59]
    ds_write_b128 v4, v[60:63] offset:16
    s_waitcnt lgkmcnt(0)
    s_barrier
    s_cmp_eq_u32 s3, 3
    s_cbranch_scc0 adaLN_cond__linear_kernel_hedgehog__glu_gated_bilinear__prompt_kernel_skip_5
    v_lshrrev_b32 v4, 2, v1
    v_add_u32 v4, 151552, v4
    ds_read_b32 v64, v4 offset:0
    ds_read_b32 v65, v4 offset:256
    ds_read_b32 v66, v4 offset:512
    ds_read_b32 v67, v4 offset:768
    ds_read_b32 v68, v4 offset:1024
    ds_read_b32 v69, v4 offset:1280
    ds_read_b32 v70, v4 offset:1536
    ds_read_b32 v71, v4 offset:1792
    ds_read_b32 v72, v4 offset:2048
    ds_read_b32 v73, v4 offset:2304
    ds_read_b32 v74, v4 offset:2560
    ds_read_b32 v75, v4 offset:2816
    ds_read_b32 v76, v4 offset:3072
    ds_read_b32 v77, v4 offset:3328
    ds_read_b32 v78, v4 offset:3584
    ds_read_b32 v79, v4 offset:3840
    ds_read_b32 v80, v4 offset:4096
    ds_read_b32 v81, v4 offset:4352
    ds_read_b32 v82, v4 offset:4608
    ds_read_b32 v83, v4 offset:4864
    ds_read_b32 v84, v4 offset:5120
    ds_read_b32 v85, v4 offset:5376
    ds_read_b32 v86, v4 offset:5632
    ds_read_b32 v87, v4 offset:5888
    ds_read_b32 v88, v4 offset:6144
    ds_read_b32 v89, v4 offset:6400
    ds_read_b32 v90, v4 offset:6656
    ds_read_b32 v91, v4 offset:6912
    ds_read_b32 v92, v4 offset:7168
    ds_read_b32 v93, v4 offset:7424
    ds_read_b32 v94, v4 offset:7680
    ds_read_b32 v95, v4 offset:7936
    s_lshr_b32 s36, s2, 1
    s_mul_i32 s35, s36, 9363
    s_lshr_b32 s35, s35, 16
    s_mul_i32 s34, s35, 7
    s_sub_u32 s34, s36, s34
    s_lshl_b32 s34, s34, 6
    s_and_b32 s36, s2, 1
    v_lshrrev_b32 v96, 4, v1
    v_add_u32 v96, s34, v96
    v_lshlrev_b32 v97, 1, v96
    s_lshl_b32 s36, s36, 13
    s_cmp_eq_u32 s35, 0
    s_cselect_b32 s34, 8, 0
    s_add_u32 s34, s34, s36
    s_add_u32 s34, s34, 0x1000
    v_lshlrev_b32 v97, 3, v97
    s_waitcnt lgkmcnt(14)
    v_pk_add_f32 v[64:65], v[64:65], v[80:81]
    s_waitcnt lgkmcnt(12)
    v_pk_add_f32 v[66:67], v[66:67], v[82:83]
    s_waitcnt lgkmcnt(10)
    v_pk_add_f32 v[68:69], v[68:69], v[84:85]
    s_waitcnt lgkmcnt(8)
    v_pk_add_f32 v[70:71], v[70:71], v[86:87]
    s_waitcnt lgkmcnt(6)
    v_pk_add_f32 v[72:73], v[72:73], v[88:89]
    s_waitcnt lgkmcnt(4)
    v_pk_add_f32 v[74:75], v[74:75], v[90:91]
    s_waitcnt lgkmcnt(2)
    v_pk_add_f32 v[76:77], v[76:77], v[92:93]
    s_waitcnt lgkmcnt(0)
    v_pk_add_f32 v[78:79], v[78:79], v[94:95]
    v_pk_add_f32 v[64:65], v[64:65], v[72:73]
    v_pk_add_f32 v[66:67], v[66:67], v[74:75]
    v_pk_add_f32 v[68:69], v[68:69], v[76:77]
    v_pk_add_f32 v[70:71], v[70:71], v[78:79]
    v_pk_add_f32 v[64:65], v[64:65], v[68:69]
    v_pk_add_f32 v[66:67], v[66:67], v[70:71]
    v_pk_add_f32 v[64:65], v[64:65], v[66:67]
    v_add_f32 v64, v64, v65
    v_mov_b32 v65, s28
    buffer_store_dwordx2 v[64:65], v97, s[8:11], s34 offen sc1
adaLN_cond__linear_kernel_hedgehog__glu_gated_bilinear__prompt_kernel_skip_5:
adaLN_cond__linear_kernel_hedgehog__glu_gated_bilinear__prompt_kernel_skip_4:
    v_lshrrev_b32 v4, 6, v1
    v_mul_u32_u24 v4, 2688, v4
    v_and_b32 v7, 0x30, v1
    v_add_u32 v7, v4, v7
    s_mul_i32 s37, s30, 56
    s_and_b32 s38, s37, 8
    s_and_b32 s37, s37, 0xfff0
    s_mul_i32 s33, s3, 43008
    s_add_u32 s37, s37, s33
    s_mov_b32 s77, s37
    s_lshl_b32 s44, s3, 11
    s_lshl_b32 s45, s3, 10
    v_lshrrev_b32 v4, 7, v1
    v_and_b32 v5, 0x70, v1
    v_mul_u32_u24 v6, 896, v4
    v_add_u32 v250, v6, v5
    s_sub_u32 s33, s2, 84
    s_cmp_lt_u32 s33, 98
    s_cselect_b32 s7, 1, 0
    s_sub_u32 s33, s2, 28
    s_cmp_lt_u32 s33, 56
    s_cmov_b32 s7, 2
    s_cmp_eq_u32 s7, 1
    s_cbranch_scc0 adaLN_cond__linear_kernel_hedgehog__glu_gated_bilinear__prompt_kernel_skip_6
    s_lshl_b32 s33, s2, 2
    s_add_u32 s33, s33, s3
    s_sub_u32 s34, s33, 336
    s_mov_b32 s24, s62
    s_and_b32 s25, s63, 0xffff
    s_mov_b32 s26, 0x188000
    s_mov_b32 s27, 0x20000
    s_mul_i32 s35, s34, 9363
    s_lshr_b32 s35, s35, 16
    s_mul_i32 s36, s35, 7
    s_sub_u32 s36, s34, s36
    s_mul_i32 s40, s35, 28672
    s_lshl_b32 s37, s36, 7
    s_add_u32 s40, s40, s37
    s_mul_i32 s42, s36, 229376
    s_lshl_b32 s35, s35, 12
    s_add_u32 s42, s42, s35
    s_add_u32 s42, s42, 0x480000
adaLN_cond__linear_kernel_hedgehog__glu_gated_bilinear__prompt_kernel_skip_6:
    s_mul_i32 s33, s101, 172032
    s_add_u32 s48, s33, s77
    s_add_u32 s33, s33, 172032
    s_cmp_eq_u32 s33, 1204224
    s_cmov_b32 s33, 0
    s_add_u32 s49, s33, s77
    s_add_u32 s33, s33, 172032
    s_cmp_eq_u32 s33, 1204224
    s_cmov_b32 s33, 0
    s_add_u32 s50, s33, s77
    s_add_u32 s33, s33, 172032
    s_cmp_eq_u32 s33, 1204224
    s_cmov_b32 s33, 0
    s_add_u32 s51, s33, s77
    s_add_u32 s33, s33, 172032
    s_cmp_eq_u32 s33, 1204224
    s_cmov_b32 s33, 0
    s_add_u32 s56, s33, s77
    s_add_u32 s33, s33, 172032
    s_cmp_eq_u32 s33, 1204224
    s_cmov_b32 s33, 0
    s_add_u32 s57, s33, s77
    s_add_u32 s33, s33, 172032
    s_cmp_eq_u32 s33, 1204224
    s_cmov_b32 s33, 0
    s_add_u32 s71, s33, s77
    s_lshl_b32 s79, s3, 12
    s_mov_b32 s62, s54
    s_mov_b32 s63, s55
    s_and_b32 s53, s53, 0xffff
    s_mov_b32 s54, 25088
    s_mov_b32 s55, 0x20000
    s_lshr_b32 s33, s2, 3
    s_lshr_b32 s68, s33, 4
    s_lshl_b32 s34, s32, 1
    s_add_u32 s68, s68, s34
    s_and_b32 s69, s33, 15
    s_lshr_b32 s35, s69, 2
    s_lshl_b32 s36, s68, 2
    s_add_u32 s72, s35, s36
    s_and_b32 s78, s69, 3
    s_lshl_b32 s73, s78, 2
    s_cmp_eq_u32 s78, 3
    s_cselect_b32 s74, 1, 0
    s_sub_u32 s73, s73, s74
    s_add_u32 s73, s73, s3
    s_lshr_b32 s74, s78, 1
    s_add_u32 s74, s74, s3
    v_lshlrev_b32 v5, 2, v3
    v_sub_u32 v5, v2, v5
    v_mov_b32 v9, 0x3f80
    v_subrev_u32 v6, 0, v5
    v_cmp_gt_u32 vcc, 2, v6
    v_lshlrev_b32 v6, 4, v6
    v_lshlrev_b32 v6, v6, v9
    v_cndmask_b32 v6, 0, v6, vcc
    v_accvgpr_write_b32 a24, v6
    v_subrev_u32 v6, 2, v5
    v_cmp_gt_u32 vcc, 2, v6
    v_lshlrev_b32 v6, 4, v6
    v_lshlrev_b32 v6, v6, v9
    v_cndmask_b32 v6, 0, v6, vcc
    v_accvgpr_write_b32 a25, v6
    v_subrev_u32 v6, 8, v5
    v_cmp_gt_u32 vcc, 2, v6
    v_lshlrev_b32 v6, 4, v6
    v_lshlrev_b32 v6, v6, v9
    v_cndmask_b32 v6, 0, v6, vcc
    v_accvgpr_write_b32 a26, v6
    v_subrev_u32 v6, 10, v5
    v_cmp_gt_u32 vcc, 2, v6
    v_lshlrev_b32 v6, 4, v6
    v_lshlrev_b32 v6, v6, v9
    v_cndmask_b32 v6, 0, v6, vcc
    v_accvgpr_write_b32 a27, v6
    v_subrev_u32 v6, 16, v5
    v_cmp_gt_u32 vcc, 2, v6
    v_lshlrev_b32 v6, 4, v6
    v_lshlrev_b32 v6, v6, v9
    v_cndmask_b32 v6, 0, v6, vcc
    v_accvgpr_write_b32 a28, v6
    v_subrev_u32 v6, 18, v5
    v_cmp_gt_u32 vcc, 2, v6
    v_lshlrev_b32 v6, 4, v6
    v_lshlrev_b32 v6, v6, v9
    v_cndmask_b32 v6, 0, v6, vcc
    v_accvgpr_write_b32 a29, v6
    v_subrev_u32 v6, 24, v5
    v_cmp_gt_u32 vcc, 2, v6
    v_lshlrev_b32 v6, 4, v6
    v_lshlrev_b32 v6, v6, v9
    v_cndmask_b32 v6, 0, v6, vcc
    v_accvgpr_write_b32 a30, v6
    v_subrev_u32 v6, 26, v5
    v_cmp_gt_u32 vcc, 2, v6
    v_lshlrev_b32 v6, 4, v6
    v_lshlrev_b32 v6, v6, v9
    v_cndmask_b32 v6, 0, v6, vcc
    v_accvgpr_write_b32 a31, v6
    v_lshrrev_b32 v4, 3, v2
    v_mul_u32_u24 v4, 7168, v4
    v_and_b32 v5, 7, v2
    v_lshl_add_u32 v4, v5, 7, v4
    s_mul_i32 s35, s3, 28672
    v_add_u32 v4, s35, v4
    v_bfe_u32 v5, v2, 1, 3
    v_xor_b32 v5, v3, v5
    v_xor_b32 v6, 0, v5
    v_lshl_add_u32 v12, v6, 4, v4
    v_xor_b32 v6, 2, v5
    v_lshl_add_u32 v13, v6, 4, v4
    v_xor_b32 v6, 4, v5
    v_lshl_add_u32 v14, v6, 4, v4
    v_xor_b32 v6, 6, v5
    v_lshl_add_u32 v15, v6, 4, v4
    v_cmp_gt_u32 vcc, 28, v2
    s_nop 1
    v_cndmask_b32 v252, 0, -1, vcc
    v_mov_b32 v6, 0x3f803f80
    v_cmp_eq_u32 vcc, 28, v2
    s_nop 1
    v_cndmask_b32 v253, 0, v6, vcc
    v_mov_b32 v176, 0
    v_mov_b32 v177, 0
    v_mov_b32 v178, 0
    v_mov_b32 v179, 0
    s_mov_b32 s37, 0x3f803f80
    v_bfe_u32 v4, v0, 2, 2
    v_bfe_u32 v5, v0, 4, 1
    v_and_b32 v6, 3, v0
    v_lshlrev_b32 v6, 3, v6
    v_lshl_add_u32 v6, v5, 5, v6
    v_lshl_add_u32 v5, v3, 2, v4
    v_lshl_add_u32 v161, v5, 6, v6
    v_add_u32 v161, s38, v161
    v_add_u32 v160, 118784, v161
    v_lshl_add_u32 v5, v3, 2, v4
    v_lshl_add_u32 v251, v5, 7, v6
    s_add_u32 s33, s79, 86016
    v_add_u32 v251, s33, v251
    v_mul_u32_u24 v163, 56, v5
    v_add_u32 v163, v6, v163
    v_add_u32 v163, 161792, v163
    s_lshl_b32 s35, s101, 9
    s_add_u32 s35, s35, 151552
    v_lshl_add_u32 v162, v2, 3, s35
    v_and_b32 v4, 1, v2
    v_lshlrev_b32 v4, 4, v4
    v_mov_b32 v5, 0xffff
    v_lshlrev_b32 v4, v4, v5
    v_lshrrev_b32 v5, 1, v2
    v_lshlrev_b32 v6, 2, v3
    v_sub_u32 v5, v5, v6
    v_cmp_eq_u32 vcc, 0, v5
    s_nop 1
    v_cndmask_b32 v216, 0, v4, vcc
    v_cmp_eq_u32 vcc, 1, v5
    s_nop 1
    v_cndmask_b32 v217, 0, v4, vcc
    v_cmp_eq_u32 vcc, 2, v5
    s_nop 1
    v_cndmask_b32 v218, 0, v4, vcc
    v_cmp_eq_u32 vcc, 3, v5
    s_nop 1
    v_cndmask_b32 v219, 0, v4, vcc
    v_cmp_eq_u32 vcc, 8, v5
    s_nop 1
    v_cndmask_b32 v220, 0, v4, vcc
    v_cmp_eq_u32 vcc, 9, v5
    s_nop 1
    v_cndmask_b32 v221, 0, v4, vcc
    v_cmp_eq_u32 vcc, 10, v5
    s_nop 1
    v_cndmask_b32 v222, 0, v4, vcc
    v_cmp_eq_u32 vcc, 11, v5
    s_nop 1
    v_cndmask_b32 v223, 0, v4, vcc
    v_mov_b32 v202, 0
    v_mov_b32 v203, 0
    v_mov_b32 v214, 0
    v_mov_b32 v215, 0
    v_add_u32 v254, s44, v1
    s_mul_i32 s33, s30, 1568
    s_mov_b32 m0, 161792
    s_nop 0
    buffer_load_dwordx4 v1, s[52:55], s33 offen lds
    buffer_load_dwordx4 v1, s[52:55], s33 offen offset:1024 lds
    v_mov_b32 v248, 0
    v_mov_b32 v249, 0
    s_cmp_eq_u32 s7, 2
    s_cbranch_scc0 adaLN_cond__linear_kernel_hedgehog__glu_gated_bilinear__prompt_kernel_skip_7
    s_mov_b32 s20, s66
    s_and_b32 s21, s67, 0xffff
    s_mov_b32 s22, 0x24c000
    s_mov_b32 s23, 0x20000
    s_mov_b32 s24, s64
    s_and_b32 s25, s65, 0xffff
    s_mov_b32 s26, 0x380
    s_mov_b32 s27, 0x20000
    v_lshrrev_b32 v249, 3, v0
    v_and_b32 v6, 7, v0
    v_mul_u32_u24 v248, 5376, v249
    v_lshl_add_u32 v248, v6, 4, v248
    v_lshlrev_b32 v249, 1, v249
    s_and_b32 s47, s2, 1
    s_mul_i32 s46, s47, 1204224
    s_lshl_b32 s36, s2, 6
    s_and_b32 s36, s36, 0xff80
    s_add_u32 s46, s46, s36
    s_mul_i32 s47, s47, 448
adaLN_cond__linear_kernel_hedgehog__glu_gated_bilinear__prompt_kernel_skip_7:
    s_mov_b32 s64, s62
    s_and_b32 s65, s63, 0xffff
    s_mov_b32 s66, 0x62000
    s_mov_b32 s67, 0x20000
    s_lshr_b32 s33, s2, 3
    s_lshl_b32 s33, s33, 2
    s_add_u32 s33, s33, s3
    s_mul_i32 s41, s33, 3200
    s_lshl_b32 s33, s2, 2
    s_add_u32 s33, s33, s3
    s_and_b32 s43, s33, 511
    s_mul_i32 s43, s43, 3200
    v_lshlrev_b32 v247, 3, v1
    s_add_u32 s96, s96, 128
    s_cmp_eq_u32 s96, 896
    s_cmov_b32 s96, 0
    s_add_u32 s33, s97, s96
    s_add_u32 m0, s39, 2048
    s_add_u32 s34, s33, 0
    buffer_load_dwordx4 v10, s[12:15], s34 offen lds
    s_add_u32 m0, s39, 9216
    s_add_u32 s34, s33, 7168
    buffer_load_dwordx4 v11, s[12:15], s34 offen lds
    s_add_u32 m0, s39, 16384
    s_add_u32 s34, s33, 14336
    buffer_load_dwordx4 v10, s[12:15], s34 offen lds
    s_add_u32 m0, s39, 23552
    s_add_u32 s34, s33, 21504
    buffer_load_dwordx4 v11, s[12:15], s34 offen lds
    s_add_u32 s96, s96, 128
    s_cmp_eq_u32 s96, 896
    s_cmov_b32 s96, 0
    s_add_u32 s33, s97, s96
    s_add_u32 m0, s39, 3072
    s_add_u32 s34, s33, 0
    buffer_load_dwordx4 v10, s[12:15], s34 offen lds
    s_add_u32 m0, s39, 10240
    s_add_u32 s34, s33, 7168
    buffer_load_dwordx4 v11, s[12:15], s34 offen lds
    s_add_u32 m0, s39, 17408
    s_add_u32 s34, s33, 14336
    buffer_load_dwordx4 v10, s[12:15], s34 offen lds
    s_add_u32 m0, s39, 24576
    s_add_u32 s34, s33, 21504
    buffer_load_dwordx4 v11, s[12:15], s34 offen lds
    s_waitcnt vmcnt(14)
    ds_read_b128 v[16:19], v12 offset:0
    ds_read_b128 v[20:23], v13 offset:0
    ds_read_b128 v[24:27], v14 offset:0
    ds_read_b128 v[28:31], v15 offset:0
    s_add_u32 s96, s96, 128
    s_cmp_eq_u32 s96, 896
    s_cmov_b32 s96, 0
    s_add_u32 s33, s97, s96
    s_add_u32 m0, s39, 4096
    s_add_u32 s34, s33, 0
    buffer_load_dwordx4 v10, s[12:15], s34 offen lds
    s_add_u32 m0, s39, 11264
    s_add_u32 s34, s33, 7168
    buffer_load_dwordx4 v11, s[12:15], s34 offen lds
    s_add_u32 m0, s39, 18432
    s_add_u32 s34, s33, 14336
    buffer_load_dwordx4 v10, s[12:15], s34 offen lds
    s_add_u32 m0, s39, 25600
    s_add_u32 s34, s33, 21504
    buffer_load_dwordx4 v11, s[12:15], s34 offen lds
    s_waitcnt lgkmcnt(0)
    v_dot2c_f32_bf16 v176, s37, v16
    v_dot2c_f32_bf16 v178, v16, v16
    v_dot2c_f32_bf16 v177, s37, v17
    v_dot2c_f32_bf16 v179, v17, v17
    v_dot2c_f32_bf16 v176, s37, v18
    v_dot2c_f32_bf16 v178, v18, v18
    v_dot2c_f32_bf16 v177, s37, v19
    v_dot2c_f32_bf16 v179, v19, v19
    v_dot2c_f32_bf16 v176, s37, v20
    v_dot2c_f32_bf16 v178, v20, v20
    v_dot2c_f32_bf16 v177, s37, v21
    v_dot2c_f32_bf16 v179, v21, v21
    v_dot2c_f32_bf16 v176, s37, v22
    v_dot2c_f32_bf16 v178, v22, v22
    v_dot2c_f32_bf16 v177, s37, v23
    v_dot2c_f32_bf16 v179, v23, v23
    v_dot2c_f32_bf16 v176, s37, v24
    v_dot2c_f32_bf16 v178, v24, v24
    v_dot2c_f32_bf16 v177, s37, v25
    v_dot2c_f32_bf16 v179, v25, v25
    v_dot2c_f32_bf16 v176, s37, v26
    v_dot2c_f32_bf16 v178, v26, v26
    v_dot2c_f32_bf16 v177, s37, v27
    v_dot2c_f32_bf16 v179, v27, v27
    v_dot2c_f32_bf16 v176, s37, v28
    v_dot2c_f32_bf16 v178, v28, v28
    v_dot2c_f32_bf16 v177, s37, v29
    v_dot2c_f32_bf16 v179, v29, v29
    v_dot2c_f32_bf16 v176, s37, v30
    v_dot2c_f32_bf16 v178, v30, v30
    v_dot2c_f32_bf16 v177, s37, v31
    v_dot2c_f32_bf16 v179, v31, v31
    s_waitcnt vmcnt(14)
    ds_read_b128 v[32:35], v12 offset:1024
    ds_read_b128 v[36:39], v13 offset:1024
    ds_read_b128 v[40:43], v14 offset:1024
    ds_read_b128 v[44:47], v15 offset:1024
    s_add_u32 s96, s96, 128
    s_cmp_eq_u32 s96, 896
    s_cmov_b32 s96, 0
    s_add_u32 s33, s97, s96
    s_add_u32 m0, s39, 5120
    s_add_u32 s34, s33, 0
    buffer_load_dwordx4 v10, s[12:15], s34 offen lds
    s_add_u32 m0, s39, 12288
    s_add_u32 s34, s33, 7168
    buffer_load_dwordx4 v11, s[12:15], s34 offen lds
    s_add_u32 m0, s39, 19456
    s_add_u32 s34, s33, 14336
    buffer_load_dwordx4 v10, s[12:15], s34 offen lds
    s_add_u32 m0, s39, 26624
    s_add_u32 s34, s33, 21504
    buffer_load_dwordx4 v11, s[12:15], s34 offen lds
    s_waitcnt lgkmcnt(3)
    v_dot2c_f32_bf16 v176, s37, v32
    v_dot2c_f32_bf16 v178, v32, v32
    v_dot2c_f32_bf16 v177, s37, v33
    v_dot2c_f32_bf16 v179, v33, v33
    v_dot2c_f32_bf16 v176, s37, v34
    v_dot2c_f32_bf16 v178, v34, v34
    v_dot2c_f32_bf16 v177, s37, v35
    v_dot2c_f32_bf16 v179, v35, v35
    s_waitcnt lgkmcnt(2)
    v_dot2c_f32_bf16 v176, s37, v36
    v_dot2c_f32_bf16 v178, v36, v36
    v_dot2c_f32_bf16 v177, s37, v37
    v_dot2c_f32_bf16 v179, v37, v37
    v_dot2c_f32_bf16 v176, s37, v38
    v_dot2c_f32_bf16 v178, v38, v38
    v_dot2c_f32_bf16 v177, s37, v39
    v_dot2c_f32_bf16 v179, v39, v39
    s_waitcnt lgkmcnt(1)
    v_dot2c_f32_bf16 v176, s37, v40
    v_dot2c_f32_bf16 v178, v40, v40
    v_dot2c_f32_bf16 v177, s37, v41
    v_dot2c_f32_bf16 v179, v41, v41
    v_dot2c_f32_bf16 v176, s37, v42
    v_dot2c_f32_bf16 v178, v42, v42
    v_dot2c_f32_bf16 v177, s37, v43
    v_dot2c_f32_bf16 v179, v43, v43
    s_waitcnt lgkmcnt(0)
    v_dot2c_f32_bf16 v176, s37, v44
    v_dot2c_f32_bf16 v178, v44, v44
    v_dot2c_f32_bf16 v177, s37, v45
    v_dot2c_f32_bf16 v179, v45, v45
    v_dot2c_f32_bf16 v176, s37, v46
    v_dot2c_f32_bf16 v178, v46, v46
    v_dot2c_f32_bf16 v177, s37, v47
    v_dot2c_f32_bf16 v179, v47, v47
    s_waitcnt vmcnt(12)
    ds_read_b128 v[48:51], v12 offset:2048
    ds_read_b128 v[52:55], v13 offset:2048
    ds_read_b128 v[56:59], v14 offset:2048
    ds_read_b128 v[60:63], v15 offset:2048
    s_add_u32 s96, s96, 128
    s_cmp_eq_u32 s96, 896
    s_cmov_b32 s96, 0
    s_add_u32 s33, s97, s96
    s_add_u32 m0, s39, 6144
    s_add_u32 s34, s33, 0
    buffer_load_dwordx4 v10, s[12:15], s34 offen lds
    s_add_u32 m0, s39, 13312
    s_add_u32 s34, s33, 7168
    buffer_load_dwordx4 v11, s[12:15], s34 offen lds
    s_add_u32 m0, s39, 20480
    s_add_u32 s34, s33, 14336
    buffer_load_dwordx4 v10, s[12:15], s34 offen lds
    s_add_u32 m0, s39, 27648
    s_add_u32 s34, s33, 21504
    buffer_load_dwordx4 v11, s[12:15], s34 offen lds
    ds_read_b64_tr_b16 v[232:233], v163 offset:0
    ds_read_b64_tr_b16 v[234:235], v163 offset:448
    ds_read_b64_tr_b16 v[236:237], v163 offset:896
    ds_read_b64_tr_b16 v[238:239], v163 offset:1344
    s_waitcnt lgkmcnt(7)
    v_dot2c_f32_bf16 v176, s37, v48
    v_dot2c_f32_bf16 v178, v48, v48
    v_dot2c_f32_bf16 v177, s37, v49
    v_dot2c_f32_bf16 v179, v49, v49
    v_dot2c_f32_bf16 v176, s37, v50
    v_dot2c_f32_bf16 v178, v50, v50
    v_dot2c_f32_bf16 v177, s37, v51
    v_dot2c_f32_bf16 v179, v51, v51
    s_waitcnt lgkmcnt(6)
    v_dot2c_f32_bf16 v176, s37, v52
    v_dot2c_f32_bf16 v178, v52, v52
    v_dot2c_f32_bf16 v177, s37, v53
    v_dot2c_f32_bf16 v179, v53, v53
    v_dot2c_f32_bf16 v176, s37, v54
    v_dot2c_f32_bf16 v178, v54, v54
    v_dot2c_f32_bf16 v177, s37, v55
    v_dot2c_f32_bf16 v179, v55, v55
    s_waitcnt lgkmcnt(5)
    v_dot2c_f32_bf16 v176, s37, v56
    v_dot2c_f32_bf16 v178, v56, v56
    v_dot2c_f32_bf16 v177, s37, v57
    v_dot2c_f32_bf16 v179, v57, v57
    v_dot2c_f32_bf16 v176, s37, v58
    v_dot2c_f32_bf16 v178, v58, v58
    v_dot2c_f32_bf16 v177, s37, v59
    v_dot2c_f32_bf16 v179, v59, v59
    s_waitcnt lgkmcnt(4)
    v_dot2c_f32_bf16 v176, s37, v60
    v_dot2c_f32_bf16 v178, v60, v60
    v_dot2c_f32_bf16 v177, s37, v61
    v_dot2c_f32_bf16 v179, v61, v61
    v_dot2c_f32_bf16 v176, s37, v62
    v_dot2c_f32_bf16 v178, v62, v62
    v_dot2c_f32_bf16 v177, s37, v63
    v_dot2c_f32_bf16 v179, v63, v63
    s_waitcnt vmcnt(12)
    ds_read_b128 v[64:67], v12 offset:3072
    ds_read_b128 v[68:71], v13 offset:3072
    ds_read_b128 v[72:75], v14 offset:3072
    ds_read_b128 v[76:79], v15 offset:3072
    s_add_u32 m0, s44, 117888
    s_nop 0
    buffer_load_dwordx4 v7, s[16:19], s48 offen offset:896 lds
    s_add_u32 m0, s44, 118016
    s_nop 0
    buffer_load_dwordx4 v7, s[16:19], s48 offen offset:1792 lds
    v_cmp_eq_u32 vcc, 1, v3
    s_waitcnt lgkmcnt(7)
    v_and_b32 v232, v252, v232
    v_and_b32 v233, v252, v233
    s_waitcnt lgkmcnt(6)
    v_and_b32 v234, v252, v234
    v_and_b32 v235, v252, v235
    s_waitcnt lgkmcnt(5)
    v_and_b32 v236, v252, v236
    v_and_b32 v237, v252, v237
    s_waitcnt lgkmcnt(4)
    v_and_b32 v238, v252, v238
    v_and_b32 v239, v252, v239
    v_cndmask_b32 v238, v238, 0, vcc
    v_cndmask_b32 v239, v239, 0, vcc
    v_accvgpr_write_b32 a16, v232
    v_accvgpr_write_b32 a17, v233
    v_accvgpr_write_b32 a18, v234
    v_accvgpr_write_b32 a19, v235
    v_accvgpr_write_b32 a20, v236
    v_accvgpr_write_b32 a21, v237
    v_accvgpr_write_b32 a22, v238
    v_accvgpr_write_b32 a23, v239
    s_waitcnt lgkmcnt(3)
    v_dot2c_f32_bf16 v176, s37, v64
    v_dot2c_f32_bf16 v178, v64, v64
    v_dot2c_f32_bf16 v177, s37, v65
    v_dot2c_f32_bf16 v179, v65, v65
    v_dot2c_f32_bf16 v176, s37, v66
    v_dot2c_f32_bf16 v178, v66, v66
    v_dot2c_f32_bf16 v177, s37, v67
    v_dot2c_f32_bf16 v179, v67, v67
    s_waitcnt lgkmcnt(2)
    v_dot2c_f32_bf16 v176, s37, v68
    v_dot2c_f32_bf16 v178, v68, v68
    v_dot2c_f32_bf16 v177, s37, v69
    v_dot2c_f32_bf16 v179, v69, v69
    v_dot2c_f32_bf16 v176, s37, v70
    v_dot2c_f32_bf16 v178, v70, v70
    v_dot2c_f32_bf16 v177, s37, v71
    v_dot2c_f32_bf16 v179, v71, v71
    s_waitcnt lgkmcnt(1)
    v_dot2c_f32_bf16 v176, s37, v72
    v_dot2c_f32_bf16 v178, v72, v72
    v_dot2c_f32_bf16 v177, s37, v73
    v_dot2c_f32_bf16 v179, v73, v73
    v_dot2c_f32_bf16 v176, s37, v74
    v_dot2c_f32_bf16 v178, v74, v74
    v_dot2c_f32_bf16 v177, s37, v75
    v_dot2c_f32_bf16 v179, v75, v75
    s_waitcnt lgkmcnt(0)
    v_dot2c_f32_bf16 v176, s37, v76
    v_dot2c_f32_bf16 v178, v76, v76
    v_dot2c_f32_bf16 v177, s37, v77
    v_dot2c_f32_bf16 v179, v77, v77
    v_dot2c_f32_bf16 v176, s37, v78
    v_dot2c_f32_bf16 v178, v78, v78
    v_dot2c_f32_bf16 v177, s37, v79
    v_dot2c_f32_bf16 v179, v79, v79
    s_waitcnt vmcnt(10)
    ds_read_b128 v[80:83], v12 offset:4096
    ds_read_b128 v[84:87], v13 offset:4096
    ds_read_b128 v[88:91], v14 offset:4096
    ds_read_b128 v[92:95], v15 offset:4096
    s_add_u32 m0, s44, 126080
    s_nop 0
    buffer_load_dwordx4 v7, s[16:19], s49 offen offset:896 lds
    s_add_u32 m0, s44, 126208
    s_nop 0
    buffer_load_dwordx4 v7, s[16:19], s49 offen offset:1792 lds
    s_waitcnt lgkmcnt(3)
    v_dot2c_f32_bf16 v176, s37, v80
    v_dot2c_f32_bf16 v178, v80, v80
    v_dot2c_f32_bf16 v177, s37, v81
    v_dot2c_f32_bf16 v179, v81, v81
    v_dot2c_f32_bf16 v176, s37, v82
    v_dot2c_f32_bf16 v178, v82, v82
    v_dot2c_f32_bf16 v177, s37, v83
    v_dot2c_f32_bf16 v179, v83, v83
    s_waitcnt lgkmcnt(2)
    v_dot2c_f32_bf16 v176, s37, v84
    v_dot2c_f32_bf16 v178, v84, v84
    v_dot2c_f32_bf16 v177, s37, v85
    v_dot2c_f32_bf16 v179, v85, v85
    v_dot2c_f32_bf16 v176, s37, v86
    v_dot2c_f32_bf16 v178, v86, v86
    v_dot2c_f32_bf16 v177, s37, v87
    v_dot2c_f32_bf16 v179, v87, v87
    s_waitcnt lgkmcnt(1)
    v_dot2c_f32_bf16 v176, s37, v88
    v_dot2c_f32_bf16 v178, v88, v88
    v_dot2c_f32_bf16 v177, s37, v89
    v_dot2c_f32_bf16 v179, v89, v89
    v_dot2c_f32_bf16 v176, s37, v90
    v_dot2c_f32_bf16 v178, v90, v90
    v_dot2c_f32_bf16 v177, s37, v91
    v_dot2c_f32_bf16 v179, v91, v91
    s_waitcnt lgkmcnt(0)
    v_dot2c_f32_bf16 v176, s37, v92
    v_dot2c_f32_bf16 v178, v92, v92
    v_dot2c_f32_bf16 v177, s37, v93
    v_dot2c_f32_bf16 v179, v93, v93
    v_dot2c_f32_bf16 v176, s37, v94
    v_dot2c_f32_bf16 v178, v94, v94
    v_dot2c_f32_bf16 v177, s37, v95
    v_dot2c_f32_bf16 v179, v95, v95
    s_waitcnt vmcnt(8)
    ds_read_b128 v[96:99], v12 offset:5120
    ds_read_b128 v[100:103], v13 offset:5120
    ds_read_b128 v[104:107], v14 offset:5120
    ds_read_b128 v[108:111], v15 offset:5120
    s_add_u32 m0, s44, 134272
    s_nop 0
    buffer_load_dwordx4 v7, s[16:19], s50 offen offset:896 lds
    s_add_u32 m0, s44, 134400
    s_nop 0
    buffer_load_dwordx4 v7, s[16:19], s50 offen offset:1792 lds
    s_waitcnt lgkmcnt(3)
    v_dot2c_f32_bf16 v176, s37, v96
    v_dot2c_f32_bf16 v178, v96, v96
    v_dot2c_f32_bf16 v177, s37, v97
    v_dot2c_f32_bf16 v179, v97, v97
    v_dot2c_f32_bf16 v176, s37, v98
    v_dot2c_f32_bf16 v178, v98, v98
    v_dot2c_f32_bf16 v177, s37, v99
    v_dot2c_f32_bf16 v179, v99, v99
    s_waitcnt lgkmcnt(2)
    v_dot2c_f32_bf16 v176, s37, v100
    v_dot2c_f32_bf16 v178, v100, v100
    v_dot2c_f32_bf16 v177, s37, v101
    v_dot2c_f32_bf16 v179, v101, v101
    v_dot2c_f32_bf16 v176, s37, v102
    v_dot2c_f32_bf16 v178, v102, v102
    v_dot2c_f32_bf16 v177, s37, v103
    v_dot2c_f32_bf16 v179, v103, v103
    s_waitcnt lgkmcnt(1)
    v_dot2c_f32_bf16 v176, s37, v104
    v_dot2c_f32_bf16 v178, v104, v104
    v_dot2c_f32_bf16 v177, s37, v105
    v_dot2c_f32_bf16 v179, v105, v105
    v_dot2c_f32_bf16 v176, s37, v106
    v_dot2c_f32_bf16 v178, v106, v106
    v_dot2c_f32_bf16 v177, s37, v107
    v_dot2c_f32_bf16 v179, v107, v107
    s_waitcnt lgkmcnt(0)
    v_dot2c_f32_bf16 v176, s37, v108
    v_dot2c_f32_bf16 v178, v108, v108
    v_dot2c_f32_bf16 v177, s37, v109
    v_dot2c_f32_bf16 v179, v109, v109
    v_dot2c_f32_bf16 v176, s37, v110
    v_dot2c_f32_bf16 v178, v110, v110
    v_dot2c_f32_bf16 v177, s37, v111
    v_dot2c_f32_bf16 v179, v111, v111
    s_waitcnt vmcnt(6)
    ds_read_b128 v[112:115], v12 offset:6144
    ds_read_b128 v[116:119], v13 offset:6144
    ds_read_b128 v[120:123], v14 offset:6144
    ds_read_b128 v[124:127], v15 offset:6144
    s_add_u32 m0, s44, 142464
    s_nop 0
    buffer_load_dwordx4 v7, s[16:19], s51 offen offset:896 lds
    s_add_u32 m0, s44, 142592
    s_nop 0
    buffer_load_dwordx4 v7, s[16:19], s51 offen offset:1792 lds
    s_waitcnt lgkmcnt(3)
    v_dot2c_f32_bf16 v176, s37, v112
    v_dot2c_f32_bf16 v178, v112, v112
    v_dot2c_f32_bf16 v177, s37, v113
    v_dot2c_f32_bf16 v179, v113, v113
    v_dot2c_f32_bf16 v176, s37, v114
    v_dot2c_f32_bf16 v178, v114, v114
    v_dot2c_f32_bf16 v177, s37, v115
    v_dot2c_f32_bf16 v179, v115, v115
    s_waitcnt lgkmcnt(2)
    v_dot2c_f32_bf16 v176, s37, v116
    v_dot2c_f32_bf16 v178, v116, v116
    v_dot2c_f32_bf16 v177, s37, v117
    v_dot2c_f32_bf16 v179, v117, v117
    v_dot2c_f32_bf16 v176, s37, v118
    v_dot2c_f32_bf16 v178, v118, v118
    v_dot2c_f32_bf16 v177, s37, v119
    v_dot2c_f32_bf16 v179, v119, v119
    s_waitcnt lgkmcnt(1)
    v_dot2c_f32_bf16 v176, s37, v120
    v_dot2c_f32_bf16 v178, v120, v120
    v_dot2c_f32_bf16 v177, s37, v121
    v_dot2c_f32_bf16 v179, v121, v121
    v_dot2c_f32_bf16 v176, s37, v122
    v_dot2c_f32_bf16 v178, v122, v122
    v_dot2c_f32_bf16 v177, s37, v123
    v_dot2c_f32_bf16 v179, v123, v123
    s_waitcnt lgkmcnt(0)
    v_dot2c_f32_bf16 v176, s37, v124
    v_dot2c_f32_bf16 v178, v124, v124
    v_dot2c_f32_bf16 v177, s37, v125
    v_dot2c_f32_bf16 v179, v125, v125
    v_dot2c_f32_bf16 v176, s37, v126
    v_dot2c_f32_bf16 v178, v126, v126
    v_dot2c_f32_bf16 v177, s37, v127
    v_dot2c_f32_bf16 v179, v127, v127
    s_nop 1
    v_add_f32 v176, v176, v177
    v_add_f32 v178, v178, v179
    v_mov_b32 v180, v176
    v_mov_b32 v181, v178
    s_nop 0
    v_permlane32_swap_b32 v176, v180
    v_permlane32_swap_b32 v178, v181
    v_add_f32 v176, v176, v180
    v_add_f32 v178, v178, v181
    v_mul_f32 v182, 0xbb124925, v176
    v_mov_b32 v180, 0x3727c5ac
    v_mov_b32 v183, v180
    v_fmac_f32 v183, 0x3b124925, v178
    v_fma_f32 v183, -v182, v182, v183
    v_max_f32 v183, v183, v180
    v_rsq_f32 v8, v183
    v_sqrt_f32 v183, v183
    s_nop 0
    v_cvt_pk_bf16_f32 v180, v182, v183
    v_lshlrev_b32 v181, 16, v180
    v_and_b32 v180, 0xffff0000, v180
    v_sub_f32 v182, v182, v181
    v_sub_f32 v183, v183, v180
    v_cvt_pk_bf16_f32 v224, v181, v182
    v_cvt_pk_bf16_f32 v225, v180, v183
    v_mov_b32 v226, 0
    v_mov_b32 v227, 0
    v_cmp_eq_u32 vcc, 1, v3
    s_nop 1
    v_cndmask_b32 v224, v224, 0, vcc
    v_cndmask_b32 v225, v225, 0, vcc
    v_mov_b32 v12, v160
    v_mov_b32 v13, v161
    v_mov_b32 v14, v162
    s_waitcnt lgkmcnt(0)
    s_mul_i32 s28, s6, 0x9e3779b1
    s_add_u32 s28, s28, 0x7f4a7c15
    s_mul_i32 s100, s28, 0x85ebca6b
    s_xor_b32 s100, s100, 0x5bd1e995
    s_lshl_b32 s76, s3, 10
    s_add_u32 s77, s76, 4096
    s_min_u32 s77, s77, 6144
    s_add_u32 s34, s76, 0x1000
    buffer_load_dwordx4 v[228:231], v1, s[8:11], s34 offen sc1
    s_add_u32 s34, s77, 0x1000
    buffer_load_dwordx4 v[232:235], v1, s[8:11], s34 offen sc1
    s_add_u32 s34, s76, 0x3000
    buffer_load_dwordx4 v[236:239], v1, s[8:11], s34 offen sc1
    s_add_u32 s34, s77, 0x3000
    buffer_load_dwordx4 v[240:243], v1, s[8:11], s34 offen sc1
    s_waitcnt vmcnt(3)
    v_xor_b32 v4, s28, v229
    v_bitop3_b32 v4, v4, v231, s28 bitop3:0xf6
    s_waitcnt vmcnt(2)
    v_bitop3_b32 v4, v4, v233, s28 bitop3:0xf6
    v_bitop3_b32 v4, v4, v235, s28 bitop3:0xf6
    s_waitcnt vmcnt(1)
    v_bitop3_b32 v4, v4, v237, s28 bitop3:0xf6
    v_bitop3_b32 v4, v4, v239, s28 bitop3:0xf6
    s_waitcnt vmcnt(0)
    v_bitop3_b32 v4, v4, v241, s28 bitop3:0xf6
    v_bitop3_b32 v4, v4, v243, s28 bitop3:0xf6
    v_cmp_ne_u32 vcc, 0, v4
    s_nop 1
    s_cbranch_vccz adaLN_cond__linear_kernel_hedgehog__glu_gated_bilinear__prompt_kernel_skip_8
    s_mov_b32 s33, 40000
adaLN_cond__linear_kernel_hedgehog__glu_gated_bilinear__prompt_kernel_poll_9:
    s_add_u32 s34, s76, 0x1000
    buffer_load_dwordx4 v[228:231], v1, s[8:11], s34 offen sc1
    s_add_u32 s34, s77, 0x1000
    buffer_load_dwordx4 v[232:235], v1, s[8:11], s34 offen sc1
    s_add_u32 s34, s76, 0x3000
    buffer_load_dwordx4 v[236:239], v1, s[8:11], s34 offen sc1
    s_add_u32 s34, s77, 0x3000
    buffer_load_dwordx4 v[240:243], v1, s[8:11], s34 offen sc1
    s_waitcnt vmcnt(0)
    v_xor_b32 v4, s28, v229
    v_bitop3_b32 v4, v4, v231, s28 bitop3:0xf6
    v_bitop3_b32 v4, v4, v233, s28 bitop3:0xf6
    v_bitop3_b32 v4, v4, v235, s28 bitop3:0xf6
    v_bitop3_b32 v4, v4, v237, s28 bitop3:0xf6
    v_bitop3_b32 v4, v4, v239, s28 bitop3:0xf6
    v_bitop3_b32 v4, v4, v241, s28 bitop3:0xf6
    v_bitop3_b32 v4, v4, v243, s28 bitop3:0xf6
    v_cmp_ne_u32 vcc, 0, v4
    s_sub_u32 s33, s33, 1
    s_cbranch_scc1 adaLN_cond__linear_kernel_hedgehog__glu_gated_bilinear__prompt_kernel_pollx_10
    s_cbranch_vccnz adaLN_cond__linear_kernel_hedgehog__glu_gated_bilinear__prompt_kernel_poll_9
adaLN_cond__linear_kernel_hedgehog__glu_gated_bilinear__prompt_kernel_pollx_10:
adaLN_cond__linear_kernel_hedgehog__glu_gated_bilinear__prompt_kernel_skip_8:
    s_lshr_b32 s34, s76, 1
    s_add_u32 s34, s34, 151552
    v_lshrrev_b32 v4, 1, v1
    v_add_u32 v4, s34, v4
    v_add_f32 v228, v228, v236
    v_add_f32 v230, v230, v238
    v_cvt_pk_bf16_f32 v228, v228, v228
    v_cvt_pk_bf16_f32 v229, v230, v230
    v_and_b32 v228, 0xffff0000, v228
    v_add_f32 v228, 1.0, v228
    v_cvt_pk_bf16_f32 v228, v228, v228
    ds_write_b64 v4, v[228:229] offset:0
    ds_write_b64 v4, v[228:229] offset:3584
    s_lshr_b32 s34, s77, 1
    s_add_u32 s34, s34, 151552
    v_lshrrev_b32 v4, 1, v1
    v_add_u32 v4, s34, v4
    v_add_f32 v232, v232, v240
    v_add_f32 v234, v234, v242
    v_cvt_pk_bf16_f32 v232, v232, v232
    v_cvt_pk_bf16_f32 v233, v234, v234
    v_and_b32 v232, 0xffff0000, v232
    v_add_f32 v232, 1.0, v232
    v_cvt_pk_bf16_f32 v232, v232, v232
    ds_write_b64 v4, v[232:233] offset:0
    ds_write_b64 v4, v[232:233] offset:3584
    s_mov_b32 s6, s12
    s_mov_b32 s70, s13
    s_cmp_ge_u32 s2, 128
    s_cselect_b32 s12, s60, s58
    s_cselect_b32 s13, s61, s59
    s_and_b32 s13, s13, 0xffff
    s_mov_b32 s14, 0x188000
    s_waitcnt vmcnt(0) lgkmcnt(0)
    s_barrier
    s_add_u32 m0, s44, 0
    s_add_u32 s33, s56, 896
    buffer_load_dwordx4 v7, s[16:19], s33 offen lds
    s_add_u32 m0, s44, 1024
    s_add_u32 s33, s56, 1792
    buffer_load_dwordx4 v7, s[16:19], s33 offen lds
    s_add_u32 m0, s44, 7296
    s_nop 0
    buffer_load_dwordx4 v7, s[16:19], s57 offen offset:896 lds
    s_add_u32 m0, s44, 7424
    s_nop 0
    buffer_load_dwordx4 v7, s[16:19], s57 offen offset:1792 lds
    s_add_u32 m0, s44, 15488
    s_nop 0
    buffer_load_dwordx4 v7, s[16:19], s71 offen offset:896 lds
    s_add_u32 m0, s44, 15616
    s_nop 0
    buffer_load_dwordx4 v7, s[16:19], s71 offen offset:1792 lds
    ds_read_b64 v[200:201], v14 offset:0
    ds_read_b64 v[212:213], v14 offset:256
    ds_read_b64_tr_b16 a[168:169], v12 offset:0
    ds_read_b64_tr_b16 a[170:171], v12 offset:512
    ds_read_b64_tr_b16 a[172:173], v12 offset:1024
    ds_read_b64_tr_b16 a[174:175], v12 offset:1536
    ds_read_b64_tr_b16 a[176:177], v12 offset:2048
    ds_read_b64_tr_b16 a[178:179], v12 offset:2560
    ds_read_b64_tr_b16 a[180:181], v12 offset:3072
    ds_read_b64_tr_b16 a[182:183], v12 offset:3584
    s_waitcnt lgkmcnt(9)
    v_and_b32 v192, v216, v200
    v_and_b32 v193, v217, v200
    v_and_b32 v194, v218, v200
    v_and_b32 v195, v219, v200
    v_and_b32 v196, v220, v200
    v_and_b32 v197, v221, v200
    v_and_b32 v198, v222, v200
    v_and_b32 v199, v223, v200
    v_mfma_f32_32x32x16_bf16 v[160:175], v[200:203], v[224:227], 0
    v_mfma_f32_32x32x16_bf16 v[160:175], v[192:195], v[16:19], v[160:175]
    v_mfma_f32_32x32x16_bf16 v[160:175], v[196:199], v[20:23], v[160:175]
    s_waitcnt lgkmcnt(8)
    v_and_b32 v204, v216, v212
    v_and_b32 v205, v217, v212
    v_and_b32 v206, v218, v212
    v_and_b32 v207, v219, v212
    v_and_b32 v208, v220, v212
    v_and_b32 v209, v221, v212
    v_and_b32 v210, v222, v212
    v_and_b32 v211, v223, v212
    v_mfma_f32_32x32x16_bf16 v[176:191], v[212:215], v[224:227], 0
    ds_read_b64 v[200:201], v14 offset:512
    ds_read_b64_tr_b16 a[184:185], v12 offset:4096
    ds_read_b64_tr_b16 a[186:187], v12 offset:4608
    v_mfma_f32_32x32x16_bf16 v[176:191], v[204:207], v[24:27], v[176:191]
    v_cvt_pk_bf16_f32 v16, v160, v161
    v_cvt_pk_bf16_f32 v17, v162, v163
    v_cvt_pk_bf16_f32 v18, v164, v165
    v_cvt_pk_bf16_f32 v19, v166, v167
    v_mfma_f32_32x32x16_bf16 v[176:191], v[208:211], v[28:31], v[176:191]
    v_cvt_pk_bf16_f32 v20, v168, v169
    v_cvt_pk_bf16_f32 v21, v170, v171
    v_cvt_pk_bf16_f32 v22, v172, v173
    v_cvt_pk_bf16_f32 v23, v174, v175
    s_waitcnt lgkmcnt(9)
    v_mfma_f32_32x32x16_bf16 v[128:143], a[168:171], v[16:19], 0
    ds_read_b64_tr_b16 a[188:189], v12 offset:5120
    ds_read_b64_tr_b16 a[190:191], v12 offset:5632
    ds_read_b64_tr_b16 a[192:193], v12 offset:6144
    ds_read_b64_tr_b16 a[194:195], v12 offset:6656
    s_waitcnt lgkmcnt(11)
    v_mfma_f32_32x32x16_bf16 v[144:159], v[16:19], a[172:175], 0
    ds_read_b64_tr_b16 a[196:197], v12 offset:7168
    ds_read_b64_tr_b16 a[198:199], v12 offset:7680
    s_cmp_eq_u32 s7, 1
    s_cbranch_scc0 adaLN_cond__linear_kernel_hedgehog__glu_gated_bilinear__prompt_kernel_skip_11
    s_add_u32 m0, s79, 86016
    s_nop 0
    buffer_load_dwordx4 v250, s[24:27], s40 offen lds
    s_add_u32 s40, s40, 7168
    s_add_u32 m0, s79, 87040
    s_nop 0
    buffer_load_dwordx4 v250, s[24:27], s40 offen lds
    s_add_u32 s40, s40, 7168
    s_add_u32 m0, s79, 88064
    s_nop 0
    buffer_load_dwordx4 v250, s[24:27], s40 offen lds
    s_add_u32 s40, s40, 7168
    s_add_u32 m0, s79, 89088
    s_nop 0
    buffer_load_dwordx4 v250, s[24:27], s40 offen lds
adaLN_cond__linear_kernel_hedgehog__glu_gated_bilinear__prompt_kernel_skip_11:
    s_waitcnt lgkmcnt(8)
    v_and_b32 v192, v216, v200
    v_mfma_f32_32x32x16_bf16 v[128:143], a[176:179], v[20:23], v[128:143]
    v_and_b32 v193, v217, v200
    v_and_b32 v194, v218, v200
    v_and_b32 v195, v219, v200
    v_and_b32 v196, v220, v200
    v_mfma_f32_32x32x16_bf16 v[144:159], v[20:23], a[180:183], v[144:159]
    v_and_b32 v197, v221, v200
    v_and_b32 v198, v222, v200
    v_and_b32 v199, v223, v200
    v_mfma_f32_32x32x16_bf16 v[160:175], v[200:203], v[224:227], 0
    ds_read_b64 v[212:213], v14 offset:768
    ds_read_b64_tr_b16 a[168:169], v12 offset:8192
    ds_read_b64_tr_b16 a[170:171], v12 offset:8704
    v_mfma_f32_32x32x16_bf16 v[160:175], v[192:195], v[32:35], v[160:175]
    v_cvt_pk_bf16_f32 v24, v176, v177
    v_cvt_pk_bf16_f32 v25, v178, v179
    v_cvt_pk_bf16_f32 v26, v180, v181
    v_cvt_pk_bf16_f32 v27, v182, v183
    v_mfma_f32_32x32x16_bf16 v[160:175], v[196:199], v[36:39], v[160:175]
    v_cvt_pk_bf16_f32 v28, v184, v185
    v_cvt_pk_bf16_f32 v29, v186, v187
    v_cvt_pk_bf16_f32 v30, v188, v189
    v_cvt_pk_bf16_f32 v31, v190, v191
    s_waitcnt lgkmcnt(9)
    v_mfma_f32_32x32x16_bf16 v[128:143], a[184:187], v[24:27], v[128:143]
    ds_read_b64_tr_b16 a[172:173], v12 offset:9216
    ds_read_b64_tr_b16 a[174:175], v12 offset:9728
    ds_read_b64_tr_b16 a[176:177], v12 offset:10240
    ds_read_b64_tr_b16 a[178:179], v12 offset:10752
    s_waitcnt lgkmcnt(11)
    v_mfma_f32_32x32x16_bf16 v[144:159], v[24:27], a[188:191], v[144:159]
    ds_read_b64_tr_b16 a[180:181], v12 offset:11264
    ds_read_b64_tr_b16 a[182:183], v12 offset:11776
    s_add_u32 m0, s45, 24576
    s_nop 0
    buffer_load_dwordx4 v7, s[16:19], s48 offen lds
    s_waitcnt lgkmcnt(11)
    v_mfma_f32_32x32x16_bf16 v[128:143], a[192:195], v[28:31], v[128:143]
    s_waitcnt lgkmcnt(8)
    v_and_b32 v204, v216, v212
    v_and_b32 v205, v217, v212
    v_and_b32 v206, v218, v212
    v_and_b32 v207, v219, v212
    v_mfma_f32_32x32x16_bf16 v[144:159], v[28:31], a[196:199], v[144:159]
    v_and_b32 v208, v220, v212
    v_and_b32 v209, v221, v212
    v_and_b32 v210, v222, v212
    v_and_b32 v211, v223, v212
    v_mfma_f32_32x32x16_bf16 v[176:191], v[212:215], v[224:227], 0
    ds_read_b64 v[200:201], v14 offset:1024
    ds_read_b64_tr_b16 a[184:185], v12 offset:12288
    ds_read_b64_tr_b16 a[186:187], v12 offset:12800
    v_mfma_f32_32x32x16_bf16 v[176:191], v[204:207], v[40:43], v[176:191]
    v_cvt_pk_bf16_f32 v32, v160, v161
    v_cvt_pk_bf16_f32 v33, v162, v163
    v_cvt_pk_bf16_f32 v34, v164, v165
    v_cvt_pk_bf16_f32 v35, v166, v167
    v_mfma_f32_32x32x16_bf16 v[176:191], v[208:211], v[44:47], v[176:191]
    v_cvt_pk_bf16_f32 v36, v168, v169
    v_cvt_pk_bf16_f32 v37, v170, v171
    v_cvt_pk_bf16_f32 v38, v172, v173
    v_cvt_pk_bf16_f32 v39, v174, v175
    s_waitcnt lgkmcnt(9)
    v_mfma_f32_32x32x16_bf16 v[128:143], a[168:171], v[32:35], v[128:143]
    ds_read_b64_tr_b16 a[188:189], v12 offset:13312
    ds_read_b64_tr_b16 a[190:191], v12 offset:13824
    ds_read_b64_tr_b16 a[192:193], v12 offset:14336
    ds_read_b64_tr_b16 a[194:195], v12 offset:14848
    ds_read_b64_tr_b16 a[196:197], v12 offset:15360
    s_waitcnt lgkmcnt(12)
    v_mfma_f32_32x32x16_bf16 v[144:159], v[32:35], a[172:175], v[144:159]
    ds_read_b64_tr_b16 a[198:199], v12 offset:15872
    s_add_u32 m0, s45, 28672
    s_nop 0
    buffer_load_dwordx4 v7, s[16:19], s49 offen lds
    s_add_u32 m0, s45, 32768
    s_waitcnt lgkmcnt(11)
    v_mfma_f32_32x32x16_bf16 v[128:143], a[176:179], v[36:39], v[128:143]
    buffer_load_dwordx4 v7, s[16:19], s50 offen lds
    s_waitcnt lgkmcnt(8)
    v_and_b32 v192, v216, v200
    v_and_b32 v193, v217, v200
    v_and_b32 v194, v218, v200
    v_and_b32 v195, v219, v200
    v_mfma_f32_32x32x16_bf16 v[144:159], v[36:39], a[180:183], v[144:159]
    v_and_b32 v196, v220, v200
    v_and_b32 v197, v221, v200
    v_and_b32 v198, v222, v200
    v_and_b32 v199, v223, v200
    v_mfma_f32_32x32x16_bf16 v[160:175], v[200:203], v[224:227], 0
    ds_read_b64 v[212:213], v14 offset:1280
    ds_read_b64_tr_b16 a[168:169], v12 offset:16384
    ds_read_b64_tr_b16 a[170:171], v12 offset:16896
    v_mfma_f32_32x32x16_bf16 v[160:175], v[192:195], v[48:51], v[160:175]
    v_cvt_pk_bf16_f32 v40, v176, v177
    v_cvt_pk_bf16_f32 v41, v178, v179
    v_cvt_pk_bf16_f32 v42, v180, v181
    v_cvt_pk_bf16_f32 v43, v182, v183
    v_mfma_f32_32x32x16_bf16 v[160:175], v[196:199], v[52:55], v[160:175]
    v_cvt_pk_bf16_f32 v44, v184, v185
    v_cvt_pk_bf16_f32 v45, v186, v187
    v_cvt_pk_bf16_f32 v46, v188, v189
    v_cvt_pk_bf16_f32 v47, v190, v191
    s_waitcnt lgkmcnt(9)
    v_mfma_f32_32x32x16_bf16 v[128:143], a[184:187], v[40:43], v[128:143]
    ds_read_b64_tr_b16 a[172:173], v12 offset:17408
    ds_read_b64_tr_b16 a[174:175], v12 offset:17920
    ds_read_b64_tr_b16 a[176:177], v12 offset:18432
    ds_read_b64_tr_b16 a[178:179], v12 offset:18944
    ds_read_b64_tr_b16 a[180:181], v12 offset:19456
    s_waitcnt lgkmcnt(12)
    v_mfma_f32_32x32x16_bf16 v[144:159], v[40:43], a[188:191], v[144:159]
    ds_read_b64_tr_b16 a[182:183], v12 offset:19968
    s_add_u32 m0, s45, 36864
    s_nop 0
    buffer_load_dwordx4 v7, s[16:19], s51 offen lds
    s_add_u32 m0, s45, 40960
    s_waitcnt lgkmcnt(11)
    v_mfma_f32_32x32x16_bf16 v[128:143], a[192:195], v[44:47], v[128:143]
    buffer_load_dwordx4 v7, s[16:19], s56 offen lds
    s_waitcnt lgkmcnt(8)
    v_and_b32 v204, v216, v212
    v_and_b32 v205, v217, v212
    v_and_b32 v206, v218, v212
    v_and_b32 v207, v219, v212
    v_mfma_f32_32x32x16_bf16 v[144:159], v[44:47], a[196:199], v[144:159]
    v_and_b32 v208, v220, v212
    v_and_b32 v209, v221, v212
    v_and_b32 v210, v222, v212
    v_and_b32 v211, v223, v212
    v_mfma_f32_32x32x16_bf16 v[176:191], v[212:215], v[224:227], 0
    ds_read_b64 v[200:201], v14 offset:1536
    ds_read_b64_tr_b16 a[184:185], v12 offset:20480
    ds_read_b64_tr_b16 a[186:187], v12 offset:20992
    v_mfma_f32_32x32x16_bf16 v[176:191], v[204:207], v[56:59], v[176:191]
    v_cvt_pk_bf16_f32 v48, v160, v161
    v_cvt_pk_bf16_f32 v49, v162, v163
    v_cvt_pk_bf16_f32 v50, v164, v165
    v_cvt_pk_bf16_f32 v51, v166, v167
    v_mfma_f32_32x32x16_bf16 v[176:191], v[208:211], v[60:63], v[176:191]
    v_cvt_pk_bf16_f32 v52, v168, v169
    v_cvt_pk_bf16_f32 v53, v170, v171
    v_cvt_pk_bf16_f32 v54, v172, v173
    v_cvt_pk_bf16_f32 v55, v174, v175
    s_waitcnt lgkmcnt(9)
    v_mfma_f32_32x32x16_bf16 v[128:143], a[168:171], v[48:51], v[128:143]
    ds_read_b64_tr_b16 a[188:189], v12 offset:21504
    ds_read_b64_tr_b16 a[190:191], v12 offset:22016
    ds_read_b64_tr_b16 a[192:193], v12 offset:22528
    ds_read_b64_tr_b16 a[194:195], v12 offset:23040
    ds_read_b64_tr_b16 a[196:197], v12 offset:23552
    s_waitcnt lgkmcnt(12)
    v_mfma_f32_32x32x16_bf16 v[144:159], v[48:51], a[172:175], v[144:159]
    ds_read_b64_tr_b16 a[198:199], v12 offset:24064
    s_add_u32 m0, s45, 45056
    s_nop 0
    buffer_load_dwordx4 v7, s[16:19], s57 offen lds
    s_add_u32 m0, s45, 49152
    s_waitcnt lgkmcnt(11)
    v_mfma_f32_32x32x16_bf16 v[128:143], a[176:179], v[52:55], v[128:143]
    buffer_load_dwordx4 v7, s[16:19], s71 offen lds
    s_waitcnt lgkmcnt(8)
    v_and_b32 v192, v216, v200
    v_and_b32 v193, v217, v200
    v_and_b32 v194, v218, v200
    v_and_b32 v195, v219, v200
    v_mfma_f32_32x32x16_bf16 v[144:159], v[52:55], a[180:183], v[144:159]
    v_and_b32 v196, v220, v200
    v_and_b32 v197, v221, v200
    v_and_b32 v198, v222, v200
    v_and_b32 v199, v223, v200
    v_mfma_f32_32x32x16_bf16 v[160:175], v[200:203], v[224:227], 0
    ds_read_b64 v[212:213], v14 offset:1792
    ds_read_b64_tr_b16 a[168:169], v12 offset:24576
    ds_read_b64_tr_b16 a[170:171], v12 offset:25088
    v_mfma_f32_32x32x16_bf16 v[160:175], v[192:195], v[64:67], v[160:175]
    v_cvt_pk_bf16_f32 v56, v176, v177
    v_cvt_pk_bf16_f32 v57, v178, v179
    v_cvt_pk_bf16_f32 v58, v180, v181
    v_cvt_pk_bf16_f32 v59, v182, v183
    v_mfma_f32_32x32x16_bf16 v[160:175], v[196:199], v[68:71], v[160:175]
    v_cvt_pk_bf16_f32 v60, v184, v185
    v_cvt_pk_bf16_f32 v61, v186, v187
    v_cvt_pk_bf16_f32 v62, v188, v189
    v_cvt_pk_bf16_f32 v63, v190, v191
    s_waitcnt lgkmcnt(9)
    v_mfma_f32_32x32x16_bf16 v[128:143], a[184:187], v[56:59], v[128:143]
    ds_read_b64_tr_b16 a[172:173], v12 offset:25600
    ds_read_b64_tr_b16 a[174:175], v12 offset:26112
    ds_read_b64_tr_b16 a[176:177], v12 offset:26624
    ds_read_b64_tr_b16 a[178:179], v12 offset:27136
    s_waitcnt lgkmcnt(11)
    v_mfma_f32_32x32x16_bf16 v[144:159], v[56:59], a[188:191], v[144:159]
    ds_read_b64_tr_b16 a[180:181], v12 offset:27648
    ds_read_b64_tr_b16 a[182:183], v12 offset:28160
    s_waitcnt lgkmcnt(8)
    v_and_b32 v204, v216, v212
    v_mfma_f32_32x32x16_bf16 v[128:143], a[192:195], v[60:63], v[128:143]
    v_and_b32 v205, v217, v212
    v_and_b32 v206, v218, v212
    v_and_b32 v207, v219, v212
    v_and_b32 v208, v220, v212
    v_mfma_f32_32x32x16_bf16 v[144:159], v[60:63], a[196:199], v[144:159]
    v_and_b32 v209, v221, v212
    v_and_b32 v210, v222, v212
    v_and_b32 v211, v223, v212
    v_mfma_f32_32x32x16_bf16 v[176:191], v[212:215], v[224:227], 0
    ds_read_b64 v[200:201], v14 offset:2048
    ds_read_b64_tr_b16 a[184:185], v12 offset:28672
    ds_read_b64_tr_b16 a[186:187], v12 offset:29184
    v_mfma_f32_32x32x16_bf16 v[176:191], v[204:207], v[72:75], v[176:191]
    v_cvt_pk_bf16_f32 v64, v160, v161
    v_cvt_pk_bf16_f32 v65, v162, v163
    v_cvt_pk_bf16_f32 v66, v164, v165
    v_cvt_pk_bf16_f32 v67, v166, v167
    v_mfma_f32_32x32x16_bf16 v[176:191], v[208:211], v[76:79], v[176:191]
    v_cvt_pk_bf16_f32 v68, v168, v169
    v_cvt_pk_bf16_f32 v69, v170, v171
    v_cvt_pk_bf16_f32 v70, v172, v173
    v_cvt_pk_bf16_f32 v71, v174, v175
    s_waitcnt lgkmcnt(9)
    v_mfma_f32_32x32x16_bf16 v[128:143], a[168:171], v[64:67], v[128:143]
    ds_read_b64_tr_b16 a[188:189], v12 offset:29696
    ds_read_b64_tr_b16 a[190:191], v12 offset:30208
    ds_read_b64_tr_b16 a[192:193], v12 offset:30720
    ds_read_b64_tr_b16 a[194:195], v12 offset:31232
    s_waitcnt lgkmcnt(11)
    v_mfma_f32_32x32x16_bf16 v[144:159], v[64:67], a[172:175], v[144:159]
    ds_read_b64_tr_b16 a[196:197], v12 offset:31744
    ds_read_b64_tr_b16 a[198:199], v12 offset:32256
    s_cmp_lg_u32 s7, 1
    s_cbranch_scc0 adaLN_cond__linear_kernel_hedgehog__glu_gated_bilinear__prompt_kernel_skip_12
    s_waitcnt vmcnt(7)
adaLN_cond__linear_kernel_hedgehog__glu_gated_bilinear__prompt_kernel_skip_12:
    s_waitcnt vmcnt(11)
    s_waitcnt lgkmcnt(8)
    v_and_b32 v192, v216, v200
    v_mfma_f32_32x32x16_bf16 v[128:143], a[176:179], v[68:71], v[128:143]
    v_and_b32 v193, v217, v200
    v_and_b32 v194, v218, v200
    v_and_b32 v195, v219, v200
    v_and_b32 v196, v220, v200
    v_mfma_f32_32x32x16_bf16 v[144:159], v[68:71], a[180:183], v[144:159]
    v_and_b32 v197, v221, v200
    v_and_b32 v198, v222, v200
    v_and_b32 v199, v223, v200
    s_waitcnt lgkmcnt(0)
    s_barrier
    v_mfma_f32_32x32x16_bf16 v[160:175], v[200:203], v[224:227], 0
    ds_read_b64 v[212:213], v14 offset:2304
    ds_read_b64_tr_b16 a[168:169], v13 offset:0
    ds_read_b64_tr_b16 a[170:171], v13 offset:512
    v_mfma_f32_32x32x16_bf16 v[160:175], v[192:195], v[80:83], v[160:175]
    v_cvt_pk_bf16_f32 v72, v176, v177
    v_cvt_pk_bf16_f32 v73, v178, v179
    v_cvt_pk_bf16_f32 v74, v180, v181
    v_cvt_pk_bf16_f32 v75, v182, v183
    v_mfma_f32_32x32x16_bf16 v[160:175], v[196:199], v[84:87], v[160:175]
    v_cvt_pk_bf16_f32 v76, v184, v185
    v_cvt_pk_bf16_f32 v77, v186, v187
    v_cvt_pk_bf16_f32 v78, v188, v189
    v_cvt_pk_bf16_f32 v79, v190, v191
    v_mfma_f32_32x32x16_bf16 v[128:143], a[184:187], v[72:75], v[128:143]
    ds_read_b64_tr_b16 a[172:173], v13 offset:1024
    ds_read_b64_tr_b16 a[174:175], v13 offset:1536
    ds_read_b64_tr_b16 a[176:177], v13 offset:2048
    ds_read_b64_tr_b16 a[178:179], v13 offset:2560
    v_mfma_f32_32x32x16_bf16 v[144:159], v[72:75], a[188:191], v[144:159]
    ds_read_b64_tr_b16 a[180:181], v13 offset:3072
    ds_read_b64_tr_b16 a[182:183], v13 offset:3584
    s_cmp_eq_u32 s7, 2
    s_cbranch_scc0 adaLN_cond__linear_kernel_hedgehog__glu_gated_bilinear__prompt_kernel_skip_13
    buffer_load_dwordx4 a[64:67], v248, s[20:23], s46 offen
    s_add_u32 s46, s46, 172032
    buffer_load_dwordx4 a[68:71], v248, s[20:23], s46 offen
    s_add_u32 s46, s46, 172032
    buffer_load_dwordx4 a[72:75], v248, s[20:23], s46 offen
    s_add_u32 s46, s46, 172032
    buffer_load_dwordx4 a[76:79], v248, s[20:23], s46 offen
    s_add_u32 s46, s46, 172032
adaLN_cond__linear_kernel_hedgehog__glu_gated_bilinear__prompt_kernel_skip_13:
    s_cmp_lg_u32 s7, 2
    s_cbranch_scc0 adaLN_cond__linear_kernel_hedgehog__glu_gated_bilinear__prompt_kernel_skip_14
    s_mov_b64 exec, 0x1ffffff
    buffer_load_dword a100, v247, s[64:67], s41 offen
    buffer_load_dword a101, v247, s[12:15], s43 offen
    s_mov_b64 exec, -1
adaLN_cond__linear_kernel_hedgehog__glu_gated_bilinear__prompt_kernel_skip_14:
    v_mfma_f32_32x32x16_bf16 v[128:143], a[192:195], v[76:79], v[128:143]
    s_waitcnt lgkmcnt(8)
    v_and_b32 v204, v216, v212
    v_and_b32 v205, v217, v212
    v_and_b32 v206, v218, v212
    v_and_b32 v207, v219, v212
    v_mfma_f32_32x32x16_bf16 v[144:159], v[76:79], a[196:199], v[144:159]
    v_and_b32 v208, v220, v212
    v_and_b32 v209, v221, v212
    v_and_b32 v210, v222, v212
    v_and_b32 v211, v223, v212
    v_mfma_f32_32x32x16_bf16 v[176:191], v[212:215], v[224:227], 0
    ds_read_b64 v[200:201], v14 offset:2560
    ds_read_b64_tr_b16 a[184:185], v13 offset:4096
    ds_read_b64_tr_b16 a[186:187], v13 offset:4608
    v_mfma_f32_32x32x16_bf16 v[176:191], v[204:207], v[88:91], v[176:191]
    v_cvt_pk_bf16_f32 v80, v160, v161
    v_cvt_pk_bf16_f32 v81, v162, v163
    v_cvt_pk_bf16_f32 v82, v164, v165
    v_cvt_pk_bf16_f32 v83, v166, v167
    v_mfma_f32_32x32x16_bf16 v[176:191], v[208:211], v[92:95], v[176:191]
    v_cvt_pk_bf16_f32 v84, v168, v169
    v_cvt_pk_bf16_f32 v85, v170, v171
    v_cvt_pk_bf16_f32 v86, v172, v173
    v_cvt_pk_bf16_f32 v87, v174, v175
    s_waitcnt lgkmcnt(9)
    v_mfma_f32_32x32x16_bf16 v[128:143], a[168:171], v[80:83], v[128:143]
    ds_read_b64_tr_b16 a[188:189], v13 offset:5120
    ds_read_b64_tr_b16 a[190:191], v13 offset:5632
    ds_read_b64_tr_b16 a[192:193], v13 offset:6144
    ds_read_b64_tr_b16 a[194:195], v13 offset:6656
    s_waitcnt lgkmcnt(11)
    v_mfma_f32_32x32x16_bf16 v[144:159], v[80:83], a[172:175], v[144:159]
    ds_read_b64_tr_b16 a[196:197], v13 offset:7168
    ds_read_b64_tr_b16 a[198:199], v13 offset:7680
    s_cmp_eq_u32 s7, 2
    s_cbranch_scc0 adaLN_cond__linear_kernel_hedgehog__glu_gated_bilinear__prompt_kernel_skip_15
    buffer_load_dwordx4 a[80:83], v248, s[20:23], s46 offen
    s_add_u32 s46, s46, 172032
    buffer_load_dwordx4 a[84:87], v248, s[20:23], s46 offen
    s_add_u32 s46, s46, 172032
    buffer_load_dwordx4 a[88:91], v248, s[20:23], s46 offen
    buffer_load_ushort a92, v249, s[24:27], s47 offen offset:0
    buffer_load_ushort a93, v249, s[24:27], s47 offen offset:64
    buffer_load_ushort a94, v249, s[24:27], s47 offen offset:128
    buffer_load_ushort a95, v249, s[24:27], s47 offen offset:192
    buffer_load_ushort a96, v249, s[24:27], s47 offen offset:256
    buffer_load_ushort a97, v249, s[24:27], s47 offen offset:320
    buffer_load_ushort a98, v249, s[24:27], s47 offen offset:384
adaLN_cond__linear_kernel_hedgehog__glu_gated_bilinear__prompt_kernel_skip_15:
    s_waitcnt lgkmcnt(8)
    v_and_b32 v192, v216, v200
    v_mfma_f32_32x32x16_bf16 v[128:143], a[176:179], v[84:87], v[128:143]
    v_and_b32 v193, v217, v200
    v_and_b32 v194, v218, v200
    v_and_b32 v195, v219, v200
    v_and_b32 v196, v220, v200
    v_mfma_f32_32x32x16_bf16 v[144:159], v[84:87], a[180:183], v[144:159]
    v_and_b32 v197, v221, v200
    v_and_b32 v198, v222, v200
    v_and_b32 v199, v223, v200
    v_mfma_f32_32x32x16_bf16 v[160:175], v[200:203], v[224:227], 0
    ds_read_b64 v[212:213], v14 offset:2816
    ds_read_b64_tr_b16 a[168:169], v13 offset:8192
    ds_read_b64_tr_b16 a[170:171], v13 offset:8704
    v_mfma_f32_32x32x16_bf16 v[160:175], v[192:195], v[96:99], v[160:175]
    v_cvt_pk_bf16_f32 v88, v176, v177
    v_cvt_pk_bf16_f32 v89, v178, v179
    v_cvt_pk_bf16_f32 v90, v180, v181
    v_cvt_pk_bf16_f32 v91, v182, v183
    v_mfma_f32_32x32x16_bf16 v[160:175], v[196:199], v[100:103], v[160:175]
    v_cvt_pk_bf16_f32 v92, v184, v185
    v_cvt_pk_bf16_f32 v93, v186, v187
    v_cvt_pk_bf16_f32 v94, v188, v189
    v_cvt_pk_bf16_f32 v95, v190, v191
    s_waitcnt lgkmcnt(9)
    v_mfma_f32_32x32x16_bf16 v[128:143], a[184:187], v[88:91], v[128:143]
    ds_read_b64_tr_b16 a[172:173], v13 offset:9216
    ds_read_b64_tr_b16 a[174:175], v13 offset:9728
    ds_read_b64_tr_b16 a[176:177], v13 offset:10240
    ds_read_b64_tr_b16 a[178:179], v13 offset:10752
    s_waitcnt lgkmcnt(11)
    v_mfma_f32_32x32x16_bf16 v[144:159], v[88:91], a[188:191], v[144:159]
    ds_read_b64_tr_b16 a[180:181], v13 offset:11264
    ds_read_b64_tr_b16 a[182:183], v13 offset:11776
    s_waitcnt lgkmcnt(8)
    v_and_b32 v204, v216, v212
    v_mfma_f32_32x32x16_bf16 v[128:143], a[192:195], v[92:95], v[128:143]
    v_and_b32 v205, v217, v212
    v_and_b32 v206, v218, v212
    v_and_b32 v207, v219, v212
    v_and_b32 v208, v220, v212
    v_mfma_f32_32x32x16_bf16 v[144:159], v[92:95], a[196:199], v[144:159]
    v_and_b32 v209, v221, v212
    v_and_b32 v210, v222, v212
    v_and_b32 v211, v223, v212
    v_mfma_f32_32x32x16_bf16 v[176:191], v[212:215], v[224:227], 0
    ds_read_b64 v[200:201], v14 offset:3072
    ds_read_b64_tr_b16 a[184:185], v13 offset:12288
    ds_read_b64_tr_b16 a[186:187], v13 offset:12800
    v_mfma_f32_32x32x16_bf16 v[176:191], v[204:207], v[104:107], v[176:191]
    v_cvt_pk_bf16_f32 v96, v160, v161
    v_cvt_pk_bf16_f32 v97, v162, v163
    v_cvt_pk_bf16_f32 v98, v164, v165
    v_cvt_pk_bf16_f32 v99, v166, v167
    v_mfma_f32_32x32x16_bf16 v[176:191], v[208:211], v[108:111], v[176:191]
    v_cvt_pk_bf16_f32 v100, v168, v169
    v_cvt_pk_bf16_f32 v101, v170, v171
    v_cvt_pk_bf16_f32 v102, v172, v173
    v_cvt_pk_bf16_f32 v103, v174, v175
    s_waitcnt lgkmcnt(9)
    v_mfma_f32_32x32x16_bf16 v[128:143], a[168:171], v[96:99], v[128:143]
    ds_read_b64_tr_b16 a[188:189], v13 offset:13312
    ds_read_b64_tr_b16 a[190:191], v13 offset:13824
    ds_read_b64_tr_b16 a[192:193], v13 offset:14336
    ds_read_b64_tr_b16 a[194:195], v13 offset:14848
    s_waitcnt lgkmcnt(11)
    v_mfma_f32_32x32x16_bf16 v[144:159], v[96:99], a[172:175], v[144:159]
    ds_read_b64_tr_b16 a[196:197], v13 offset:15360
    ds_read_b64_tr_b16 a[198:199], v13 offset:15872
    s_waitcnt lgkmcnt(8)
    v_and_b32 v192, v216, v200
    v_mfma_f32_32x32x16_bf16 v[128:143], a[176:179], v[100:103], v[128:143]
    v_and_b32 v193, v217, v200
    v_and_b32 v194, v218, v200
    v_and_b32 v195, v219, v200
    v_and_b32 v196, v220, v200
    v_mfma_f32_32x32x16_bf16 v[144:159], v[100:103], a[180:183], v[144:159]
    v_and_b32 v197, v221, v200
    v_and_b32 v198, v222, v200
    v_and_b32 v199, v223, v200
    v_mfma_f32_32x32x16_bf16 v[160:175], v[200:203], v[224:227], 0
    ds_read_b64 v[212:213], v14 offset:3328
    ds_read_b64_tr_b16 a[168:169], v13 offset:16384
    ds_read_b64_tr_b16 a[170:171], v13 offset:16896
    v_mfma_f32_32x32x16_bf16 v[160:175], v[192:195], v[112:115], v[160:175]
    v_cvt_pk_bf16_f32 v104, v176, v177
    v_cvt_pk_bf16_f32 v105, v178, v179
    v_cvt_pk_bf16_f32 v106, v180, v181
    v_cvt_pk_bf16_f32 v107, v182, v183
    v_mfma_f32_32x32x16_bf16 v[160:175], v[196:199], v[116:119], v[160:175]
    v_cvt_pk_bf16_f32 v108, v184, v185
    v_cvt_pk_bf16_f32 v109, v186, v187
    v_cvt_pk_bf16_f32 v110, v188, v189
    v_cvt_pk_bf16_f32 v111, v190, v191
    s_waitcnt lgkmcnt(9)
    v_mfma_f32_32x32x16_bf16 v[128:143], a[184:187], v[104:107], v[128:143]
    ds_read_b64_tr_b16 a[172:173], v13 offset:17408
    ds_read_b64_tr_b16 a[174:175], v13 offset:17920
    ds_read_b64_tr_b16 a[176:177], v13 offset:18432
    ds_read_b64_tr_b16 a[178:179], v13 offset:18944
    s_waitcnt lgkmcnt(11)
    v_mfma_f32_32x32x16_bf16 v[144:159], v[104:107], a[188:191], v[144:159]
    ds_read_b64_tr_b16 a[180:181], v13 offset:19456
    ds_read_b64_tr_b16 a[182:183], v13 offset:19968
    s_cmp_eq_u32 s7, 1
    s_cbranch_scc0 adaLN_cond__linear_kernel_hedgehog__glu_gated_bilinear__prompt_kernel_skip_16
    s_waitcnt vmcnt(7)
    ds_read_b64_tr_b16 a[104:105], v251 offset:0
    ds_read_b64_tr_b16 a[106:107], v251 offset:1024
    ds_read_b64_tr_b16 a[108:109], v251 offset:64
    ds_read_b64_tr_b16 a[110:111], v251 offset:1088
    ds_read_b64_tr_b16 a[112:113], v251 offset:2048
    ds_read_b64_tr_b16 a[114:115], v251 offset:3072
    ds_read_b64_tr_b16 a[116:117], v251 offset:2112
    ds_read_b64_tr_b16 a[118:119], v251 offset:3136
    s_waitcnt lgkmcnt(6)
    buffer_store_dwordx4 a[104:107], v1, s[8:11], s42 offen offset:0 sc1
    s_waitcnt lgkmcnt(4)
    buffer_store_dwordx4 a[108:111], v1, s[8:11], s42 offen offset:1024 sc1
    s_waitcnt lgkmcnt(2)
    buffer_store_dwordx4 a[112:115], v1, s[8:11], s42 offen offset:2048 sc1
    s_waitcnt lgkmcnt(0)
    buffer_store_dwordx4 a[116:119], v1, s[8:11], s42 offen offset:3072 sc1
adaLN_cond__linear_kernel_hedgehog__glu_gated_bilinear__prompt_kernel_skip_16:
    s_waitcnt lgkmcnt(8)
    v_and_b32 v204, v216, v212
    v_mfma_f32_32x32x16_bf16 v[128:143], a[192:195], v[108:111], v[128:143]
    v_and_b32 v205, v217, v212
    v_and_b32 v206, v218, v212
    v_and_b32 v207, v219, v212
    v_and_b32 v208, v220, v212
    v_mfma_f32_32x32x16_bf16 v[144:159], v[108:111], a[196:199], v[144:159]
    v_and_b32 v209, v221, v212
    v_and_b32 v210, v222, v212
    v_and_b32 v211, v223, v212
    v_mfma_f32_32x32x16_bf16 v[176:191], v[212:215], v[224:227], 0
    ds_read_b64_tr_b16 a[184:185], v13 offset:20480
    ds_read_b64_tr_b16 a[186:187], v13 offset:20992
    ds_read_b64_tr_b16 a[188:189], v13 offset:21504
    v_mfma_f32_32x32x16_bf16 v[176:191], v[204:207], v[120:123], v[176:191]
    v_cvt_pk_bf16_f32 v112, v160, v161
    v_cvt_pk_bf16_f32 v113, v162, v163
    v_cvt_pk_bf16_f32 v114, v164, v165
    v_cvt_pk_bf16_f32 v115, v166, v167
    v_mfma_f32_32x32x16_bf16 v[176:191], v[208:211], v[124:127], v[176:191]
    v_cvt_pk_bf16_f32 v116, v168, v169
    v_cvt_pk_bf16_f32 v117, v170, v171
    v_cvt_pk_bf16_f32 v118, v172, v173
    v_cvt_pk_bf16_f32 v119, v174, v175
    s_waitcnt lgkmcnt(9)
    v_mfma_f32_32x32x16_bf16 v[128:143], a[168:171], v[112:115], v[128:143]
    ds_read_b64_tr_b16 a[190:191], v13 offset:22016
    ds_read_b64_tr_b16 a[192:193], v13 offset:22528
    s_waitcnt lgkmcnt(9)
    v_mfma_f32_32x32x16_bf16 v[144:159], v[112:115], a[172:175], v[144:159]
    ds_read_b64_tr_b16 a[194:195], v13 offset:23040
    s_waitcnt lgkmcnt(8)
    v_mfma_f32_32x32x16_bf16 v[128:143], a[176:179], v[116:119], v[128:143]
    ds_read_b64_tr_b16 a[196:197], v13 offset:23552
    s_waitcnt lgkmcnt(7)
    v_mfma_f32_32x32x16_bf16 v[144:159], v[116:119], a[180:183], v[144:159]
    ds_read_b64_tr_b16 a[198:199], v13 offset:24064
    v_cvt_pk_bf16_f32 v120, v176, v177
    v_cvt_pk_bf16_f32 v121, v178, v179
    v_cvt_pk_bf16_f32 v122, v180, v181
    v_cvt_pk_bf16_f32 v123, v182, v183
    v_cvt_pk_bf16_f32 v124, v184, v185
    v_cvt_pk_bf16_f32 v125, v186, v187
    v_cvt_pk_bf16_f32 v126, v188, v189
    v_cvt_pk_bf16_f32 v127, v190, v191
    s_waitcnt lgkmcnt(6)
    v_mfma_f32_32x32x16_bf16 v[128:143], a[184:187], v[120:123], v[128:143]
    s_waitcnt lgkmcnt(4)
    v_mfma_f32_32x32x16_bf16 v[144:159], v[120:123], a[188:191], v[144:159]
    s_waitcnt lgkmcnt(2)
    v_mfma_f32_32x32x16_bf16 v[128:143], a[192:195], v[124:127], v[128:143]
    s_waitcnt lgkmcnt(0)
    v_mfma_f32_32x32x16_bf16 v[144:159], v[124:127], a[196:199], v[144:159]
    s_lshl_b32 s33, s3, 7
    s_add_u32 s33, s33, 158720
    v_lshl_add_u32 v4, v2, 2, s33
    v_lshl_add_u32 v5, v3, 4, s33
    ds_write_b32 v4, v8
    s_waitcnt lgkmcnt(0)
    ds_read_b128 v[232:235], v5 offset:0
    ds_read_b128 v[236:239], v5 offset:32
    ds_read_b128 v[240:243], v5 offset:64
    ds_read_b128 v[244:247], v5 offset:96
    v_pk_mul_f32 v[128:129], v[128:129], v[8:9] op_sel_hi:[1,0]
    v_pk_mul_f32 v[130:131], v[130:131], v[8:9] op_sel_hi:[1,0]
    v_pk_mul_f32 v[132:133], v[132:133], v[8:9] op_sel_hi:[1,0]
    v_pk_mul_f32 v[134:135], v[134:135], v[8:9] op_sel_hi:[1,0]
    v_pk_mul_f32 v[136:137], v[136:137], v[8:9] op_sel_hi:[1,0]
    v_pk_mul_f32 v[138:139], v[138:139], v[8:9] op_sel_hi:[1,0]
    v_pk_mul_f32 v[140:141], v[140:141], v[8:9] op_sel_hi:[1,0]
    v_pk_mul_f32 v[142:143], v[142:143], v[8:9] op_sel_hi:[1,0]
    s_mov_b32 s40, 0x3fb8aa3b
    v_cmp_eq_u32 s[46:47], 1, v3
    v_cvt_pk_bf16_f32 v160, v128, v129
    v_cvt_pk_bf16_f32 v161, v130, v131
    v_cvt_pk_bf16_f32 v162, v132, v133
    v_cvt_pk_bf16_f32 v163, v134, v135
    v_cvt_pk_bf16_f32 v164, v136, v137
    v_cvt_pk_bf16_f32 v165, v138, v139
    v_cvt_pk_bf16_f32 v166, v140, v141
    v_cvt_pk_bf16_f32 v167, v142, v143
    v_cndmask_b32 v166, v166, 0, s[46:47]
    v_cndmask_b32 v167, v167, 0, s[46:47]
    v_mfma_f32_32x32x16_bf16 v[176:191], a[16:19], v[160:163], 0
    s_nop 0
    v_mfma_f32_32x32x16_bf16 v[176:191], a[20:23], v[164:167], v[176:191]
    s_waitcnt lgkmcnt(3)
    v_mul_f32 v144, v144, v232
    v_mul_f32 v145, v145, v233
    v_mul_f32 v146, v146, v234
    v_mul_f32 v147, v147, v235
    s_waitcnt lgkmcnt(2)
    v_mul_f32 v148, v148, v236
    v_mul_f32 v149, v149, v237
    v_mul_f32 v150, v150, v238
    v_mul_f32 v151, v151, v239
    s_waitcnt lgkmcnt(1)
    v_mul_f32 v152, v152, v240
    v_mul_f32 v153, v153, v241
    v_mul_f32 v154, v154, v242
    v_mul_f32 v155, v155, v243
    s_waitcnt lgkmcnt(0)
    v_mul_f32 v156, v156, v244
    v_mul_f32 v157, v157, v245
    v_mul_f32 v158, v158, v246
    v_mul_f32 v159, v159, v247
    v_cvt_pk_bf16_f32 v168, v144, v145
    v_cvt_pk_bf16_f32 v169, v146, v147
    v_cvt_pk_bf16_f32 v170, v148, v149
    v_cvt_pk_bf16_f32 v171, v150, v151
    v_cvt_pk_bf16_f32 v172, v152, v153
    v_cvt_pk_bf16_f32 v173, v154, v155
    v_cvt_pk_bf16_f32 v174, v156, v157
    v_cvt_pk_bf16_f32 v175, v158, v159
    v_and_or_b32 v168, v168, v252, v253
    v_and_or_b32 v169, v169, v252, v253
    v_and_or_b32 v170, v170, v252, v253
    v_and_or_b32 v171, v171, v252, v253
    v_and_or_b32 v172, v172, v252, v253
    v_and_or_b32 v173, v173, v252, v253
    v_and_or_b32 v174, v174, v252, v253
    v_and_or_b32 v175, v175, v252, v253
    v_max3_f32 v192, v176, v177, v178
    v_max3_f32 v194, v188, v189, v190
    v_max3_f32 v192, v192, v179, v180
    v_max3_f32 v192, v192, v181, v182
    v_max3_f32 v192, v192, v183, v184
    v_max3_f32 v192, v192, v185, v186
    v_max_f32 v194, v194, v191
    v_max_f32 v192, v192, v187
    v_cndmask_b32 v194, v194, v192, s[46:47]
    v_max_f32 v192, v192, v194
    v_min3_f32 v193, v176, v177, v178
    v_min3_f32 v195, v188, v189, v190
    v_min3_f32 v193, v193, v179, v180
    v_min3_f32 v193, v193, v181, v182
    v_min3_f32 v193, v193, v183, v184
    v_min3_f32 v193, v193, v185, v186
    v_min_f32 v195, v195, v191
    v_min_f32 v193, v193, v187
    v_cndmask_b32 v195, v195, v193, s[46:47]
    v_min_f32 v193, v193, v195
    v_mov_b32 v194, v192
    v_mov_b32 v195, v193
    s_nop 0
    v_permlane32_swap_b32 v192, v194
    v_permlane32_swap_b32 v193, v195
    v_max_f32 v192, v192, v194
    v_min_f32 v193, v193, v195
    v_mul_f32 v192, 0xbfb8aa3b, v192
    v_mul_f32 v193, 0x3fb8aa3b, v193
    v_mov_b32 v194, 0xff800000
    v_cndmask_b32 v196, v192, v194, s[46:47]
    v_cndmask_b32 v197, v193, v194, s[46:47]
    v_fma_f32 v200, v176, s40, v192
    v_fma_f32 v216, -v176, s40, v193
    v_fma_f32 v201, v177, s40, v192
    v_fma_f32 v217, -v177, s40, v193
    v_fma_f32 v202, v178, s40, v192
    v_fma_f32 v218, -v178, s40, v193
    v_fma_f32 v203, v179, s40, v192
    v_fma_f32 v219, -v179, s40, v193
    v_fma_f32 v204, v180, s40, v192
    v_fma_f32 v220, -v180, s40, v193
    v_fma_f32 v205, v181, s40, v192
    v_fma_f32 v221, -v181, s40, v193
    v_fma_f32 v206, v182, s40, v192
    v_fma_f32 v222, -v182, s40, v193
    v_fma_f32 v207, v183, s40, v192
    v_fma_f32 v223, -v183, s40, v193
    v_fma_f32 v208, v184, s40, v192
    v_fma_f32 v224, -v184, s40, v193
    v_fma_f32 v209, v185, s40, v192
    v_fma_f32 v225, -v185, s40, v193
    v_fma_f32 v210, v186, s40, v192
    v_fma_f32 v226, -v186, s40, v193
    v_fma_f32 v211, v187, s40, v192
    v_fma_f32 v227, -v187, s40, v193
    v_fma_f32 v212, v188, s40, v196
    v_fma_f32 v228, -v188, s40, v197
    v_fma_f32 v213, v189, s40, v196
    v_fma_f32 v229, -v189, s40, v197
    v_fma_f32 v214, v190, s40, v196
    v_fma_f32 v230, -v190, s40, v197
    v_fma_f32 v215, v191, s40, v196
    v_fma_f32 v231, -v191, s40, v197
    v_exp_f32 v200, v200
    v_exp_f32 v201, v201
    v_exp_f32 v202, v202
    v_exp_f32 v203, v203
    v_exp_f32 v204, v204
    v_exp_f32 v205, v205
    v_exp_f32 v206, v206
    v_exp_f32 v207, v207
    v_exp_f32 v208, v208
    v_exp_f32 v209, v209
    v_exp_f32 v210, v210
    v_exp_f32 v211, v211
    v_exp_f32 v212, v212
    v_exp_f32 v213, v213
    v_exp_f32 v214, v214
    v_exp_f32 v215, v215
    v_exp_f32 v216, v216
    v_exp_f32 v217, v217
    v_exp_f32 v218, v218
    v_exp_f32 v219, v219
    v_exp_f32 v220, v220
    v_exp_f32 v221, v221
    v_exp_f32 v222, v222
    v_exp_f32 v223, v223
    v_exp_f32 v224, v224
    v_exp_f32 v225, v225
    v_exp_f32 v226, v226
    v_exp_f32 v227, v227
    v_exp_f32 v228, v228
    v_exp_f32 v229, v229
    v_exp_f32 v230, v230
    v_exp_f32 v231, v231
    v_pk_add_f32 v[192:193], v[200:201], v[202:203]
    v_pk_add_f32 v[194:195], v[216:217], v[218:219]
    v_pk_add_f32 v[192:193], v[192:193], v[204:205]
    v_pk_add_f32 v[194:195], v[194:195], v[220:221]
    v_pk_add_f32 v[192:193], v[192:193], v[206:207]
    v_pk_add_f32 v[194:195], v[194:195], v[222:223]
    v_pk_add_f32 v[192:193], v[192:193], v[208:209]
    v_pk_add_f32 v[194:195], v[194:195], v[224:225]
    v_pk_add_f32 v[192:193], v[192:193], v[210:211]
    v_pk_add_f32 v[194:195], v[194:195], v[226:227]
    v_pk_add_f32 v[192:193], v[192:193], v[212:213]
    v_pk_add_f32 v[194:195], v[194:195], v[228:229]
    v_pk_add_f32 v[192:193], v[192:193], v[214:215]
    v_pk_add_f32 v[194:195], v[194:195], v[230:231]
    v_add_f32 v192, v192, v193
    v_add_f32 v194, v194, v195
    v_mov_b32 v193, v192
    v_mov_b32 v195, v194
    s_nop 0
    v_permlane32_swap_b32 v192, v193
    v_permlane32_swap_b32 v194, v195
    v_add_f32 v192, v192, v193
    v_add_f32 v194, v194, v195
    v_rcp_f32 v192, v192
    v_rcp_f32 v194, v194
    v_pk_mul_f32 v[200:201], v[200:201], v[192:193] op_sel_hi:[1,0]
    v_pk_mul_f32 v[216:217], v[216:217], v[194:195] op_sel_hi:[1,0]
    v_cvt_pk_bf16_f32 v128, v200, v201
    v_cvt_pk_bf16_f32 v136, v216, v217
    v_pk_mul_f32 v[202:203], v[202:203], v[192:193] op_sel_hi:[1,0]
    v_pk_mul_f32 v[218:219], v[218:219], v[194:195] op_sel_hi:[1,0]
    v_cvt_pk_bf16_f32 v129, v202, v203
    v_cvt_pk_bf16_f32 v137, v218, v219
    v_pk_mul_f32 v[204:205], v[204:205], v[192:193] op_sel_hi:[1,0]
    v_pk_mul_f32 v[220:221], v[220:221], v[194:195] op_sel_hi:[1,0]
    v_cvt_pk_bf16_f32 v130, v204, v205
    v_cvt_pk_bf16_f32 v138, v220, v221
    v_pk_mul_f32 v[206:207], v[206:207], v[192:193] op_sel_hi:[1,0]
    v_pk_mul_f32 v[222:223], v[222:223], v[194:195] op_sel_hi:[1,0]
    v_cvt_pk_bf16_f32 v131, v206, v207
    v_cvt_pk_bf16_f32 v139, v222, v223
    v_pk_mul_f32 v[208:209], v[208:209], v[192:193] op_sel_hi:[1,0]
    v_pk_mul_f32 v[224:225], v[224:225], v[194:195] op_sel_hi:[1,0]
    v_cvt_pk_bf16_f32 v132, v208, v209
    v_cvt_pk_bf16_f32 v140, v224, v225
    v_pk_mul_f32 v[210:211], v[210:211], v[192:193] op_sel_hi:[1,0]
    v_pk_mul_f32 v[226:227], v[226:227], v[194:195] op_sel_hi:[1,0]
    v_cvt_pk_bf16_f32 v133, v210, v211
    v_cvt_pk_bf16_f32 v141, v226, v227
    v_pk_mul_f32 v[212:213], v[212:213], v[192:193] op_sel_hi:[1,0]
    v_pk_mul_f32 v[228:229], v[228:229], v[194:195] op_sel_hi:[1,0]
    v_cvt_pk_bf16_f32 v134, v212, v213
    v_cvt_pk_bf16_f32 v142, v228, v229
    v_pk_mul_f32 v[214:215], v[214:215], v[192:193] op_sel_hi:[1,0]
    v_pk_mul_f32 v[230:231], v[230:231], v[194:195] op_sel_hi:[1,0]
    v_cvt_pk_bf16_f32 v135, v214, v215
    v_cvt_pk_bf16_f32 v143, v230, v231
    v_mfma_f32_32x32x16_bf16 v[176:191], v[128:131], a[24:27], 0
    v_mfma_f32_32x32x16_bf16 v[144:159], v[136:139], a[24:27], 0
    v_mfma_f32_32x32x16_bf16 v[176:191], v[132:135], a[28:31], v[176:191]
    v_mfma_f32_32x32x16_bf16 v[144:159], v[140:143], a[28:31], v[144:159]
    s_lshl_b32 s35, s3, 13
    s_add_u32 s35, s35, 53248
    v_lshl_add_u32 v6, v1, 1, s35
    v_lshl_add_u32 v5, v1, 1, s44
    v_add_u32 v5, 53248, v5
    s_lshl_b32 s41, s30, 4
    s_add_u32 s41, s41, s29
    s_lshl_b32 s41, s41, 12
    s_add_u32 s41, s41, s45
    s_add_u32 s41, s41, 0x620000
    s_nop 0
    v_cvt_pk_bf16_f32 v128, v176, v177
    v_cvt_pk_bf16_f32 v129, v178, v179
    v_cvt_pk_bf16_f32 v130, v180, v181
    v_cvt_pk_bf16_f32 v131, v182, v183
    v_cvt_pk_bf16_f32 v132, v184, v185
    v_cvt_pk_bf16_f32 v133, v186, v187
    v_cvt_pk_bf16_f32 v134, v188, v189
    v_cvt_pk_bf16_f32 v135, v190, v191
    v_cvt_pk_bf16_f32 v136, v144, v145
    v_cvt_pk_bf16_f32 v137, v146, v147
    v_cvt_pk_bf16_f32 v138, v148, v149
    v_cvt_pk_bf16_f32 v139, v150, v151
    v_cvt_pk_bf16_f32 v140, v152, v153
    v_cvt_pk_bf16_f32 v141, v154, v155
    v_cvt_pk_bf16_f32 v142, v156, v157
    v_cvt_pk_bf16_f32 v143, v158, v159
    v_mfma_f32_32x32x16_bf16 v[192:207], v[128:131], v[168:171], 0
    v_mfma_f32_32x32x16_bf16 v[208:223], v[136:139], v[168:171], 0
    v_mfma_f32_32x32x16_bf16 v[192:207], v[132:135], v[172:175], v[192:207]
    v_mfma_f32_32x32x16_bf16 v[208:223], v[140:143], v[172:175], v[208:223]
    s_nop 10
    ds_write_b128 v6, v[192:195] offset:0
    ds_write_b128 v6, v[196:199] offset:16
    ds_write_b128 v6, v[200:203] offset:2048
    ds_write_b128 v6, v[204:207] offset:2064
    ds_write_b128 v6, v[208:211] offset:4096
    ds_write_b128 v6, v[212:215] offset:4112
    ds_write_b128 v6, v[216:219] offset:6144
    ds_write_b128 v6, v[220:223] offset:6160
    s_waitcnt vmcnt(0) lgkmcnt(0)
    s_barrier
    ds_read_b128 v[128:131], v5 offset:0
    ds_read_b128 v[132:135], v5 offset:16
    ds_read_b128 v[136:139], v5 offset:8192
    ds_read_b128 v[140:143], v5 offset:8208
    ds_read_b128 v[144:147], v5 offset:16384
    ds_read_b128 v[148:151], v5 offset:16400
    ds_read_b128 v[152:155], v5 offset:24576
    ds_read_b128 v[156:159], v5 offset:24592
    ds_read_b64_tr_b16 a[0:1], v13 offset:24576
    ds_read_b64_tr_b16 a[2:3], v13 offset:25088
    ds_read_b64_tr_b16 a[4:5], v13 offset:25600
    ds_read_b64_tr_b16 a[6:7], v13 offset:26112
    s_cmp_eq_u32 s3, 0
    s_cbranch_scc0 adaLN_cond__linear_kernel_hedgehog__glu_gated_bilinear__prompt_kernel_skip_17
    v_lshlrev_b32 v4, 8, v1
    v_mov_b32 v5, s28
    s_lshl_b32 s33, s2, 4
    s_add_u32 s33, s33, 0x10000
    s_mov_b64 exec, 0xff
    buffer_store_dword v5, v4, s[8:11], s33 offen sc1
    s_mov_b64 exec, -1
adaLN_cond__linear_kernel_hedgehog__glu_gated_bilinear__prompt_kernel_skip_17:
    s_waitcnt lgkmcnt(9)
    v_pk_add_f32 v[128:129], v[128:129], v[136:137]
    v_pk_add_f32 v[130:131], v[130:131], v[138:139]
    s_waitcnt lgkmcnt(8)
    v_pk_add_f32 v[132:133], v[132:133], v[140:141]
    v_pk_add_f32 v[134:135], v[134:135], v[142:143]
    s_waitcnt lgkmcnt(5)
    v_pk_add_f32 v[144:145], v[144:145], v[152:153]
    v_pk_add_f32 v[146:147], v[146:147], v[154:155]
    s_waitcnt lgkmcnt(4)
    v_pk_add_f32 v[148:149], v[148:149], v[156:157]
    v_pk_add_f32 v[150:151], v[150:151], v[158:159]
    v_pk_add_f32 v[128:129], v[128:129], v[144:145]
    v_pk_add_f32 v[130:131], v[130:131], v[146:147]
    v_pk_add_f32 v[132:133], v[132:133], v[148:149]
    v_pk_add_f32 v[134:135], v[134:135], v[150:151]
    v_cvt_pk_bf16_f32 v136, v128, v129
    v_cvt_pk_bf16_f32 v137, v130, v131
    v_cvt_pk_bf16_f32 v138, v132, v133
    v_cvt_pk_bf16_f32 v139, v134, v135
    buffer_store_dwordx4 v[136:139], v1, s[8:11], s41 offen sc1
    s_cmp_lt_u32 s74, 4
    s_cbranch_scc0 adaLN_cond__linear_kernel_hedgehog__glu_gated_bilinear__prompt_kernel_skip_18
    v_mul_u32_u24 v4, 896, v2
    v_lshl_add_u32 v4, v3, 3, v4
    s_mul_i32 s36, s72, 28672
    s_lshl_b32 s39, s73, 6
    s_add_u32 s36, s36, s39
    s_mov_b32 s24, s6
    s_mov_b32 s25, s70
    s_mov_b32 s26, 0x1c0000
    s_mov_b32 s27, 0x20000
    buffer_load_dwordx2 v[232:233], v4, s[24:27], s36 offen offset:0
    buffer_load_dwordx2 v[234:235], v4, s[24:27], s36 offen offset:16
    buffer_load_dwordx2 v[236:237], v4, s[24:27], s36 offen offset:32
    buffer_load_dwordx2 v[238:239], v4, s[24:27], s36 offen offset:48
adaLN_cond__linear_kernel_hedgehog__glu_gated_bilinear__prompt_kernel_skip_18:
    v_mov_b32 v14, v8
    v_lshrrev_b32 v4, 8, v1
    v_lshlrev_b32 v5, 6, v4
    v_and_b32 v6, 0xf0, v1
    v_xor_b32 v5, v5, v6
    v_mul_u32_u24 v4, 896, v4
    v_add_u32 v8, v4, v5
    v_add_u32 v9, 2560, v8
    v_add_u32 v10, 5120, v8
    v_add_u32 v11, 7680, v8
    s_lshl_b32 s20, s78, 8
    s_min_u32 s20, s20, 640
    s_mul_i32 s21, s3, 57344
    s_add_u32 s21, s21, s20
    s_lshl_b32 s22, s3, 14
    s_mul_i32 s23, s3, 43008
    s_add_u32 s20, s20, s23
    s_mul_i32 s23, s3, 12288
    s_lshl_b32 s48, s30, 2
    s_add_u32 s48, s48, s3
    s_lshl_b32 s48, s48, 8
    s_add_u32 s48, s48, 0x18000
    s_lshl_b32 s38, s29, 4
    s_add_u32 s38, s38, s48
    s_waitcnt lgkmcnt(2)
    v_mfma_f32_32x32x16_bf16 v[160:175], a[0:3], v[16:19], 0
    ds_read_b64_tr_b16 a[8:9], v13 offset:26624
    ds_read_b64_tr_b16 a[10:11], v13 offset:27136
    s_waitcnt lgkmcnt(2)
    v_mfma_f32_32x32x16_bf16 v[160:175], a[4:7], v[20:23], v[160:175]
    ds_read_b64_tr_b16 a[0:1], v13 offset:27648
    ds_read_b64_tr_b16 a[2:3], v13 offset:28160
    s_waitcnt lgkmcnt(2)
    v_mfma_f32_32x32x16_bf16 v[160:175], a[8:11], v[24:27], v[160:175]
    ds_read_b64_tr_b16 a[4:5], v13 offset:28672
    ds_read_b64_tr_b16 a[6:7], v13 offset:29184
    s_add_u32 m0, s22, 86016
    s_add_u32 s33, s21, 175616
    buffer_load_dwordx4 v8, s[64:67], s33 offen offset:0 lds
    s_waitcnt lgkmcnt(2)
    v_mfma_f32_32x32x16_bf16 v[160:175], a[0:3], v[28:31], v[160:175]
    ds_read_b64_tr_b16 a[8:9], v13 offset:29696
    ds_read_b64_tr_b16 a[10:11], v13 offset:30208
    buffer_load_dwordx4 v9, s[64:67], s33 offen offset:1024 lds
    s_waitcnt lgkmcnt(2)
    v_mfma_f32_32x32x16_bf16 v[160:175], a[4:7], v[32:35], v[160:175]
    ds_read_b64_tr_b16 a[0:1], v13 offset:30720
    ds_read_b64_tr_b16 a[2:3], v13 offset:31232
    s_waitcnt lgkmcnt(2)
    v_mfma_f32_32x32x16_bf16 v[160:175], a[8:11], v[36:39], v[160:175]
    ds_read_b64_tr_b16 a[4:5], v13 offset:31744
    ds_read_b64_tr_b16 a[6:7], v13 offset:32256
    buffer_load_dwordx4 v10, s[64:67], s33 offen offset:2048 lds
    s_waitcnt lgkmcnt(2)
    v_mfma_f32_32x32x16_bf16 v[160:175], a[0:3], v[40:43], v[160:175]
    ds_read_b64_tr_b16 a[8:9], v13 offset:32768
    ds_read_b64_tr_b16 a[10:11], v13 offset:33280
    buffer_load_dwordx4 v11, s[64:67], s33 offen offset:3072 lds
    s_waitcnt lgkmcnt(2)
    v_mfma_f32_32x32x16_bf16 v[160:175], a[4:7], v[44:47], v[160:175]
    ds_read_b64_tr_b16 a[0:1], v13 offset:33792
    ds_read_b64_tr_b16 a[2:3], v13 offset:34304
    s_waitcnt lgkmcnt(2)
    v_mfma_f32_32x32x16_bf16 v[160:175], a[8:11], v[48:51], v[160:175]
    ds_read_b64_tr_b16 a[4:5], v13 offset:34816
    ds_read_b64_tr_b16 a[6:7], v13 offset:35328
    s_add_u32 m0, s22, 90112
    s_add_u32 s33, s21, 189952
    buffer_load_dwordx4 v8, s[64:67], s33 offen offset:0 lds
    s_waitcnt lgkmcnt(2)
    v_mfma_f32_32x32x16_bf16 v[160:175], a[0:3], v[52:55], v[160:175]
    ds_read_b64_tr_b16 a[8:9], v13 offset:35840
    ds_read_b64_tr_b16 a[10:11], v13 offset:36352
    buffer_load_dwordx4 v9, s[64:67], s33 offen offset:1024 lds
    s_waitcnt lgkmcnt(2)
    v_mfma_f32_32x32x16_bf16 v[160:175], a[4:7], v[56:59], v[160:175]
    ds_read_b64_tr_b16 a[0:1], v13 offset:36864
    ds_read_b64_tr_b16 a[2:3], v13 offset:37376
    s_waitcnt lgkmcnt(2)
    v_mfma_f32_32x32x16_bf16 v[160:175], a[8:11], v[60:63], v[160:175]
    ds_read_b64_tr_b16 a[4:5], v13 offset:37888
    ds_read_b64_tr_b16 a[6:7], v13 offset:38400
    buffer_load_dwordx4 v10, s[64:67], s33 offen offset:2048 lds
    s_waitcnt lgkmcnt(2)
    v_mfma_f32_32x32x16_bf16 v[160:175], a[0:3], v[64:67], v[160:175]
    ds_read_b64_tr_b16 a[8:9], v13 offset:38912
    ds_read_b64_tr_b16 a[10:11], v13 offset:39424
    buffer_load_dwordx4 v11, s[64:67], s33 offen offset:3072 lds
    s_waitcnt lgkmcnt(2)
    v_mfma_f32_32x32x16_bf16 v[160:175], a[4:7], v[68:71], v[160:175]
    ds_read_b64_tr_b16 a[0:1], v13 offset:39936
    ds_read_b64_tr_b16 a[2:3], v13 offset:40448
    s_waitcnt lgkmcnt(2)
    v_mfma_f32_32x32x16_bf16 v[160:175], a[8:11], v[72:75], v[160:175]
    ds_read_b64_tr_b16 a[4:5], v13 offset:40960
    ds_read_b64_tr_b16 a[6:7], v13 offset:41472
    s_cmp_lt_u32 s74, 4
    s_cbranch_scc0 adaLN_cond__linear_kernel_hedgehog__glu_gated_bilinear__prompt_kernel_skip_19
    s_waitcnt vmcnt(12)
adaLN_cond__linear_kernel_hedgehog__glu_gated_bilinear__prompt_kernel_skip_19:
    s_cmp_ge_u32 s74, 4
    s_cbranch_scc0 adaLN_cond__linear_kernel_hedgehog__glu_gated_bilinear__prompt_kernel_skip_20
    s_waitcnt vmcnt(8)
adaLN_cond__linear_kernel_hedgehog__glu_gated_bilinear__prompt_kernel_skip_20:
    v_mov_b32 v4, s28
    v_mov_b32 v5, 0
    s_mov_b64 exec, 1
    buffer_store_dword v4, v5, s[8:11], s38 offen sc1
    s_mov_b64 exec, -1
    s_add_u32 m0, s22, 94208
    s_add_u32 s33, s21, 204288
    buffer_load_dwordx4 v8, s[64:67], s33 offen offset:0 lds
    s_waitcnt lgkmcnt(2)
    v_mfma_f32_32x32x16_bf16 v[160:175], a[0:3], v[76:79], v[160:175]
    ds_read_b64_tr_b16 a[8:9], v13 offset:41984
    ds_read_b64_tr_b16 a[10:11], v13 offset:42496
    buffer_load_dwordx4 v9, s[64:67], s33 offen offset:1024 lds
    s_waitcnt lgkmcnt(2)
    v_mfma_f32_32x32x16_bf16 v[160:175], a[4:7], v[80:83], v[160:175]
    ds_read_b64_tr_b16 a[0:1], v13 offset:43008
    ds_read_b64_tr_b16 a[2:3], v13 offset:43520
    s_waitcnt lgkmcnt(2)
    v_mfma_f32_32x32x16_bf16 v[160:175], a[8:11], v[84:87], v[160:175]
    ds_read_b64_tr_b16 a[4:5], v13 offset:44032
    ds_read_b64_tr_b16 a[6:7], v13 offset:44544
    buffer_load_dwordx4 v10, s[64:67], s33 offen offset:2048 lds
    s_waitcnt lgkmcnt(2)
    v_mfma_f32_32x32x16_bf16 v[160:175], a[0:3], v[88:91], v[160:175]
    ds_read_b64_tr_b16 a[8:9], v13 offset:45056
    ds_read_b64_tr_b16 a[10:11], v13 offset:45568
    buffer_load_dwordx4 v11, s[64:67], s33 offen offset:3072 lds
    s_waitcnt lgkmcnt(2)
    v_mfma_f32_32x32x16_bf16 v[160:175], a[4:7], v[92:95], v[160:175]
    ds_read_b64_tr_b16 a[0:1], v13 offset:46080
    ds_read_b64_tr_b16 a[2:3], v13 offset:46592
    s_waitcnt lgkmcnt(2)
    v_mfma_f32_32x32x16_bf16 v[160:175], a[8:11], v[96:99], v[160:175]
    ds_read_b64_tr_b16 a[4:5], v13 offset:47104
    ds_read_b64_tr_b16 a[6:7], v13 offset:47616
    s_add_u32 m0, s22, 98304
    s_add_u32 s33, s21, 218624
    buffer_load_dwordx4 v8, s[64:67], s33 offen offset:0 lds
    s_waitcnt lgkmcnt(2)
    v_mfma_f32_32x32x16_bf16 v[160:175], a[0:3], v[100:103], v[160:175]
    ds_read_b64_tr_b16 a[8:9], v13 offset:48128
    ds_read_b64_tr_b16 a[10:11], v13 offset:48640
    buffer_load_dwordx4 v9, s[64:67], s33 offen offset:1024 lds
    s_waitcnt lgkmcnt(2)
    v_mfma_f32_32x32x16_bf16 v[160:175], a[4:7], v[104:107], v[160:175]
    ds_read_b64_tr_b16 a[0:1], v13 offset:49152
    ds_read_b64_tr_b16 a[2:3], v13 offset:49664
    s_waitcnt lgkmcnt(2)
    v_mfma_f32_32x32x16_bf16 v[160:175], a[8:11], v[108:111], v[160:175]
    ds_read_b64_tr_b16 a[4:5], v13 offset:50176
    ds_read_b64_tr_b16 a[6:7], v13 offset:50688
    buffer_load_dwordx4 v10, s[64:67], s33 offen offset:2048 lds
    s_waitcnt lgkmcnt(2)
    v_mfma_f32_32x32x16_bf16 v[160:175], a[0:3], v[112:115], v[160:175]
    ds_read_b64_tr_b16 a[8:9], v13 offset:51200
    ds_read_b64_tr_b16 a[10:11], v13 offset:51712
    buffer_load_dwordx4 v11, s[64:67], s33 offen offset:3072 lds
    s_waitcnt lgkmcnt(2)
    v_mfma_f32_32x32x16_bf16 v[160:175], a[4:7], v[116:119], v[160:175]
    ds_read_b64_tr_b16 a[0:1], v13 offset:52224
    ds_read_b64_tr_b16 a[2:3], v13 offset:52736
    s_waitcnt lgkmcnt(2)
    v_mfma_f32_32x32x16_bf16 v[160:175], a[8:11], v[120:123], v[160:175]
    s_waitcnt lgkmcnt(0)
    v_mfma_f32_32x32x16_bf16 v[160:175], a[0:3], v[124:127], v[160:175]
    s_cmp_eq_u32 s7, 2
    s_cbranch_scc0 adaLN_cond__linear_kernel_hedgehog__glu_gated_bilinear__prompt_kernel_skip_21
    v_accvgpr_read_b32 v16, a64
    v_accvgpr_read_b32 v17, a65
    v_accvgpr_read_b32 v18, a66
    v_accvgpr_read_b32 v19, a67
    v_accvgpr_read_b32 v20, a68
    v_accvgpr_read_b32 v21, a69
    v_accvgpr_read_b32 v22, a70
    v_accvgpr_read_b32 v23, a71
    v_accvgpr_read_b32 v24, a72
    v_accvgpr_read_b32 v25, a73
    v_accvgpr_read_b32 v26, a74
    v_accvgpr_read_b32 v27, a75
    v_accvgpr_read_b32 v28, a76
    v_accvgpr_read_b32 v29, a77
    v_accvgpr_read_b32 v30, a78
    v_accvgpr_read_b32 v31, a79
    v_accvgpr_read_b32 v32, a80
    v_accvgpr_read_b32 v33, a81
    v_accvgpr_read_b32 v34, a82
    v_accvgpr_read_b32 v35, a83
    v_accvgpr_read_b32 v36, a84
    v_accvgpr_read_b32 v37, a85
    v_accvgpr_read_b32 v38, a86
    v_accvgpr_read_b32 v39, a87
    v_accvgpr_read_b32 v40, a88
    v_accvgpr_read_b32 v41, a89
    v_accvgpr_read_b32 v42, a90
    v_accvgpr_read_b32 v43, a91
    v_accvgpr_read_b32 v44, a92
    v_accvgpr_read_b32 v45, a93
    v_accvgpr_read_b32 v46, a94
    v_accvgpr_read_b32 v47, a95
    v_accvgpr_read_b32 v48, a96
    v_accvgpr_read_b32 v49, a97
    v_accvgpr_read_b32 v50, a98
    v_lshlrev_b32 v44, 16, v44
    v_mul_f32 v64, 0xbfb8aa3b, v44
    v_lshlrev_b32 v45, 16, v45
    v_mul_f32 v65, 0xbfb8aa3b, v45
    v_lshlrev_b32 v46, 16, v46
    v_mul_f32 v66, 0xbfb8aa3b, v46
    v_lshlrev_b32 v47, 16, v47
    v_mul_f32 v67, 0xbfb8aa3b, v47
    v_lshlrev_b32 v48, 16, v48
    v_mul_f32 v68, 0xbfb8aa3b, v48
    v_lshlrev_b32 v49, 16, v49
    v_mul_f32 v69, 0xbfb8aa3b, v49
    v_lshlrev_b32 v50, 16, v50
    v_mul_f32 v70, 0xbfb8aa3b, v50
    v_exp_f32 v64, v64
    v_exp_f32 v65, v65
    v_exp_f32 v66, v66
    v_exp_f32 v67, v67
    v_exp_f32 v68, v68
    v_exp_f32 v69, v69
    v_exp_f32 v70, v70
    v_add_f32 v64, 1.0, v64
    v_add_f32 v65, 1.0, v65
    v_add_f32 v66, 1.0, v66
    v_add_f32 v67, 1.0, v67
    v_add_f32 v68, 1.0, v68
    v_add_f32 v69, 1.0, v69
    v_add_f32 v70, 1.0, v70
    v_rcp_f32 v64, v64
    v_rcp_f32 v65, v65
    v_rcp_f32 v66, v66
    v_rcp_f32 v67, v67
    v_rcp_f32 v68, v68
    v_rcp_f32 v69, v69
    v_rcp_f32 v70, v70
    v_mul_f32 v64, v64, v44
    v_mul_f32 v65, v65, v45
    v_mul_f32 v66, v66, v46
    v_mul_f32 v67, v67, v47
    v_mul_f32 v68, v68, v48
    v_mul_f32 v69, v69, v49
    v_mul_f32 v70, v70, v50
    v_cvt_pk_bf16_f32 v64, v64, v65
    v_lshlrev_b32 v44, 16, v64
    v_and_b32 v45, 0xffff0000, v64
    v_cvt_pk_bf16_f32 v66, v66, v67
    v_lshlrev_b32 v46, 16, v66
    v_and_b32 v47, 0xffff0000, v66
    v_cvt_pk_bf16_f32 v68, v68, v69
    v_lshlrev_b32 v48, 16, v68
    v_and_b32 v49, 0xffff0000, v68
    v_cvt_pk_bf16_f32 v70, v70, v71
    v_lshlrev_b32 v50, 16, v70
    v_and_b32 v51, 0xffff0000, v70
    v_lshlrev_b32 v64, 16, v16
    v_and_b32 v65, 0xffff0000, v16
    v_pk_mul_f32 v[56:57], v[64:65], v[44:45] op_sel_hi:[1,0]
    v_lshlrev_b32 v66, 16, v17
    v_and_b32 v67, 0xffff0000, v17
    v_pk_mul_f32 v[58:59], v[66:67], v[44:45] op_sel_hi:[1,0]
    v_lshlrev_b32 v68, 16, v18
    v_and_b32 v69, 0xffff0000, v18
    v_pk_mul_f32 v[60:61], v[68:69], v[44:45] op_sel_hi:[1,0]
    v_lshlrev_b32 v70, 16, v19
    v_and_b32 v71, 0xffff0000, v19
    v_pk_mul_f32 v[62:63], v[70:71], v[44:45] op_sel_hi:[1,0]
    v_lshlrev_b32 v64, 16, v20
    v_and_b32 v65, 0xffff0000, v20
    v_pk_fma_f32 v[56:57], v[64:65], v[44:45], v[56:57] op_sel:[0,1,0] op_sel_hi:[1,1,1]
    v_lshlrev_b32 v66, 16, v21
    v_and_b32 v67, 0xffff0000, v21
    v_pk_fma_f32 v[58:59], v[66:67], v[44:45], v[58:59] op_sel:[0,1,0] op_sel_hi:[1,1,1]
    v_lshlrev_b32 v68, 16, v22
    v_and_b32 v69, 0xffff0000, v22
    v_pk_fma_f32 v[60:61], v[68:69], v[44:45], v[60:61] op_sel:[0,1,0] op_sel_hi:[1,1,1]
    v_lshlrev_b32 v70, 16, v23
    v_and_b32 v71, 0xffff0000, v23
    v_pk_fma_f32 v[62:63], v[70:71], v[44:45], v[62:63] op_sel:[0,1,0] op_sel_hi:[1,1,1]
    v_lshlrev_b32 v64, 16, v24
    v_and_b32 v65, 0xffff0000, v24
    v_pk_fma_f32 v[56:57], v[64:65], v[46:47], v[56:57] op_sel_hi:[1,0,1]
    v_lshlrev_b32 v66, 16, v25
    v_and_b32 v67, 0xffff0000, v25
    v_pk_fma_f32 v[58:59], v[66:67], v[46:47], v[58:59] op_sel_hi:[1,0,1]
    v_lshlrev_b32 v68, 16, v26
    v_and_b32 v69, 0xffff0000, v26
    v_pk_fma_f32 v[60:61], v[68:69], v[46:47], v[60:61] op_sel_hi:[1,0,1]
    v_lshlrev_b32 v70, 16, v27
    v_and_b32 v71, 0xffff0000, v27
    v_pk_fma_f32 v[62:63], v[70:71], v[46:47], v[62:63] op_sel_hi:[1,0,1]
    v_lshlrev_b32 v64, 16, v28
    v_and_b32 v65, 0xffff0000, v28
    v_pk_fma_f32 v[56:57], v[64:65], v[46:47], v[56:57] op_sel:[0,1,0] op_sel_hi:[1,1,1]
    v_lshlrev_b32 v66, 16, v29
    v_and_b32 v67, 0xffff0000, v29
    v_pk_fma_f32 v[58:59], v[66:67], v[46:47], v[58:59] op_sel:[0,1,0] op_sel_hi:[1,1,1]
    v_lshlrev_b32 v68, 16, v30
    v_and_b32 v69, 0xffff0000, v30
    v_pk_fma_f32 v[60:61], v[68:69], v[46:47], v[60:61] op_sel:[0,1,0] op_sel_hi:[1,1,1]
    v_lshlrev_b32 v70, 16, v31
    v_and_b32 v71, 0xffff0000, v31
    v_pk_fma_f32 v[62:63], v[70:71], v[46:47], v[62:63] op_sel:[0,1,0] op_sel_hi:[1,1,1]
    v_lshlrev_b32 v64, 16, v32
    v_and_b32 v65, 0xffff0000, v32
    v_pk_fma_f32 v[56:57], v[64:65], v[48:49], v[56:57] op_sel_hi:[1,0,1]
    v_lshlrev_b32 v66, 16, v33
    v_and_b32 v67, 0xffff0000, v33
    v_pk_fma_f32 v[58:59], v[66:67], v[48:49], v[58:59] op_sel_hi:[1,0,1]
    v_lshlrev_b32 v68, 16, v34
    v_and_b32 v69, 0xffff0000, v34
    v_pk_fma_f32 v[60:61], v[68:69], v[48:49], v[60:61] op_sel_hi:[1,0,1]
    v_lshlrev_b32 v70, 16, v35
    v_and_b32 v71, 0xffff0000, v35
    v_pk_fma_f32 v[62:63], v[70:71], v[48:49], v[62:63] op_sel_hi:[1,0,1]
    v_lshlrev_b32 v64, 16, v36
    v_and_b32 v65, 0xffff0000, v36
    v_pk_fma_f32 v[56:57], v[64:65], v[48:49], v[56:57] op_sel:[0,1,0] op_sel_hi:[1,1,1]
    v_lshlrev_b32 v66, 16, v37
    v_and_b32 v67, 0xffff0000, v37
    v_pk_fma_f32 v[58:59], v[66:67], v[48:49], v[58:59] op_sel:[0,1,0] op_sel_hi:[1,1,1]
    v_lshlrev_b32 v68, 16, v38
    v_and_b32 v69, 0xffff0000, v38
    v_pk_fma_f32 v[60:61], v[68:69], v[48:49], v[60:61] op_sel:[0,1,0] op_sel_hi:[1,1,1]
    v_lshlrev_b32 v70, 16, v39
    v_and_b32 v71, 0xffff0000, v39
    v_pk_fma_f32 v[62:63], v[70:71], v[48:49], v[62:63] op_sel:[0,1,0] op_sel_hi:[1,1,1]
    v_lshlrev_b32 v64, 16, v40
    v_and_b32 v65, 0xffff0000, v40
    v_pk_fma_f32 v[56:57], v[64:65], v[50:51], v[56:57] op_sel_hi:[1,0,1]
    v_lshlrev_b32 v66, 16, v41
    v_and_b32 v67, 0xffff0000, v41
    v_pk_fma_f32 v[58:59], v[66:67], v[50:51], v[58:59] op_sel_hi:[1,0,1]
    v_lshlrev_b32 v68, 16, v42
    v_and_b32 v69, 0xffff0000, v42
    v_pk_fma_f32 v[60:61], v[68:69], v[50:51], v[60:61] op_sel_hi:[1,0,1]
    v_lshlrev_b32 v70, 16, v43
    v_and_b32 v71, 0xffff0000, v43
    v_pk_fma_f32 v[62:63], v[70:71], v[50:51], v[62:63] op_sel_hi:[1,0,1]
    v_lshlrev_b32 v4, 5, v0
    v_add_u32 v4, 151552, v4
    ds_write_b128 v4, v[56:59]
    ds_write_b128 v4, v[60:63] offset:16
adaLN_cond__linear_kernel_hedgehog__glu_gated_bilinear__prompt_kernel_skip_21:
    s_nop 9
    v_pk_mul_f32 v[160:161], v[160:161], v[14:15] op_sel_hi:[1,0]
    v_pk_mul_f32 v[162:163], v[162:163], v[14:15] op_sel_hi:[1,0]
    v_pk_mul_f32 v[164:165], v[164:165], v[14:15] op_sel_hi:[1,0]
    v_pk_mul_f32 v[166:167], v[166:167], v[14:15] op_sel_hi:[1,0]
    v_pk_mul_f32 v[168:169], v[168:169], v[14:15] op_sel_hi:[1,0]
    v_pk_mul_f32 v[170:171], v[170:171], v[14:15] op_sel_hi:[1,0]
    v_pk_mul_f32 v[172:173], v[172:173], v[14:15] op_sel_hi:[1,0]
    v_pk_mul_f32 v[174:175], v[174:175], v[14:15] op_sel_hi:[1,0]
    v_cvt_pk_bf16_f32 v144, v160, v161
    v_cvt_pk_bf16_f32 v145, v162, v163
    v_cvt_pk_bf16_f32 v146, v164, v165
    v_cvt_pk_bf16_f32 v147, v166, v167
    v_cvt_pk_bf16_f32 v148, v168, v169
    v_cvt_pk_bf16_f32 v149, v170, v171
    v_cvt_pk_bf16_f32 v150, v172, v173
    v_cvt_pk_bf16_f32 v151, v174, v175
    v_cndmask_b32 v150, v150, 0, s[46:47]
    v_cndmask_b32 v151, v151, 0, s[46:47]
    v_mfma_f32_32x32x16_bf16 v[176:191], a[16:19], v[144:147], 0
    s_nop 0
    v_mfma_f32_32x32x16_bf16 v[176:191], a[20:23], v[148:151], v[176:191]
    s_waitcnt lgkmcnt(0)
    s_barrier
    s_cmp_eq_u32 s3, 1
    s_cbranch_scc0 adaLN_cond__linear_kernel_hedgehog__glu_gated_bilinear__prompt_kernel_skip_22
    s_cmp_eq_u32 s7, 2
    s_cbranch_scc0 adaLN_cond__linear_kernel_hedgehog__glu_gated_bilinear__prompt_kernel_skip_23
    v_lshrrev_b32 v4, 2, v1
    v_add_u32 v4, 151552, v4
    ds_read_b32 v64, v4 offset:0
    ds_read_b32 v65, v4 offset:256
    ds_read_b32 v66, v4 offset:512
    ds_read_b32 v67, v4 offset:768
    ds_read_b32 v68, v4 offset:1024
    ds_read_b32 v69, v4 offset:1280
    ds_read_b32 v70, v4 offset:1536
    ds_read_b32 v71, v4 offset:1792
    ds_read_b32 v72, v4 offset:2048
    ds_read_b32 v73, v4 offset:2304
    ds_read_b32 v74, v4 offset:2560
    ds_read_b32 v75, v4 offset:2816
    ds_read_b32 v76, v4 offset:3072
    ds_read_b32 v77, v4 offset:3328
    ds_read_b32 v78, v4 offset:3584
    ds_read_b32 v79, v4 offset:3840
    ds_read_b32 v80, v4 offset:4096
    ds_read_b32 v81, v4 offset:4352
    ds_read_b32 v82, v4 offset:4608
    ds_read_b32 v83, v4 offset:4864
    ds_read_b32 v84, v4 offset:5120
    ds_read_b32 v85, v4 offset:5376
    ds_read_b32 v86, v4 offset:5632
    ds_read_b32 v87, v4 offset:5888
    ds_read_b32 v88, v4 offset:6144
    ds_read_b32 v89, v4 offset:6400
    ds_read_b32 v90, v4 offset:6656
    ds_read_b32 v91, v4 offset:6912
    ds_read_b32 v92, v4 offset:7168
    ds_read_b32 v93, v4 offset:7424
    ds_read_b32 v94, v4 offset:7680
    ds_read_b32 v95, v4 offset:7936
    s_lshr_b32 s36, s2, 1
    s_mul_i32 s35, s36, 9363
    s_lshr_b32 s35, s35, 16
    s_mul_i32 s34, s35, 7
    s_sub_u32 s34, s36, s34
    s_lshl_b32 s34, s34, 6
    s_and_b32 s36, s2, 1
    v_lshrrev_b32 v96, 4, v1
    v_add_u32 v96, s34, v96
    v_bfe_u32 v99, v96, 2, 1
    v_and_b32 v100, 3, v96
    v_lshl_add_u32 v100, v99, 4, v100
    v_lshrrev_b32 v97, 5, v96
    v_lshl_add_u32 v97, v97, 5, v100
    v_bfe_u32 v101, v96, 3, 2
    v_lshl_add_u32 v97, v101, 2, v97
    s_lshl_b32 s36, s36, 12
    s_lshl_b32 s34, s35, 13
    s_add_u32 s34, s34, s36
    s_add_u32 s34, s34, 0x2000
    v_lshlrev_b32 v97, 3, v97
    s_waitcnt lgkmcnt(14)
    v_pk_add_f32 v[64:65], v[64:65], v[80:81]
    s_waitcnt lgkmcnt(12)
    v_pk_add_f32 v[66:67], v[66:67], v[82:83]
    s_waitcnt lgkmcnt(10)
    v_pk_add_f32 v[68:69], v[68:69], v[84:85]
    s_waitcnt lgkmcnt(8)
    v_pk_add_f32 v[70:71], v[70:71], v[86:87]
    s_waitcnt lgkmcnt(6)
    v_pk_add_f32 v[72:73], v[72:73], v[88:89]
    s_waitcnt lgkmcnt(4)
    v_pk_add_f32 v[74:75], v[74:75], v[90:91]
    s_waitcnt lgkmcnt(2)
    v_pk_add_f32 v[76:77], v[76:77], v[92:93]
    s_waitcnt lgkmcnt(0)
    v_pk_add_f32 v[78:79], v[78:79], v[94:95]
    v_pk_add_f32 v[64:65], v[64:65], v[72:73]
    v_pk_add_f32 v[66:67], v[66:67], v[74:75]
    v_pk_add_f32 v[68:69], v[68:69], v[76:77]
    v_pk_add_f32 v[70:71], v[70:71], v[78:79]
    v_pk_add_f32 v[64:65], v[64:65], v[68:69]
    v_pk_add_f32 v[66:67], v[66:67], v[70:71]
    v_pk_add_f32 v[64:65], v[64:65], v[66:67]
    v_add_f32 v64, v64, v65
    v_mov_b32 v65, s28
    buffer_store_dwordx2 v[64:65], v97, s[8:11], s34 offen sc1
adaLN_cond__linear_kernel_hedgehog__glu_gated_bilinear__prompt_kernel_skip_23:
adaLN_cond__linear_kernel_hedgehog__glu_gated_bilinear__prompt_kernel_skip_22:
    s_cmp_ge_u32 s69, 7
    s_cselect_b32 s52, 1, 0
    s_cselect_b32 s53, 7, 0
    s_sub_u32 s53, s69, s53
    s_min_u32 s53, s53, 6
    s_lshl_b32 s33, s68, 1
    s_add_u32 s52, s52, s33
    s_cmp_lt_u32 s69, 14
    s_cselect_b32 s69, 1, 0
    s_and_b32 s33, s52, 3
    s_lshl_b32 s33, s33, 1
    s_add_u32 s54, s33, s53
    s_cmp_ge_u32 s54, 7
    s_cselect_b32 s33, 7, 0
    s_sub_u32 s54, s54, s33
    s_mul_i32 s76, s53, 229376
    s_mul_i32 s33, s3, 57344
    s_add_u32 s76, s76, s33
    s_add_u32 s76, s76, 0x480000
    s_lshl_b32 s77, s54, 13
    s_cmp_ge_u32 s3, 2
    s_cselect_b32 s24, s60, s58
    s_cselect_b32 s25, s61, s59
    s_cselect_b32 s75, 14464, 0
    s_and_b32 s25, s25, 0xffff
    s_mov_b32 s26, 0x188000
    s_mov_b32 s27, 0x20000
    s_and_b32 s33, s3, 1
    s_mul_i32 s70, s33, 7168
    s_add_u32 s75, s75, s70
    s_mul_i32 s70, s33, 114688
    s_mul_i32 s33, s30, 224
    s_add_u32 s70, s70, s33
    s_mul_i32 s97, s101, 229376
    s_lshl_b32 s49, s32, 12
    s_add_u32 s49, s49, 0x10000
    v_max3_f32 v192, v176, v177, v178
    v_max3_f32 v194, v188, v189, v190
    v_max3_f32 v192, v192, v179, v180
    v_max3_f32 v192, v192, v181, v182
    v_max3_f32 v192, v192, v183, v184
    v_max3_f32 v192, v192, v185, v186
    v_max_f32 v194, v194, v191
    s_add_u32 m0, s23, 35840
    s_add_u32 s33, s20, 0
    buffer_load_dwordx4 v8, s[64:67], s33 offen offset:0 lds
    v_max_f32 v192, v192, v187
    v_cndmask_b32 v194, v194, v192, s[46:47]
    v_max_f32 v192, v192, v194
    v_min3_f32 v193, v176, v177, v178
    v_min3_f32 v195, v188, v189, v190
    v_min3_f32 v193, v193, v179, v180
    v_min3_f32 v193, v193, v181, v182
    buffer_load_dwordx4 v9, s[64:67], s33 offen offset:1024 lds
    v_min3_f32 v193, v193, v183, v184
    v_min3_f32 v193, v193, v185, v186
    v_min_f32 v195, v195, v191
    v_min_f32 v193, v193, v187
    v_cndmask_b32 v195, v195, v193, s[46:47]
    v_min_f32 v193, v193, v195
    v_mov_b32 v194, v192
    buffer_load_dwordx4 v10, s[64:67], s33 offen offset:2048 lds
    v_mov_b32 v195, v193
    v_permlane32_swap_b32 v192, v194
    s_nop 0
    v_permlane32_swap_b32 v193, v195
    v_max_f32 v192, v192, v194
    v_min_f32 v193, v193, v195
    v_mul_f32 v192, 0xbfb8aa3b, v192
    v_mul_f32 v193, 0x3fb8aa3b, v193
    buffer_load_dwordx4 v11, s[64:67], s33 offen offset:3072 lds
    v_mov_b32 v194, 0xff800000
    v_cndmask_b32 v196, v192, v194, s[46:47]
    v_cndmask_b32 v197, v193, v194, s[46:47]
    v_fma_f32 v200, v176, s40, v192
    v_fma_f32 v216, -v176, s40, v193
    v_fma_f32 v201, v177, s40, v192
    v_fma_f32 v217, -v177, s40, v193
    s_add_u32 m0, s23, 39936
    s_add_u32 s33, s20, 14336
    buffer_load_dwordx4 v8, s[64:67], s33 offen offset:0 lds
    v_fma_f32 v202, v178, s40, v192
    v_fma_f32 v218, -v178, s40, v193
    v_fma_f32 v203, v179, s40, v192
    v_fma_f32 v219, -v179, s40, v193
    v_fma_f32 v204, v180, s40, v192
    v_fma_f32 v220, -v180, s40, v193
    v_fma_f32 v205, v181, s40, v192
    buffer_load_dwordx4 v9, s[64:67], s33 offen offset:1024 lds
    v_fma_f32 v221, -v181, s40, v193
    v_fma_f32 v206, v182, s40, v192
    v_fma_f32 v222, -v182, s40, v193
    v_fma_f32 v207, v183, s40, v192
    v_fma_f32 v223, -v183, s40, v193
    v_fma_f32 v208, v184, s40, v192
    v_fma_f32 v224, -v184, s40, v193
    buffer_load_dwordx4 v10, s[64:67], s33 offen offset:2048 lds
    v_fma_f32 v209, v185, s40, v192
    v_fma_f32 v225, -v185, s40, v193
    v_fma_f32 v210, v186, s40, v192
    v_fma_f32 v226, -v186, s40, v193
    v_fma_f32 v211, v187, s40, v192
    v_fma_f32 v227, -v187, s40, v193
    v_fma_f32 v212, v188, s40, v196
    buffer_load_dwordx4 v11, s[64:67], s33 offen offset:3072 lds
    v_fma_f32 v228, -v188, s40, v197
    v_fma_f32 v213, v189, s40, v196
    v_fma_f32 v229, -v189, s40, v197
    v_fma_f32 v214, v190, s40, v196
    v_fma_f32 v230, -v190, s40, v197
    v_fma_f32 v215, v191, s40, v196
    v_fma_f32 v231, -v191, s40, v197
    s_add_u32 m0, s23, 44032
    s_add_u32 s33, s20, 28672
    buffer_load_dwordx4 v8, s[64:67], s33 offen offset:0 lds
    v_exp_f32 v200, v200
    v_exp_f32 v201, v201
    v_exp_f32 v202, v202
    v_exp_f32 v203, v203
    v_exp_f32 v204, v204
    v_exp_f32 v205, v205
    v_exp_f32 v206, v206
    buffer_load_dwordx4 v9, s[64:67], s33 offen offset:1024 lds
    v_exp_f32 v207, v207
    v_exp_f32 v208, v208
    v_exp_f32 v209, v209
    v_exp_f32 v210, v210
    v_exp_f32 v211, v211
    v_exp_f32 v212, v212
    v_exp_f32 v213, v213
    buffer_load_dwordx4 v10, s[64:67], s33 offen offset:2048 lds
    v_exp_f32 v214, v214
    v_exp_f32 v215, v215
    v_exp_f32 v216, v216
    v_exp_f32 v217, v217
    v_exp_f32 v218, v218
    v_exp_f32 v219, v219
    v_exp_f32 v220, v220
    buffer_load_dwordx4 v11, s[64:67], s33 offen offset:3072 lds
    v_exp_f32 v221, v221
    v_exp_f32 v222, v222
    v_exp_f32 v223, v223
    v_exp_f32 v224, v224
    v_exp_f32 v225, v225
    v_exp_f32 v226, v226
    v_exp_f32 v227, v227
    s_add_u32 m0, s23, 48128
    s_add_u32 s33, s20, 43008
    buffer_load_dwordx4 v8, s[64:67], s33 offen offset:0 lds
    v_exp_f32 v228, v228
    v_exp_f32 v229, v229
    v_exp_f32 v230, v230
    v_exp_f32 v231, v231
    v_pk_add_f32 v[192:193], v[200:201], v[202:203]
    v_pk_add_f32 v[194:195], v[216:217], v[218:219]
    v_pk_add_f32 v[192:193], v[192:193], v[204:205]
    v_pk_add_f32 v[194:195], v[194:195], v[220:221]
    v_pk_add_f32 v[192:193], v[192:193], v[206:207]
    v_pk_add_f32 v[194:195], v[194:195], v[222:223]
    v_pk_add_f32 v[192:193], v[192:193], v[208:209]
    v_pk_add_f32 v[194:195], v[194:195], v[224:225]
    v_pk_add_f32 v[192:193], v[192:193], v[210:211]
    v_pk_add_f32 v[194:195], v[194:195], v[226:227]
    v_pk_add_f32 v[192:193], v[192:193], v[212:213]
    v_pk_add_f32 v[194:195], v[194:195], v[228:229]
    v_pk_add_f32 v[192:193], v[192:193], v[214:215]
    v_pk_add_f32 v[194:195], v[194:195], v[230:231]
    v_add_f32 v192, v192, v193
    v_add_f32 v194, v194, v195
    v_mov_b32 v193, v192
    v_mov_b32 v195, v194
    s_nop 0
    v_permlane32_swap_b32 v192, v193
    v_permlane32_swap_b32 v194, v195
    v_add_f32 v192, v192, v193
    v_add_f32 v194, v194, v195
    v_rcp_f32 v192, v192
    v_rcp_f32 v194, v194
    v_pk_mul_f32 v[200:201], v[200:201], v[192:193] op_sel_hi:[1,0]
    v_pk_mul_f32 v[216:217], v[216:217], v[194:195] op_sel_hi:[1,0]
    v_cvt_pk_bf16_f32 v144, v200, v201
    v_cvt_pk_bf16_f32 v152, v216, v217
    v_pk_mul_f32 v[202:203], v[202:203], v[192:193] op_sel_hi:[1,0]
    v_pk_mul_f32 v[218:219], v[218:219], v[194:195] op_sel_hi:[1,0]
    v_cvt_pk_bf16_f32 v145, v202, v203
    v_cvt_pk_bf16_f32 v153, v218, v219
    v_pk_mul_f32 v[204:205], v[204:205], v[192:193] op_sel_hi:[1,0]
    v_pk_mul_f32 v[220:221], v[220:221], v[194:195] op_sel_hi:[1,0]
    v_cvt_pk_bf16_f32 v146, v204, v205
    v_cvt_pk_bf16_f32 v154, v220, v221
    v_pk_mul_f32 v[206:207], v[206:207], v[192:193] op_sel_hi:[1,0]
    v_pk_mul_f32 v[222:223], v[222:223], v[194:195] op_sel_hi:[1,0]
    v_cvt_pk_bf16_f32 v147, v206, v207
    v_cvt_pk_bf16_f32 v155, v222, v223
    v_pk_mul_f32 v[208:209], v[208:209], v[192:193] op_sel_hi:[1,0]
    v_pk_mul_f32 v[224:225], v[224:225], v[194:195] op_sel_hi:[1,0]
    v_cvt_pk_bf16_f32 v148, v208, v209
    v_cvt_pk_bf16_f32 v156, v224, v225
    v_pk_mul_f32 v[210:211], v[210:211], v[192:193] op_sel_hi:[1,0]
    v_pk_mul_f32 v[226:227], v[226:227], v[194:195] op_sel_hi:[1,0]
    v_cvt_pk_bf16_f32 v149, v210, v211
    v_cvt_pk_bf16_f32 v157, v226, v227
    v_pk_mul_f32 v[212:213], v[212:213], v[192:193] op_sel_hi:[1,0]
    v_pk_mul_f32 v[228:229], v[228:229], v[194:195] op_sel_hi:[1,0]
    v_cvt_pk_bf16_f32 v150, v212, v213
    v_cvt_pk_bf16_f32 v158, v228, v229
    v_pk_mul_f32 v[214:215], v[214:215], v[192:193] op_sel_hi:[1,0]
    v_pk_mul_f32 v[230:231], v[230:231], v[194:195] op_sel_hi:[1,0]
    v_cvt_pk_bf16_f32 v151, v214, v215
    v_cvt_pk_bf16_f32 v159, v230, v231
    s_lshl_b32 s38, s30, 16
    s_add_u32 s38, s38, s45
    s_add_u32 s38, s38, 0x620000
    s_lshl_b32 s39, s29, 14
    s_and_b32 s39, s39, 0xffff
    v_and_b32 v4, 0xf0, v1
    s_mov_b32 s50, 0x3f80
    s_mov_b32 s51, 0x3f800000
    v_mov_b32 v80, 0
    v_mov_b32 v81, 0
    v_mov_b32 v82, 0
    v_mov_b32 v83, 0
    v_mov_b32 v84, 0
    v_mov_b32 v85, 0
    v_mov_b32 v86, 0
    v_mov_b32 v87, 0
    v_add_u32 v6, 159744, v1
    v_add_u32 v7, s45, v6
    s_mov_b32 s33, 40000
adaLN_cond__linear_kernel_hedgehog__glu_gated_bilinear__prompt_kernel_poll_24:
    buffer_load_dword v12, v4, s[8:11], s48 offen sc1
    s_waitcnt vmcnt(0)
    v_xor_b32 v13, s28, v12
    v_cmp_ne_u32 vcc, 0, v13
    s_sub_u32 s33, s33, 1
    s_cbranch_scc1 adaLN_cond__linear_kernel_hedgehog__glu_gated_bilinear__prompt_kernel_pollx_25
    s_cbranch_vccnz adaLN_cond__linear_kernel_hedgehog__glu_gated_bilinear__prompt_kernel_poll_24
adaLN_cond__linear_kernel_hedgehog__glu_gated_bilinear__prompt_kernel_pollx_25:
    s_add_u32 s41, s38, s39
    buffer_load_dwordx4 v[16:19], v1, s[8:11], s41 offen sc1
    s_add_u32 s39, s39, 4096
    s_and_b32 s39, s39, 0xffff
    s_add_u32 s41, s38, s39
    buffer_load_dwordx4 v[20:23], v1, s[8:11], s41 offen sc1
    s_add_u32 s39, s39, 4096
    s_and_b32 s39, s39, 0xffff
    s_add_u32 s41, s38, s39
    buffer_load_dwordx4 v[24:27], v1, s[8:11], s41 offen sc1
    s_add_u32 s39, s39, 4096
    s_and_b32 s39, s39, 0xffff
    s_add_u32 s41, s38, s39
    buffer_load_dwordx4 v[28:31], v1, s[8:11], s41 offen sc1
    s_add_u32 s39, s39, 4096
    s_and_b32 s39, s39, 0xffff
    s_add_u32 s41, s38, s39
    buffer_load_dwordx4 v[32:35], v1, s[8:11], s41 offen sc1
    s_add_u32 s39, s39, 4096
    s_and_b32 s39, s39, 0xffff
    s_add_u32 s41, s38, s39
    buffer_load_dwordx4 v[36:39], v1, s[8:11], s41 offen sc1
    s_add_u32 s39, s39, 4096
    s_and_b32 s39, s39, 0xffff
    s_add_u32 s41, s38, s39
    buffer_load_dwordx4 v[40:43], v1, s[8:11], s41 offen sc1
    s_add_u32 s39, s39, 4096
    s_and_b32 s39, s39, 0xffff
    s_add_u32 s41, s38, s39
    buffer_load_dwordx4 v[44:47], v1, s[8:11], s41 offen sc1
    s_add_u32 s39, s39, 4096
    s_and_b32 s39, s39, 0xffff
    s_add_u32 s41, s38, s39
    buffer_load_dwordx4 v[48:51], v1, s[8:11], s41 offen sc1
    s_add_u32 s39, s39, 4096
    s_and_b32 s39, s39, 0xffff
    s_add_u32 s41, s38, s39
    buffer_load_dwordx4 v[52:55], v1, s[8:11], s41 offen sc1
    s_add_u32 s39, s39, 4096
    s_and_b32 s39, s39, 0xffff
    s_add_u32 s41, s38, s39
    buffer_load_dwordx4 v[56:59], v1, s[8:11], s41 offen sc1
    s_add_u32 s39, s39, 4096
    s_and_b32 s39, s39, 0xffff
    s_add_u32 s41, s38, s39
    buffer_load_dwordx4 v[60:63], v1, s[8:11], s41 offen sc1
    s_add_u32 s39, s39, 4096
    s_and_b32 s39, s39, 0xffff
    s_add_u32 s41, s38, s39
    buffer_load_dwordx4 v[64:67], v1, s[8:11], s41 offen sc1
    s_add_u32 s39, s39, 4096
    s_and_b32 s39, s39, 0xffff
    s_add_u32 s41, s38, s39
    buffer_load_dwordx4 v[68:71], v1, s[8:11], s41 offen sc1
    s_add_u32 s39, s39, 4096
    s_and_b32 s39, s39, 0xffff
    s_add_u32 s41, s38, s39
    buffer_load_dwordx4 v[72:75], v1, s[8:11], s41 offen sc1
    s_add_u32 s39, s39, 4096
    s_and_b32 s39, s39, 0xffff
    s_add_u32 s41, s38, s39
    buffer_load_dwordx4 v[76:79], v1, s[8:11], s41 offen sc1
    s_lshl_b32 s38, s31, 4
    s_add_u32 s38, s38, s30
    s_lshl_b32 s39, s38, 4
    s_add_u32 s39, s39, 0x20000
    s_lshl_b32 s38, s38, 11
    s_add_u32 s38, s38, 0x720000
    v_lshrrev_b32 v4, 4, v1
    v_add_u32 v4, 0, v4
    v_mul_u32_u24 v5, 4682, v4
    v_lshrrev_b32 v5, 16, v5
    v_mul_u32_u24 v240, 3360, v5
    v_lshl_add_u32 v240, v4, 4, v240
    v_lshrrev_b32 v4, 4, v1
    v_add_u32 v4, 64, v4
    v_mul_u32_u24 v5, 4682, v4
    v_lshrrev_b32 v5, 16, v5
    v_mul_u32_u24 v241, 3360, v5
    v_lshl_add_u32 v241, v4, 4, v241
    v_lshrrev_b32 v4, 4, v1
    v_add_u32 v4, 128, v4
    v_mul_u32_u24 v5, 4682, v4
    v_lshrrev_b32 v5, 16, v5
    v_mul_u32_u24 v242, 3360, v5
    v_lshl_add_u32 v242, v4, 4, v242
    v_lshrrev_b32 v4, 4, v1
    v_add_u32 v4, 192, v4
    v_mul_u32_u24 v5, 4682, v4
    v_lshrrev_b32 v5, 16, v5
    v_mul_u32_u24 v243, 3360, v5
    v_lshl_add_u32 v243, v4, 4, v243
    v_lshrrev_b32 v4, 4, v1
    v_add_u32 v4, 256, v4
    v_mul_u32_u24 v5, 4682, v4
    v_lshrrev_b32 v5, 16, v5
    v_mul_u32_u24 v244, 3360, v5
    v_lshl_add_u32 v244, v4, 4, v244
    v_lshrrev_b32 v4, 4, v1
    v_add_u32 v4, 320, v4
    v_mul_u32_u24 v5, 4682, v4
    v_lshrrev_b32 v5, 16, v5
    v_mul_u32_u24 v245, 3360, v5
    v_lshl_add_u32 v245, v4, 4, v245
    v_lshrrev_b32 v4, 4, v1
    v_add_u32 v4, 384, v4
    v_mul_u32_u24 v5, 4682, v4
    v_lshrrev_b32 v5, 16, v5
    v_mul_u32_u24 v246, 3360, v5
    v_lshl_add_u32 v246, v4, 4, v246
    s_waitcnt vmcnt(15)
    v_dot2c_f32_bf16 v80, s50, v16
    v_dot2c_f32_bf16 v81, s51, v16
    v_dot2c_f32_bf16 v82, s50, v17
    v_dot2c_f32_bf16 v83, s51, v17
    v_dot2c_f32_bf16 v84, s50, v18
    v_dot2c_f32_bf16 v85, s51, v18
    v_dot2c_f32_bf16 v86, s50, v19
    v_dot2c_f32_bf16 v87, s51, v19
    s_waitcnt vmcnt(14)
    v_dot2c_f32_bf16 v80, s50, v20
    v_dot2c_f32_bf16 v81, s51, v20
    v_dot2c_f32_bf16 v82, s50, v21
    v_dot2c_f32_bf16 v83, s51, v21
    v_dot2c_f32_bf16 v84, s50, v22
    v_dot2c_f32_bf16 v85, s51, v22
    v_dot2c_f32_bf16 v86, s50, v23
    v_dot2c_f32_bf16 v87, s51, v23
    s_waitcnt vmcnt(13)
    v_dot2c_f32_bf16 v80, s50, v24
    v_dot2c_f32_bf16 v81, s51, v24
    v_dot2c_f32_bf16 v82, s50, v25
    v_dot2c_f32_bf16 v83, s51, v25
    v_dot2c_f32_bf16 v84, s50, v26
    v_dot2c_f32_bf16 v85, s51, v26
    v_dot2c_f32_bf16 v86, s50, v27
    v_dot2c_f32_bf16 v87, s51, v27
    s_waitcnt vmcnt(12)
    v_dot2c_f32_bf16 v80, s50, v28
    v_dot2c_f32_bf16 v81, s51, v28
    v_dot2c_f32_bf16 v82, s50, v29
    v_dot2c_f32_bf16 v83, s51, v29
    v_dot2c_f32_bf16 v84, s50, v30
    v_dot2c_f32_bf16 v85, s51, v30
    v_dot2c_f32_bf16 v86, s50, v31
    v_dot2c_f32_bf16 v87, s51, v31
    s_waitcnt vmcnt(11)
    v_dot2c_f32_bf16 v80, s50, v32
    v_dot2c_f32_bf16 v81, s51, v32
    v_dot2c_f32_bf16 v82, s50, v33
    v_dot2c_f32_bf16 v83, s51, v33
    v_dot2c_f32_bf16 v84, s50, v34
    v_dot2c_f32_bf16 v85, s51, v34
    v_dot2c_f32_bf16 v86, s50, v35
    v_dot2c_f32_bf16 v87, s51, v35
    s_waitcnt vmcnt(10)
    v_dot2c_f32_bf16 v80, s50, v36
    v_dot2c_f32_bf16 v81, s51, v36
    v_dot2c_f32_bf16 v82, s50, v37
    v_dot2c_f32_bf16 v83, s51, v37
    v_dot2c_f32_bf16 v84, s50, v38
    v_dot2c_f32_bf16 v85, s51, v38
    v_dot2c_f32_bf16 v86, s50, v39
    v_dot2c_f32_bf16 v87, s51, v39
    s_waitcnt vmcnt(9)
    v_dot2c_f32_bf16 v80, s50, v40
    v_dot2c_f32_bf16 v81, s51, v40
    v_dot2c_f32_bf16 v82, s50, v41
    v_dot2c_f32_bf16 v83, s51, v41
    v_dot2c_f32_bf16 v84, s50, v42
    v_dot2c_f32_bf16 v85, s51, v42
    v_dot2c_f32_bf16 v86, s50, v43
    v_dot2c_f32_bf16 v87, s51, v43
    s_waitcnt vmcnt(8)
    v_dot2c_f32_bf16 v80, s50, v44
    v_dot2c_f32_bf16 v81, s51, v44
    v_dot2c_f32_bf16 v82, s50, v45
    v_dot2c_f32_bf16 v83, s51, v45
    v_dot2c_f32_bf16 v84, s50, v46
    v_dot2c_f32_bf16 v85, s51, v46
    v_dot2c_f32_bf16 v86, s50, v47
    v_dot2c_f32_bf16 v87, s51, v47
    s_waitcnt vmcnt(7)
    v_dot2c_f32_bf16 v80, s50, v48
    v_dot2c_f32_bf16 v81, s51, v48
    v_dot2c_f32_bf16 v82, s50, v49
    v_dot2c_f32_bf16 v83, s51, v49
    v_dot2c_f32_bf16 v84, s50, v50
    v_dot2c_f32_bf16 v85, s51, v50
    v_dot2c_f32_bf16 v86, s50, v51
    v_dot2c_f32_bf16 v87, s51, v51
    s_waitcnt vmcnt(6)
    v_dot2c_f32_bf16 v80, s50, v52
    v_dot2c_f32_bf16 v81, s51, v52
    v_dot2c_f32_bf16 v82, s50, v53
    v_dot2c_f32_bf16 v83, s51, v53
    v_dot2c_f32_bf16 v84, s50, v54
    v_dot2c_f32_bf16 v85, s51, v54
    v_dot2c_f32_bf16 v86, s50, v55
    v_dot2c_f32_bf16 v87, s51, v55
    s_waitcnt vmcnt(5)
    v_dot2c_f32_bf16 v80, s50, v56
    v_dot2c_f32_bf16 v81, s51, v56
    v_dot2c_f32_bf16 v82, s50, v57
    v_dot2c_f32_bf16 v83, s51, v57
    v_dot2c_f32_bf16 v84, s50, v58
    v_dot2c_f32_bf16 v85, s51, v58
    v_dot2c_f32_bf16 v86, s50, v59
    v_dot2c_f32_bf16 v87, s51, v59
    s_waitcnt vmcnt(4)
    v_dot2c_f32_bf16 v80, s50, v60
    v_dot2c_f32_bf16 v81, s51, v60
    v_dot2c_f32_bf16 v82, s50, v61
    v_dot2c_f32_bf16 v83, s51, v61
    v_dot2c_f32_bf16 v84, s50, v62
    v_dot2c_f32_bf16 v85, s51, v62
    v_dot2c_f32_bf16 v86, s50, v63
    v_dot2c_f32_bf16 v87, s51, v63
    s_waitcnt vmcnt(3)
    v_dot2c_f32_bf16 v80, s50, v64
    v_dot2c_f32_bf16 v81, s51, v64
    v_dot2c_f32_bf16 v82, s50, v65
    v_dot2c_f32_bf16 v83, s51, v65
    v_dot2c_f32_bf16 v84, s50, v66
    v_dot2c_f32_bf16 v85, s51, v66
    v_dot2c_f32_bf16 v86, s50, v67
    v_dot2c_f32_bf16 v87, s51, v67
    s_waitcnt vmcnt(2)
    v_dot2c_f32_bf16 v80, s50, v68
    v_dot2c_f32_bf16 v81, s51, v68
    v_dot2c_f32_bf16 v82, s50, v69
    v_dot2c_f32_bf16 v83, s51, v69
    v_dot2c_f32_bf16 v84, s50, v70
    v_dot2c_f32_bf16 v85, s51, v70
    v_dot2c_f32_bf16 v86, s50, v71
    v_dot2c_f32_bf16 v87, s51, v71
    s_waitcnt vmcnt(1)
    v_dot2c_f32_bf16 v80, s50, v72
    v_dot2c_f32_bf16 v81, s51, v72
    v_dot2c_f32_bf16 v82, s50, v73
    v_dot2c_f32_bf16 v83, s51, v73
    v_dot2c_f32_bf16 v84, s50, v74
    v_dot2c_f32_bf16 v85, s51, v74
    v_dot2c_f32_bf16 v86, s50, v75
    v_dot2c_f32_bf16 v87, s51, v75
    s_waitcnt vmcnt(0)
    v_dot2c_f32_bf16 v80, s50, v76
    v_dot2c_f32_bf16 v81, s51, v76
    v_dot2c_f32_bf16 v82, s50, v77
    v_dot2c_f32_bf16 v83, s51, v77
    v_dot2c_f32_bf16 v84, s50, v78
    v_dot2c_f32_bf16 v85, s51, v78
    v_dot2c_f32_bf16 v86, s50, v79
    v_dot2c_f32_bf16 v87, s51, v79
    v_cvt_pk_bf16_f32 v88, v80, v81
    v_cvt_pk_bf16_f32 v89, v82, v83
    v_cvt_pk_bf16_f32 v90, v84, v85
    v_cvt_pk_bf16_f32 v91, v86, v87
    ds_write_b128 v7, v[88:91]
    s_waitcnt lgkmcnt(0)
    s_barrier
    ds_read_b128 v[96:99], v6 offset:0
    ds_read_b128 v[100:103], v6 offset:1024
    ds_read_b128 v[104:107], v6 offset:2048
    ds_read_b128 v[108:111], v6 offset:3072
    s_waitcnt lgkmcnt(3)
    v_mfma_f32_32x32x16_bf16 v[40:55], v[96:99], v[144:147], 0
    s_waitcnt lgkmcnt(2)
    v_mfma_f32_32x32x16_bf16 v[40:55], v[100:103], v[148:151], v[40:55]
    s_waitcnt lgkmcnt(1)
    v_mfma_f32_32x32x16_bf16 v[40:55], v[104:107], v[152:155], v[40:55]
    s_waitcnt lgkmcnt(0)
    v_mfma_f32_32x32x16_bf16 v[40:55], v[108:111], v[156:159], v[40:55]
    s_nop 11
    v_mov_b32 v16, v52
    s_nop 1
    v_permlane32_swap_b32 v52, v16
    v_add_f32 v16, 0x358637bd, v16
    v_rcp_f32 v16, v16
    s_nop 0
    v_pk_mul_f32 v[40:41], v[40:41], v[16:17] op_sel_hi:[1,0]
    v_cvt_pk_bf16_f32 v24, v40, v41
    v_pk_mul_f32 v[42:43], v[42:43], v[16:17] op_sel_hi:[1,0]
    v_cvt_pk_bf16_f32 v25, v42, v43
    v_pk_mul_f32 v[44:45], v[44:45], v[16:17] op_sel_hi:[1,0]
    v_cvt_pk_bf16_f32 v26, v44, v45
    v_pk_mul_f32 v[46:47], v[46:47], v[16:17] op_sel_hi:[1,0]
    v_cvt_pk_bf16_f32 v27, v46, v47
    v_pk_mul_f32 v[48:49], v[48:49], v[16:17] op_sel_hi:[1,0]
    v_cvt_pk_bf16_f32 v28, v48, v49
    v_pk_mul_f32 v[50:51], v[50:51], v[16:17] op_sel_hi:[1,0]
    v_cvt_pk_bf16_f32 v29, v50, v51
    v_pk_mul_f32 v[52:53], v[52:53], v[16:17] op_sel_hi:[1,0]
    v_cvt_pk_bf16_f32 v30, v52, v53
    v_pk_mul_f32 v[54:55], v[54:55], v[16:17] op_sel_hi:[1,0]
    v_cvt_pk_bf16_f32 v31, v54, v55
    v_cndmask_b32 v30, v30, 0, s[46:47]
    v_cndmask_b32 v31, v31, 0, s[46:47]
    s_cmp_eq_u32 s6, 1
    buffer_store_dwordx4 v[24:27], v1, s[8:11], s38 offen sc1
    buffer_store_dwordx4 v[28:31], v1, s[8:11], s38 offen offset:1024 sc1
    s_cmp_lt_u32 s74, 4
    s_cbranch_scc0 adaLN_cond__linear_kernel_hedgehog__glu_gated_bilinear__prompt_kernel_skip_26
    v_lshlrev_b32 v136, 16, v232
    v_and_b32 v137, 0xffff0000, v232
    v_lshlrev_b32 v138, 16, v233
    v_and_b32 v139, 0xffff0000, v233
    v_lshlrev_b32 v140, 16, v234
    v_and_b32 v141, 0xffff0000, v234
    v_lshlrev_b32 v142, 16, v235
    v_and_b32 v143, 0xffff0000, v235
    v_lshlrev_b32 v144, 16, v236
    v_and_b32 v145, 0xffff0000, v236
    v_lshlrev_b32 v146, 16, v237
    v_and_b32 v147, 0xffff0000, v237
    v_lshlrev_b32 v148, 16, v238
    v_and_b32 v149, 0xffff0000, v238
    v_lshlrev_b32 v150, 16, v239
    v_and_b32 v151, 0xffff0000, v239
    s_cmp_eq_u32 s78, 3
    s_cselect_b32 s33, 1, 0
    s_add_u32 s33, s33, s3
    s_lshl_b32 s33, s33, 6
    v_bfe_u32 v4, v0, 2, 2
    v_lshlrev_b32 v5, 6, v4
    v_xor_b32 v5, s33, v5
    v_lshl_add_u32 v4, v3, 2, v4
    v_lshl_add_u32 v5, v4, 8, v5
    v_bfe_u32 v4, v0, 4, 1
    v_lshl_add_u32 v5, v4, 5, v5
    v_and_b32 v4, 3, v0
    v_lshl_add_u32 v10, v4, 3, v5
    v_add_u32 v10, 35840, v10
    v_add_u32 v11, 0xe000, v10
    ds_read_b64_tr_b16 a[128:129], v10 offset:0
    ds_read_b64_tr_b16 a[130:131], v10 offset:2048
    ds_read_b64_tr_b16 a[132:133], v10 offset:4096
    ds_read_b64_tr_b16 a[134:135], v10 offset:6144
    ds_read_b64_tr_b16 a[136:137], v10 offset:7168
    ds_read_b64_tr_b16 a[138:139], v10 offset:9216
    ds_read_b64_tr_b16 a[140:141], v10 offset:11264
    ds_read_b64_tr_b16 a[142:143], v10 offset:13312
    ds_read_b64_tr_b16 a[144:145], v10 offset:14336
    ds_read_b64_tr_b16 a[146:147], v10 offset:16384
    ds_read_b64_tr_b16 a[148:149], v10 offset:18432
    ds_read_b64_tr_b16 a[150:151], v10 offset:20480
    ds_read_b64_tr_b16 a[152:153], v10 offset:21504
    ds_read_b64_tr_b16 a[154:155], v10 offset:23552
    ds_read_b64_tr_b16 a[156:157], v10 offset:25600
    ds_read_b64_tr_b16 a[158:159], v10 offset:27648
    ds_read_b64_tr_b16 a[160:161], v10 offset:28672
    ds_read_b64_tr_b16 a[162:163], v10 offset:30720
    ds_read_b64_tr_b16 a[164:165], v10 offset:32768
    ds_read_b64_tr_b16 a[166:167], v10 offset:34816
adaLN_cond__linear_kernel_hedgehog__glu_gated_bilinear__prompt_kernel_skip_26:
    s_waitcnt vmcnt(0)
    v_mov_b32 v4, s28
    v_mov_b32 v5, 0
    s_cmp_eq_u32 s6, 1
    s_mov_b64 exec, 1
    buffer_store_dword v4, v5, s[8:11], s39 offen sc1
    s_mov_b64 exec, -1
    s_cmp_lt_u32 s74, 4
    s_cbranch_scc0 adaLN_cond__linear_kernel_hedgehog__glu_gated_bilinear__prompt_kernel_skip_27
    ds_read_b64_tr_b16 a[168:169], v10 offset:35840
    ds_read_b64_tr_b16 a[170:171], v10 offset:37888
    ds_read_b64_tr_b16 a[172:173], v10 offset:39936
    ds_read_b64_tr_b16 a[174:175], v10 offset:41984
    ds_read_b64_tr_b16 a[176:177], v10 offset:43008
    ds_read_b64_tr_b16 a[178:179], v10 offset:45056
    ds_read_b64_tr_b16 a[180:181], v10 offset:47104
    ds_read_b64_tr_b16 a[182:183], v10 offset:49152
    ds_read_b64_tr_b16 a[184:185], v10 offset:50176
    ds_read_b64_tr_b16 a[186:187], v10 offset:52224
    ds_read_b64_tr_b16 a[188:189], v10 offset:54272
    ds_read_b64_tr_b16 a[190:191], v10 offset:56320
    ds_read_b64_tr_b16 a[192:193], v11 offset:0
    ds_read_b64_tr_b16 a[194:195], v11 offset:2048
    ds_read_b64_tr_b16 a[196:197], v11 offset:4096
    ds_read_b64_tr_b16 a[198:199], v11 offset:6144
    ds_read_b64_tr_b16 a[200:201], v11 offset:7168
    ds_read_b64_tr_b16 a[202:203], v11 offset:9216
    ds_read_b64_tr_b16 a[204:205], v11 offset:11264
    ds_read_b64_tr_b16 a[206:207], v11 offset:13312
    ds_read_b64_tr_b16 a[208:209], v11 offset:14336
    ds_read_b64_tr_b16 a[210:211], v11 offset:16384
    ds_read_b64_tr_b16 a[212:213], v11 offset:18432
    ds_read_b64_tr_b16 a[214:215], v11 offset:20480
    ds_read_b64_tr_b16 a[216:217], v11 offset:21504
    ds_read_b64_tr_b16 a[218:219], v11 offset:23552
    ds_read_b64_tr_b16 a[220:221], v11 offset:25600
    ds_read_b64_tr_b16 a[222:223], v11 offset:27648
    ds_read_b64_tr_b16 a[224:225], v11 offset:28672
    ds_read_b64_tr_b16 a[226:227], v11 offset:30720
    ds_read_b64_tr_b16 a[228:229], v11 offset:32768
    ds_read_b64_tr_b16 a[230:231], v11 offset:34816
    ds_read_b64_tr_b16 a[232:233], v11 offset:35840
    ds_read_b64_tr_b16 a[234:235], v11 offset:37888
    ds_read_b64_tr_b16 a[236:237], v11 offset:39936
    ds_read_b64_tr_b16 a[238:239], v11 offset:41984
    ds_read_b64_tr_b16 a[240:241], v11 offset:43008
    ds_read_b64_tr_b16 a[242:243], v11 offset:45056
    ds_read_b64_tr_b16 a[244:245], v11 offset:47104
    ds_read_b64_tr_b16 a[246:247], v11 offset:49152
    ds_read_b64_tr_b16 a[248:249], v11 offset:50176
    ds_read_b64_tr_b16 a[250:251], v11 offset:52224
    ds_read_b64_tr_b16 a[252:253], v11 offset:54272
    ds_read_b64_tr_b16 a[254:255], v11 offset:56320
adaLN_cond__linear_kernel_hedgehog__glu_gated_bilinear__prompt_kernel_skip_27:
    s_waitcnt lgkmcnt(0)
    s_barrier
    s_cmp_lt_u32 s74, 4
    s_cbranch_scc0 adaLN_cond__linear_kernel_hedgehog__glu_gated_bilinear__prompt_kernel_skip_28
    v_lshlrev_b32 v5, 7, v3
    s_lshl_b32 s46, s73, 8
    s_add_u32 s46, s46, 0x6000
    s_add_u32 s47, s46, 0x1000
    buffer_load_dwordx4 v[176:179], v5, s[8:11], s46 offen offset:0 sc1
    buffer_load_dwordx4 v[180:183], v5, s[8:11], s46 offen offset:16 sc1
    buffer_load_dwordx4 v[184:187], v5, s[8:11], s46 offen offset:32 sc1
    buffer_load_dwordx4 v[188:191], v5, s[8:11], s46 offen offset:48 sc1
    buffer_load_dwordx4 v[192:195], v5, s[8:11], s46 offen offset:64 sc1
    buffer_load_dwordx4 v[196:199], v5, s[8:11], s46 offen offset:80 sc1
    buffer_load_dwordx4 v[200:203], v5, s[8:11], s46 offen offset:96 sc1
    buffer_load_dwordx4 v[204:207], v5, s[8:11], s46 offen offset:112 sc1
    buffer_load_dwordx4 v[208:211], v5, s[8:11], s47 offen offset:0 sc1
    buffer_load_dwordx4 v[212:215], v5, s[8:11], s47 offen offset:16 sc1
    buffer_load_dwordx4 v[216:219], v5, s[8:11], s47 offen offset:32 sc1
    buffer_load_dwordx4 v[220:223], v5, s[8:11], s47 offen offset:48 sc1
    buffer_load_dwordx4 v[224:227], v5, s[8:11], s47 offen offset:64 sc1
    buffer_load_dwordx4 v[228:231], v5, s[8:11], s47 offen offset:80 sc1
    buffer_load_dwordx4 v[232:235], v5, s[8:11], s47 offen offset:96 sc1
    buffer_load_dwordx4 v[236:239], v5, s[8:11], s47 offen offset:112 sc1
    v_lshlrev_b32 v5, 7, v3
    s_lshl_b32 s50, s73, 8
    s_add_u32 s50, s50, 0xa000
    s_add_u32 s51, s50, 0x1000
    buffer_load_dwordx4 v[72:75], v5, s[8:11], s50 offen offset:0 sc1
    buffer_load_dwordx4 v[76:79], v5, s[8:11], s50 offen offset:16 sc1
    buffer_load_dwordx4 v[80:83], v5, s[8:11], s50 offen offset:32 sc1
    buffer_load_dwordx4 v[84:87], v5, s[8:11], s50 offen offset:48 sc1
    buffer_load_dwordx4 v[88:91], v5, s[8:11], s50 offen offset:64 sc1
    buffer_load_dwordx4 v[92:95], v5, s[8:11], s50 offen offset:80 sc1
    buffer_load_dwordx4 v[96:99], v5, s[8:11], s50 offen offset:96 sc1
    buffer_load_dwordx4 v[100:103], v5, s[8:11], s50 offen offset:112 sc1
    buffer_load_dwordx4 v[104:107], v5, s[8:11], s51 offen offset:0 sc1
    buffer_load_dwordx4 v[108:111], v5, s[8:11], s51 offen offset:16 sc1
    buffer_load_dwordx4 v[112:115], v5, s[8:11], s51 offen offset:32 sc1
    buffer_load_dwordx4 v[116:119], v5, s[8:11], s51 offen offset:48 sc1
    buffer_load_dwordx4 v[120:123], v5, s[8:11], s51 offen offset:64 sc1
    buffer_load_dwordx4 v[124:127], v5, s[8:11], s51 offen offset:80 sc1
    buffer_load_dwordx4 v[128:131], v5, s[8:11], s51 offen offset:96 sc1
    buffer_load_dwordx4 v[132:135], v5, s[8:11], s51 offen offset:112 sc1
adaLN_cond__linear_kernel_hedgehog__glu_gated_bilinear__prompt_kernel_skip_28:
    s_add_u32 s71, s70, s97
    s_add_u32 m0, s75, 0
    s_nop 0
    buffer_load_dwordx4 v240, s[24:27], s71 offen lds
    s_add_u32 m0, s75, 1024
    s_nop 0
    buffer_load_dwordx4 v241, s[24:27], s71 offen lds
    s_lshl_b32 s38, s72, 8
    s_lshl_b32 s39, s3, 6
    s_add_u32 s38, s38, s39
    s_add_u32 s38, s38, 0x20000
    s_lshl_b32 s39, s72, 15
    s_lshl_b32 s40, s3, 13
    s_add_u32 s39, s39, s40
    s_add_u32 s39, s39, 0x720000
    s_add_u32 s40, s39, 4096
    s_lshl_b32 s36, s3, 13
    v_and_b32 v4, 0x30, v1
    s_mov_b32 s33, 40000
adaLN_cond__linear_kernel_hedgehog__glu_gated_bilinear__prompt_kernel_poll_29:
    buffer_load_dword v12, v4, s[8:11], s38 offen sc1
    s_waitcnt vmcnt(0)
    v_xor_b32 v13, s28, v12
    v_cmp_ne_u32 vcc, 0, v13
    s_sub_u32 s33, s33, 1
    s_cbranch_scc1 adaLN_cond__linear_kernel_hedgehog__glu_gated_bilinear__prompt_kernel_pollx_30
    s_cbranch_vccnz adaLN_cond__linear_kernel_hedgehog__glu_gated_bilinear__prompt_kernel_poll_29
adaLN_cond__linear_kernel_hedgehog__glu_gated_bilinear__prompt_kernel_pollx_30:
    s_add_u32 m0, s36, 115200
    s_nop 0
    buffer_load_dwordx4 v1, s[8:11], s39 offen offset:0 sc1 lds
    buffer_load_dwordx4 v1, s[8:11], s39 offen offset:1024 sc1 lds
    buffer_load_dwordx4 v1, s[8:11], s39 offen offset:2048 sc1 lds
    buffer_load_dwordx4 v1, s[8:11], s39 offen offset:3072 sc1 lds
    s_add_u32 m0, s36, 119296
    s_nop 0
    buffer_load_dwordx4 v1, s[8:11], s40 offen offset:0 sc1 lds
    buffer_load_dwordx4 v1, s[8:11], s40 offen offset:1024 sc1 lds
    buffer_load_dwordx4 v1, s[8:11], s40 offen offset:2048 sc1 lds
    buffer_load_dwordx4 v1, s[8:11], s40 offen offset:3072 sc1 lds
    s_add_u32 m0, s75, 2048
    s_nop 0
    buffer_load_dwordx4 v242, s[24:27], s71 offen lds
    s_add_u32 m0, s75, 3072
    s_nop 0
    buffer_load_dwordx4 v243, s[24:27], s71 offen lds
    s_cmp_lt_u32 s74, 4
    s_cbranch_scc0 adaLN_cond__linear_kernel_hedgehog__glu_gated_bilinear__prompt_kernel_skip_31
    v_xor_b32 v4, s28, v177
    v_bitop3_b32 v4, v4, v179, s28 bitop3:0xf6
    v_bitop3_b32 v4, v4, v181, s28 bitop3:0xf6
    v_bitop3_b32 v4, v4, v183, s28 bitop3:0xf6
    v_bitop3_b32 v4, v4, v185, s28 bitop3:0xf6
    v_bitop3_b32 v4, v4, v187, s28 bitop3:0xf6
    v_bitop3_b32 v4, v4, v189, s28 bitop3:0xf6
    v_bitop3_b32 v4, v4, v191, s28 bitop3:0xf6
    v_bitop3_b32 v4, v4, v193, s28 bitop3:0xf6
    v_bitop3_b32 v4, v4, v195, s28 bitop3:0xf6
    v_bitop3_b32 v4, v4, v197, s28 bitop3:0xf6
    v_bitop3_b32 v4, v4, v199, s28 bitop3:0xf6
    v_bitop3_b32 v4, v4, v201, s28 bitop3:0xf6
    v_bitop3_b32 v4, v4, v203, s28 bitop3:0xf6
    v_bitop3_b32 v4, v4, v205, s28 bitop3:0xf6
    v_bitop3_b32 v4, v4, v207, s28 bitop3:0xf6
    v_bitop3_b32 v4, v4, v209, s28 bitop3:0xf6
    v_bitop3_b32 v4, v4, v211, s28 bitop3:0xf6
    v_bitop3_b32 v4, v4, v213, s28 bitop3:0xf6
    v_bitop3_b32 v4, v4, v215, s28 bitop3:0xf6
    v_bitop3_b32 v4, v4, v217, s28 bitop3:0xf6
    v_bitop3_b32 v4, v4, v219, s28 bitop3:0xf6
    v_bitop3_b32 v4, v4, v221, s28 bitop3:0xf6
    v_bitop3_b32 v4, v4, v223, s28 bitop3:0xf6
    v_bitop3_b32 v4, v4, v225, s28 bitop3:0xf6
    v_bitop3_b32 v4, v4, v227, s28 bitop3:0xf6
    v_bitop3_b32 v4, v4, v229, s28 bitop3:0xf6
    v_bitop3_b32 v4, v4, v231, s28 bitop3:0xf6
    v_bitop3_b32 v4, v4, v233, s28 bitop3:0xf6
    v_bitop3_b32 v4, v4, v235, s28 bitop3:0xf6
    v_bitop3_b32 v4, v4, v237, s28 bitop3:0xf6
    v_bitop3_b32 v4, v4, v239, s28 bitop3:0xf6
    v_cmp_ne_u32 vcc, 0, v4
    s_nop 1
    s_cbranch_vccz adaLN_cond__linear_kernel_hedgehog__glu_gated_bilinear__prompt_kernel_skip_32
    s_mov_b32 s33, 40000
adaLN_cond__linear_kernel_hedgehog__glu_gated_bilinear__prompt_kernel_poll_33:
    buffer_load_dwordx4 v[176:179], v5, s[8:11], s46 offen offset:0 sc1
    buffer_load_dwordx4 v[180:183], v5, s[8:11], s46 offen offset:16 sc1
    buffer_load_dwordx4 v[184:187], v5, s[8:11], s46 offen offset:32 sc1
    buffer_load_dwordx4 v[188:191], v5, s[8:11], s46 offen offset:48 sc1
    buffer_load_dwordx4 v[192:195], v5, s[8:11], s46 offen offset:64 sc1
    buffer_load_dwordx4 v[196:199], v5, s[8:11], s46 offen offset:80 sc1
    buffer_load_dwordx4 v[200:203], v5, s[8:11], s46 offen offset:96 sc1
    buffer_load_dwordx4 v[204:207], v5, s[8:11], s46 offen offset:112 sc1
    buffer_load_dwordx4 v[208:211], v5, s[8:11], s47 offen offset:0 sc1
    buffer_load_dwordx4 v[212:215], v5, s[8:11], s47 offen offset:16 sc1
    buffer_load_dwordx4 v[216:219], v5, s[8:11], s47 offen offset:32 sc1
    buffer_load_dwordx4 v[220:223], v5, s[8:11], s47 offen offset:48 sc1
    buffer_load_dwordx4 v[224:227], v5, s[8:11], s47 offen offset:64 sc1
    buffer_load_dwordx4 v[228:231], v5, s[8:11], s47 offen offset:80 sc1
    buffer_load_dwordx4 v[232:235], v5, s[8:11], s47 offen offset:96 sc1
    buffer_load_dwordx4 v[236:239], v5, s[8:11], s47 offen offset:112 sc1
    s_waitcnt vmcnt(0)
    v_xor_b32 v4, s28, v177
    v_bitop3_b32 v4, v4, v179, s28 bitop3:0xf6
    v_bitop3_b32 v4, v4, v181, s28 bitop3:0xf6
    v_bitop3_b32 v4, v4, v183, s28 bitop3:0xf6
    v_bitop3_b32 v4, v4, v185, s28 bitop3:0xf6
    v_bitop3_b32 v4, v4, v187, s28 bitop3:0xf6
    v_bitop3_b32 v4, v4, v189, s28 bitop3:0xf6
    v_bitop3_b32 v4, v4, v191, s28 bitop3:0xf6
    v_bitop3_b32 v4, v4, v193, s28 bitop3:0xf6
    v_bitop3_b32 v4, v4, v195, s28 bitop3:0xf6
    v_bitop3_b32 v4, v4, v197, s28 bitop3:0xf6
    v_bitop3_b32 v4, v4, v199, s28 bitop3:0xf6
    v_bitop3_b32 v4, v4, v201, s28 bitop3:0xf6
    v_bitop3_b32 v4, v4, v203, s28 bitop3:0xf6
    v_bitop3_b32 v4, v4, v205, s28 bitop3:0xf6
    v_bitop3_b32 v4, v4, v207, s28 bitop3:0xf6
    v_bitop3_b32 v4, v4, v209, s28 bitop3:0xf6
    v_bitop3_b32 v4, v4, v211, s28 bitop3:0xf6
    v_bitop3_b32 v4, v4, v213, s28 bitop3:0xf6
    v_bitop3_b32 v4, v4, v215, s28 bitop3:0xf6
    v_bitop3_b32 v4, v4, v217, s28 bitop3:0xf6
    v_bitop3_b32 v4, v4, v219, s28 bitop3:0xf6
    v_bitop3_b32 v4, v4, v221, s28 bitop3:0xf6
    v_bitop3_b32 v4, v4, v223, s28 bitop3:0xf6
    v_bitop3_b32 v4, v4, v225, s28 bitop3:0xf6
    v_bitop3_b32 v4, v4, v227, s28 bitop3:0xf6
    v_bitop3_b32 v4, v4, v229, s28 bitop3:0xf6
    v_bitop3_b32 v4, v4, v231, s28 bitop3:0xf6
    v_bitop3_b32 v4, v4, v233, s28 bitop3:0xf6
    v_bitop3_b32 v4, v4, v235, s28 bitop3:0xf6
    v_bitop3_b32 v4, v4, v237, s28 bitop3:0xf6
    v_bitop3_b32 v4, v4, v239, s28 bitop3:0xf6
    v_cmp_ne_u32 vcc, 0, v4
    s_sub_u32 s33, s33, 1
    s_cbranch_scc1 adaLN_cond__linear_kernel_hedgehog__glu_gated_bilinear__prompt_kernel_pollx_34
    s_cbranch_vccnz adaLN_cond__linear_kernel_hedgehog__glu_gated_bilinear__prompt_kernel_poll_33
adaLN_cond__linear_kernel_hedgehog__glu_gated_bilinear__prompt_kernel_pollx_34:
adaLN_cond__linear_kernel_hedgehog__glu_gated_bilinear__prompt_kernel_skip_32:
    v_add_f32 v176, v176, v208
    v_add_f32 v178, v178, v210
    v_add_f32 v180, v180, v212
    v_add_f32 v182, v182, v214
    v_add_f32 v184, v184, v216
    v_add_f32 v186, v186, v218
    v_add_f32 v188, v188, v220
    v_add_f32 v190, v190, v222
    v_add_f32 v192, v192, v224
    v_add_f32 v194, v194, v226
    v_add_f32 v196, v196, v228
    v_add_f32 v198, v198, v230
    v_add_f32 v200, v200, v232
    v_add_f32 v202, v202, v234
    v_add_f32 v204, v204, v236
    v_add_f32 v206, v206, v238
    v_cvt_pk_bf16_f32 v177, v176, v178
    v_lshlrev_b32 v152, 16, v177
    v_and_b32 v153, 0xffff0000, v177
    v_cvt_pk_bf16_f32 v181, v180, v182
    v_lshlrev_b32 v154, 16, v181
    v_and_b32 v155, 0xffff0000, v181
    v_cvt_pk_bf16_f32 v185, v184, v186
    v_lshlrev_b32 v156, 16, v185
    v_and_b32 v157, 0xffff0000, v185
    v_cvt_pk_bf16_f32 v189, v188, v190
    v_lshlrev_b32 v158, 16, v189
    v_and_b32 v159, 0xffff0000, v189
    v_cvt_pk_bf16_f32 v193, v192, v194
    v_lshlrev_b32 v160, 16, v193
    v_and_b32 v161, 0xffff0000, v193
    v_cvt_pk_bf16_f32 v197, v196, v198
    v_lshlrev_b32 v162, 16, v197
    v_and_b32 v163, 0xffff0000, v197
    v_cvt_pk_bf16_f32 v201, v200, v202
    v_lshlrev_b32 v164, 16, v201
    v_and_b32 v165, 0xffff0000, v201
    v_cvt_pk_bf16_f32 v205, v204, v206
    v_lshlrev_b32 v166, 16, v205
    v_and_b32 v167, 0xffff0000, v205
    v_xor_b32 v4, s28, v73
    v_bitop3_b32 v4, v4, v75, s28 bitop3:0xf6
    v_bitop3_b32 v4, v4, v77, s28 bitop3:0xf6
    v_bitop3_b32 v4, v4, v79, s28 bitop3:0xf6
    v_bitop3_b32 v4, v4, v81, s28 bitop3:0xf6
    v_bitop3_b32 v4, v4, v83, s28 bitop3:0xf6
    v_bitop3_b32 v4, v4, v85, s28 bitop3:0xf6
    v_bitop3_b32 v4, v4, v87, s28 bitop3:0xf6
    v_bitop3_b32 v4, v4, v89, s28 bitop3:0xf6
    v_bitop3_b32 v4, v4, v91, s28 bitop3:0xf6
    v_bitop3_b32 v4, v4, v93, s28 bitop3:0xf6
    v_bitop3_b32 v4, v4, v95, s28 bitop3:0xf6
    v_bitop3_b32 v4, v4, v97, s28 bitop3:0xf6
    v_bitop3_b32 v4, v4, v99, s28 bitop3:0xf6
    v_bitop3_b32 v4, v4, v101, s28 bitop3:0xf6
    v_bitop3_b32 v4, v4, v103, s28 bitop3:0xf6
    v_bitop3_b32 v4, v4, v105, s28 bitop3:0xf6
    v_bitop3_b32 v4, v4, v107, s28 bitop3:0xf6
    v_bitop3_b32 v4, v4, v109, s28 bitop3:0xf6
    v_bitop3_b32 v4, v4, v111, s28 bitop3:0xf6
    v_bitop3_b32 v4, v4, v113, s28 bitop3:0xf6
    v_bitop3_b32 v4, v4, v115, s28 bitop3:0xf6
    v_bitop3_b32 v4, v4, v117, s28 bitop3:0xf6
    v_bitop3_b32 v4, v4, v119, s28 bitop3:0xf6
    v_bitop3_b32 v4, v4, v121, s28 bitop3:0xf6
    v_bitop3_b32 v4, v4, v123, s28 bitop3:0xf6
    v_bitop3_b32 v4, v4, v125, s28 bitop3:0xf6
    v_bitop3_b32 v4, v4, v127, s28 bitop3:0xf6
    v_bitop3_b32 v4, v4, v129, s28 bitop3:0xf6
    v_bitop3_b32 v4, v4, v131, s28 bitop3:0xf6
    v_bitop3_b32 v4, v4, v133, s28 bitop3:0xf6
    v_bitop3_b32 v4, v4, v135, s28 bitop3:0xf6
    v_cmp_ne_u32 vcc, 0, v4
    s_nop 1
    s_cbranch_vccz adaLN_cond__linear_kernel_hedgehog__glu_gated_bilinear__prompt_kernel_skip_35
    s_mov_b32 s33, 40000
adaLN_cond__linear_kernel_hedgehog__glu_gated_bilinear__prompt_kernel_poll_36:
    buffer_load_dwordx4 v[72:75], v5, s[8:11], s50 offen offset:0 sc1
    buffer_load_dwordx4 v[76:79], v5, s[8:11], s50 offen offset:16 sc1
    buffer_load_dwordx4 v[80:83], v5, s[8:11], s50 offen offset:32 sc1
    buffer_load_dwordx4 v[84:87], v5, s[8:11], s50 offen offset:48 sc1
    buffer_load_dwordx4 v[88:91], v5, s[8:11], s50 offen offset:64 sc1
    buffer_load_dwordx4 v[92:95], v5, s[8:11], s50 offen offset:80 sc1
    buffer_load_dwordx4 v[96:99], v5, s[8:11], s50 offen offset:96 sc1
    buffer_load_dwordx4 v[100:103], v5, s[8:11], s50 offen offset:112 sc1
    buffer_load_dwordx4 v[104:107], v5, s[8:11], s51 offen offset:0 sc1
    buffer_load_dwordx4 v[108:111], v5, s[8:11], s51 offen offset:16 sc1
    buffer_load_dwordx4 v[112:115], v5, s[8:11], s51 offen offset:32 sc1
    buffer_load_dwordx4 v[116:119], v5, s[8:11], s51 offen offset:48 sc1
    buffer_load_dwordx4 v[120:123], v5, s[8:11], s51 offen offset:64 sc1
    buffer_load_dwordx4 v[124:127], v5, s[8:11], s51 offen offset:80 sc1
    buffer_load_dwordx4 v[128:131], v5, s[8:11], s51 offen offset:96 sc1
    buffer_load_dwordx4 v[132:135], v5, s[8:11], s51 offen offset:112 sc1
    s_waitcnt vmcnt(0)
    v_xor_b32 v4, s28, v73
    v_bitop3_b32 v4, v4, v75, s28 bitop3:0xf6
    v_bitop3_b32 v4, v4, v77, s28 bitop3:0xf6
    v_bitop3_b32 v4, v4, v79, s28 bitop3:0xf6
    v_bitop3_b32 v4, v4, v81, s28 bitop3:0xf6
    v_bitop3_b32 v4, v4, v83, s28 bitop3:0xf6
    v_bitop3_b32 v4, v4, v85, s28 bitop3:0xf6
    v_bitop3_b32 v4, v4, v87, s28 bitop3:0xf6
    v_bitop3_b32 v4, v4, v89, s28 bitop3:0xf6
    v_bitop3_b32 v4, v4, v91, s28 bitop3:0xf6
    v_bitop3_b32 v4, v4, v93, s28 bitop3:0xf6
    v_bitop3_b32 v4, v4, v95, s28 bitop3:0xf6
    v_bitop3_b32 v4, v4, v97, s28 bitop3:0xf6
    v_bitop3_b32 v4, v4, v99, s28 bitop3:0xf6
    v_bitop3_b32 v4, v4, v101, s28 bitop3:0xf6
    v_bitop3_b32 v4, v4, v103, s28 bitop3:0xf6
    v_bitop3_b32 v4, v4, v105, s28 bitop3:0xf6
    v_bitop3_b32 v4, v4, v107, s28 bitop3:0xf6
    v_bitop3_b32 v4, v4, v109, s28 bitop3:0xf6
    v_bitop3_b32 v4, v4, v111, s28 bitop3:0xf6
    v_bitop3_b32 v4, v4, v113, s28 bitop3:0xf6
    v_bitop3_b32 v4, v4, v115, s28 bitop3:0xf6
    v_bitop3_b32 v4, v4, v117, s28 bitop3:0xf6
    v_bitop3_b32 v4, v4, v119, s28 bitop3:0xf6
    v_bitop3_b32 v4, v4, v121, s28 bitop3:0xf6
    v_bitop3_b32 v4, v4, v123, s28 bitop3:0xf6
    v_bitop3_b32 v4, v4, v125, s28 bitop3:0xf6
    v_bitop3_b32 v4, v4, v127, s28 bitop3:0xf6
    v_bitop3_b32 v4, v4, v129, s28 bitop3:0xf6
    v_bitop3_b32 v4, v4, v131, s28 bitop3:0xf6
    v_bitop3_b32 v4, v4, v133, s28 bitop3:0xf6
    v_bitop3_b32 v4, v4, v135, s28 bitop3:0xf6
    v_cmp_ne_u32 vcc, 0, v4
    s_sub_u32 s33, s33, 1
    s_cbranch_scc1 adaLN_cond__linear_kernel_hedgehog__glu_gated_bilinear__prompt_kernel_pollx_37
    s_cbranch_vccnz adaLN_cond__linear_kernel_hedgehog__glu_gated_bilinear__prompt_kernel_poll_36
adaLN_cond__linear_kernel_hedgehog__glu_gated_bilinear__prompt_kernel_pollx_37:
adaLN_cond__linear_kernel_hedgehog__glu_gated_bilinear__prompt_kernel_skip_35:
    v_add_f32 v72, v72, v104
    v_add_f32 v74, v74, v106
    v_add_f32 v76, v76, v108
    v_add_f32 v78, v78, v110
    v_add_f32 v80, v80, v112
    v_add_f32 v82, v82, v114
    v_add_f32 v84, v84, v116
    v_add_f32 v86, v86, v118
    v_add_f32 v88, v88, v120
    v_add_f32 v90, v90, v122
    v_add_f32 v92, v92, v124
    v_add_f32 v94, v94, v126
    v_add_f32 v96, v96, v128
    v_add_f32 v98, v98, v130
    v_add_f32 v100, v100, v132
    v_add_f32 v102, v102, v134
    v_cvt_pk_bf16_f32 v73, v72, v74
    v_lshlrev_b32 v16, 16, v73
    v_and_b32 v17, 0xffff0000, v73
    v_pk_add_f32 v[16:17], v[16:17], 1.0 op_sel_hi:[1,0]
    v_cvt_pk_bf16_f32 v73, v16, v17
    v_lshlrev_b32 v16, 16, v73
    v_and_b32 v17, 0xffff0000, v73
    v_cvt_pk_bf16_f32 v77, v76, v78
    v_lshlrev_b32 v18, 16, v77
    v_and_b32 v19, 0xffff0000, v77
    v_pk_add_f32 v[18:19], v[18:19], 1.0 op_sel_hi:[1,0]
    v_cvt_pk_bf16_f32 v77, v18, v19
    v_lshlrev_b32 v18, 16, v77
    v_and_b32 v19, 0xffff0000, v77
    v_cvt_pk_bf16_f32 v81, v80, v82
    v_lshlrev_b32 v20, 16, v81
    v_and_b32 v21, 0xffff0000, v81
    v_pk_add_f32 v[20:21], v[20:21], 1.0 op_sel_hi:[1,0]
    v_cvt_pk_bf16_f32 v81, v20, v21
    v_lshlrev_b32 v20, 16, v81
    v_and_b32 v21, 0xffff0000, v81
    v_cvt_pk_bf16_f32 v85, v84, v86
    v_lshlrev_b32 v22, 16, v85
    v_and_b32 v23, 0xffff0000, v85
    v_pk_add_f32 v[22:23], v[22:23], 1.0 op_sel_hi:[1,0]
    v_cvt_pk_bf16_f32 v85, v22, v23
    v_lshlrev_b32 v22, 16, v85
    v_and_b32 v23, 0xffff0000, v85
    v_cvt_pk_bf16_f32 v89, v88, v90
    v_lshlrev_b32 v24, 16, v89
    v_and_b32 v25, 0xffff0000, v89
    v_pk_add_f32 v[24:25], v[24:25], 1.0 op_sel_hi:[1,0]
    v_cvt_pk_bf16_f32 v89, v24, v25
    v_lshlrev_b32 v24, 16, v89
    v_and_b32 v25, 0xffff0000, v89
    v_cvt_pk_bf16_f32 v93, v92, v94
    v_lshlrev_b32 v26, 16, v93
    v_and_b32 v27, 0xffff0000, v93
    v_pk_add_f32 v[26:27], v[26:27], 1.0 op_sel_hi:[1,0]
    v_cvt_pk_bf16_f32 v93, v26, v27
    v_lshlrev_b32 v26, 16, v93
    v_and_b32 v27, 0xffff0000, v93
    v_cvt_pk_bf16_f32 v97, v96, v98
    v_lshlrev_b32 v28, 16, v97
    v_and_b32 v29, 0xffff0000, v97
    v_pk_add_f32 v[28:29], v[28:29], 1.0 op_sel_hi:[1,0]
    v_cvt_pk_bf16_f32 v97, v28, v29
    v_lshlrev_b32 v28, 16, v97
    v_and_b32 v29, 0xffff0000, v97
    v_cvt_pk_bf16_f32 v101, v100, v102
    v_lshlrev_b32 v30, 16, v101
    v_and_b32 v31, 0xffff0000, v101
    v_pk_add_f32 v[30:31], v[30:31], 1.0 op_sel_hi:[1,0]
    v_cvt_pk_bf16_f32 v101, v30, v31
    v_lshlrev_b32 v30, 16, v101
    v_and_b32 v31, 0xffff0000, v101
    s_waitcnt vmcnt(2)
adaLN_cond__linear_kernel_hedgehog__glu_gated_bilinear__prompt_kernel_skip_31:
    s_cmp_ge_u32 s74, 4
    s_cbranch_scc0 adaLN_cond__linear_kernel_hedgehog__glu_gated_bilinear__prompt_kernel_skip_38
    s_lshl_b32 s36, s72, 1
    s_and_b32 s33, s78, 1
    s_add_u32 s36, s36, s33
    s_min_u32 s36, s36, 111
    s_cmp_ge_u32 s36, 56
    s_cselect_b32 s20, s60, s58
    s_cselect_b32 s21, s61, s59
    s_cselect_b32 s37, 56, 0
    s_cselect_b32 s50, 256, 0
    s_and_b32 s21, s21, 0xffff
    s_mov_b32 s22, 0x188000
    s_mov_b32 s23, 0x20000
    s_sub_u32 s36, s36, s37
    v_add_u32 v7, 3072, v1
    v_min_u32 v7, 3568, v7
    s_mov_b32 s33, 0xa000
    buffer_load_dwordx4 v[128:131], v1, s[8:11], s33 offen offset:0 sc1
    s_mov_b32 s33, 0xa000
    buffer_load_dwordx4 v[132:135], v1, s[8:11], s33 offen offset:1024 sc1
    s_mov_b32 s33, 0xa000
    buffer_load_dwordx4 v[136:139], v1, s[8:11], s33 offen offset:2048 sc1
    s_mov_b32 s33, 0xa000
    buffer_load_dwordx4 v[140:143], v7, s[8:11], s33 offen offset:0 sc1
    s_mov_b32 s33, 0xb000
    buffer_load_dwordx4 v[144:147], v1, s[8:11], s33 offen offset:0 sc1
    s_mov_b32 s33, 0xb000
    buffer_load_dwordx4 v[148:151], v1, s[8:11], s33 offen offset:1024 sc1
    s_mov_b32 s33, 0xb000
    buffer_load_dwordx4 v[152:155], v1, s[8:11], s33 offen offset:2048 sc1
    s_mov_b32 s33, 0xb000
    buffer_load_dwordx4 v[156:159], v7, s[8:11], s33 offen offset:0 sc1
    s_mov_b32 s33, 0x8000
    buffer_load_dwordx4 v[160:163], v1, s[8:11], s33 offen offset:0 sc1
    s_mov_b32 s33, 0x8000
    buffer_load_dwordx4 v[164:167], v1, s[8:11], s33 offen offset:1024 sc1
    s_mov_b32 s33, 0x8000
    buffer_load_dwordx4 v[168:171], v1, s[8:11], s33 offen offset:2048 sc1
    s_mov_b32 s33, 0x8000
    buffer_load_dwordx4 v[172:175], v7, s[8:11], s33 offen offset:0 sc1
    s_mov_b32 s33, 0x9000
    buffer_load_dwordx4 v[176:179], v1, s[8:11], s33 offen offset:0 sc1
    s_mov_b32 s33, 0x9000
    buffer_load_dwordx4 v[180:183], v1, s[8:11], s33 offen offset:1024 sc1
    s_mov_b32 s33, 0x9000
    buffer_load_dwordx4 v[184:187], v1, s[8:11], s33 offen offset:2048 sc1
    s_mov_b32 s33, 0x9000
    buffer_load_dwordx4 v[188:191], v7, s[8:11], s33 offen offset:0 sc1
    v_lshrrev_b32 v8, 6, v1
    v_mul_u32_u24 v9, 3584, v8
    v_and_b32 v10, 0x30, v1
    v_add_u32 v9, v9, v10
    s_lshl_b32 s38, s36, 6
    buffer_load_dwordx4 v[16:19], v9, s[20:23], s38 offen
    s_add_u32 s38, s38, 57344
    buffer_load_dwordx4 v[20:23], v9, s[20:23], s38 offen
    s_add_u32 s38, s38, 57344
    buffer_load_dwordx4 v[24:27], v9, s[20:23], s38 offen
    s_add_u32 s38, s38, 57344
    buffer_load_dwordx4 v[28:31], v9, s[20:23], s38 offen
    s_add_u32 s38, s38, 57344
    buffer_load_dwordx4 v[32:35], v9, s[20:23], s38 offen
    s_add_u32 s38, s38, 57344
    buffer_load_dwordx4 v[36:39], v9, s[20:23], s38 offen
    s_add_u32 s38, s38, 57344
    buffer_load_dwordx4 v[40:43], v9, s[20:23], s38 offen
    s_add_u32 s38, s38, 57344
    buffer_load_dwordx4 v[44:47], v9, s[20:23], s38 offen
    s_add_u32 s38, s38, 57344
    buffer_load_dwordx4 v[48:51], v9, s[20:23], s38 offen
    s_add_u32 s38, s38, 57344
    buffer_load_dwordx4 v[52:55], v9, s[20:23], s38 offen
    s_add_u32 s38, s38, 57344
    buffer_load_dwordx4 v[56:59], v9, s[20:23], s38 offen
    s_add_u32 s38, s38, 57344
    buffer_load_dwordx4 v[60:63], v9, s[20:23], s38 offen
    s_add_u32 s38, s38, 57344
    buffer_load_dwordx4 v[64:67], v9, s[20:23], s38 offen
    s_add_u32 s38, s38, 57344
    buffer_load_dwordx4 v[68:71], v9, s[20:23], s38 offen
    s_add_u32 s38, s38, 57344
    buffer_load_dwordx4 v[72:75], v9, s[20:23], s38 offen
    s_add_u32 s38, s38, 57344
    buffer_load_dwordx4 v[76:79], v9, s[20:23], s38 offen
    s_add_u32 s38, s38, 57344
    buffer_load_dwordx4 v[80:83], v9, s[20:23], s38 offen
    s_add_u32 s38, s38, 57344
    buffer_load_dwordx4 v[84:87], v9, s[20:23], s38 offen
    s_add_u32 s38, s38, 57344
    buffer_load_dwordx4 v[88:91], v9, s[20:23], s38 offen
    s_add_u32 s38, s38, 57344
    buffer_load_dwordx4 v[92:95], v9, s[20:23], s38 offen
    s_add_u32 s38, s38, 57344
    buffer_load_dwordx4 v[96:99], v9, s[20:23], s38 offen
    s_add_u32 s38, s38, 57344
    buffer_load_dwordx4 v[100:103], v9, s[20:23], s38 offen
    s_add_u32 s38, s38, 57344
    buffer_load_dwordx4 v[104:107], v9, s[20:23], s38 offen
    s_add_u32 s38, s38, 57344
    buffer_load_dwordx4 v[108:111], v9, s[20:23], s38 offen
    s_add_u32 s38, s38, 57344
    buffer_load_dwordx4 v[112:115], v9, s[20:23], s38 offen
    s_add_u32 s38, s38, 57344
    buffer_load_dwordx4 v[116:119], v9, s[20:23], s38 offen
    s_add_u32 s38, s38, 57344
    buffer_load_dwordx4 v[120:123], v9, s[20:23], s38 offen
    s_add_u32 s38, s38, 57344
    buffer_load_dwordx4 v[124:127], v9, s[20:23], s38 offen
    s_waitcnt vmcnt(46)
adaLN_cond__linear_kernel_hedgehog__glu_gated_bilinear__prompt_kernel_skip_38:
    v_add_u32 v6, 115200, v1
    s_barrier
    s_cmp_ge_u32 s74, 4
    s_cbranch_scc0 adaLN_cond__linear_kernel_hedgehog__glu_gated_bilinear__prompt_kernel_skip_39
    s_add_u32 m0, s75, 4096
    s_nop 0
    buffer_load_dwordx4 v244, s[24:27], s71 offen lds
    s_add_u32 m0, s75, 5120
    s_nop 0
    buffer_load_dwordx4 v245, s[24:27], s71 offen lds
    s_add_u32 m0, s75, 6144
    s_nop 0
    buffer_load_dwordx4 v246, s[24:27], s71 offen lds
    s_add_u32 s97, s97, 229376
    s_cmp_eq_u32 s97, 1605632
    s_cmov_b32 s97, 0
    s_add_u32 s71, s70, s97
    s_add_u32 m0, s75, 28800
    s_nop 0
    buffer_load_dwordx4 v240, s[24:27], s71 offen lds
    s_add_u32 m0, s75, 29824
    s_nop 0
    buffer_load_dwordx4 v241, s[24:27], s71 offen lds
    s_add_u32 m0, s75, 30848
    s_nop 0
    buffer_load_dwordx4 v242, s[24:27], s71 offen lds
    s_add_u32 m0, s75, 31872
    s_nop 0
    buffer_load_dwordx4 v243, s[24:27], s71 offen lds
    s_add_u32 m0, s75, 32896
    s_nop 0
    buffer_load_dwordx4 v244, s[24:27], s71 offen lds
    s_add_u32 m0, s75, 33920
    s_nop 0
    buffer_load_dwordx4 v245, s[24:27], s71 offen lds
    s_add_u32 m0, s75, 34944
    s_nop 0
    buffer_load_dwordx4 v246, s[24:27], s71 offen lds
    s_waitcnt vmcnt(53)
    v_xor_b32 v4, s28, v129
    v_bitop3_b32 v4, v4, v131, s28 bitop3:0xf6
    s_waitcnt vmcnt(52)
    v_bitop3_b32 v4, v4, v133, s28 bitop3:0xf6
    v_bitop3_b32 v4, v4, v135, s28 bitop3:0xf6
    s_waitcnt vmcnt(51)
    v_bitop3_b32 v4, v4, v137, s28 bitop3:0xf6
    v_bitop3_b32 v4, v4, v139, s28 bitop3:0xf6
    s_waitcnt vmcnt(50)
    v_bitop3_b32 v4, v4, v141, s28 bitop3:0xf6
    v_bitop3_b32 v4, v4, v143, s28 bitop3:0xf6
    s_waitcnt vmcnt(49)
    v_bitop3_b32 v4, v4, v145, s28 bitop3:0xf6
    v_bitop3_b32 v4, v4, v147, s28 bitop3:0xf6
    s_waitcnt vmcnt(48)
    v_bitop3_b32 v4, v4, v149, s28 bitop3:0xf6
    v_bitop3_b32 v4, v4, v151, s28 bitop3:0xf6
    s_waitcnt vmcnt(47)
    v_bitop3_b32 v4, v4, v153, s28 bitop3:0xf6
    v_bitop3_b32 v4, v4, v155, s28 bitop3:0xf6
    s_waitcnt vmcnt(46)
    v_bitop3_b32 v4, v4, v157, s28 bitop3:0xf6
    v_bitop3_b32 v4, v4, v159, s28 bitop3:0xf6
    s_waitcnt vmcnt(45)
    v_bitop3_b32 v4, v4, v161, s28 bitop3:0xf6
    v_bitop3_b32 v4, v4, v163, s28 bitop3:0xf6
    s_waitcnt vmcnt(44)
    v_bitop3_b32 v4, v4, v165, s28 bitop3:0xf6
    v_bitop3_b32 v4, v4, v167, s28 bitop3:0xf6
    s_waitcnt vmcnt(43)
    v_bitop3_b32 v4, v4, v169, s28 bitop3:0xf6
    v_bitop3_b32 v4, v4, v171, s28 bitop3:0xf6
    s_waitcnt vmcnt(42)
    v_bitop3_b32 v4, v4, v173, s28 bitop3:0xf6
    v_bitop3_b32 v4, v4, v175, s28 bitop3:0xf6
    s_waitcnt vmcnt(41)
    v_bitop3_b32 v4, v4, v177, s28 bitop3:0xf6
    v_bitop3_b32 v4, v4, v179, s28 bitop3:0xf6
    s_waitcnt vmcnt(40)
    v_bitop3_b32 v4, v4, v181, s28 bitop3:0xf6
    v_bitop3_b32 v4, v4, v183, s28 bitop3:0xf6
    s_waitcnt vmcnt(39)
    v_bitop3_b32 v4, v4, v185, s28 bitop3:0xf6
    v_bitop3_b32 v4, v4, v187, s28 bitop3:0xf6
    s_waitcnt vmcnt(38)
    v_bitop3_b32 v4, v4, v189, s28 bitop3:0xf6
    v_bitop3_b32 v4, v4, v191, s28 bitop3:0xf6
    v_cmp_ne_u32 vcc, 0, v4
    s_nop 1
    s_cbranch_vccz adaLN_cond__linear_kernel_hedgehog__glu_gated_bilinear__prompt_kernel_skip_40
    s_mov_b32 s33, 40000
adaLN_cond__linear_kernel_hedgehog__glu_gated_bilinear__prompt_kernel_poll_41:
    s_mov_b32 s34, 0xa000
    buffer_load_dwordx4 v[128:131], v1, s[8:11], s34 offen offset:0 sc1
    s_mov_b32 s34, 0xa000
    buffer_load_dwordx4 v[132:135], v1, s[8:11], s34 offen offset:1024 sc1
    s_mov_b32 s34, 0xa000
    buffer_load_dwordx4 v[136:139], v1, s[8:11], s34 offen offset:2048 sc1
    s_mov_b32 s34, 0xa000
    buffer_load_dwordx4 v[140:143], v7, s[8:11], s34 offen offset:0 sc1
    s_mov_b32 s34, 0xb000
    buffer_load_dwordx4 v[144:147], v1, s[8:11], s34 offen offset:0 sc1
    s_mov_b32 s34, 0xb000
    buffer_load_dwordx4 v[148:151], v1, s[8:11], s34 offen offset:1024 sc1
    s_mov_b32 s34, 0xb000
    buffer_load_dwordx4 v[152:155], v1, s[8:11], s34 offen offset:2048 sc1
    s_mov_b32 s34, 0xb000
    buffer_load_dwordx4 v[156:159], v7, s[8:11], s34 offen offset:0 sc1
    s_mov_b32 s34, 0x8000
    buffer_load_dwordx4 v[160:163], v1, s[8:11], s34 offen offset:0 sc1
    s_mov_b32 s34, 0x8000
    buffer_load_dwordx4 v[164:167], v1, s[8:11], s34 offen offset:1024 sc1
    s_mov_b32 s34, 0x8000
    buffer_load_dwordx4 v[168:171], v1, s[8:11], s34 offen offset:2048 sc1
    s_mov_b32 s34, 0x8000
    buffer_load_dwordx4 v[172:175], v7, s[8:11], s34 offen offset:0 sc1
    s_mov_b32 s34, 0x9000
    buffer_load_dwordx4 v[176:179], v1, s[8:11], s34 offen offset:0 sc1
    s_mov_b32 s34, 0x9000
    buffer_load_dwordx4 v[180:183], v1, s[8:11], s34 offen offset:1024 sc1
    s_mov_b32 s34, 0x9000
    buffer_load_dwordx4 v[184:187], v1, s[8:11], s34 offen offset:2048 sc1
    s_mov_b32 s34, 0x9000
    buffer_load_dwordx4 v[188:191], v7, s[8:11], s34 offen offset:0 sc1
    s_waitcnt vmcnt(0)
    v_xor_b32 v4, s28, v129
    v_bitop3_b32 v4, v4, v131, s28 bitop3:0xf6
    v_bitop3_b32 v4, v4, v133, s28 bitop3:0xf6
    v_bitop3_b32 v4, v4, v135, s28 bitop3:0xf6
    v_bitop3_b32 v4, v4, v137, s28 bitop3:0xf6
    v_bitop3_b32 v4, v4, v139, s28 bitop3:0xf6
    v_bitop3_b32 v4, v4, v141, s28 bitop3:0xf6
    v_bitop3_b32 v4, v4, v143, s28 bitop3:0xf6
    v_bitop3_b32 v4, v4, v145, s28 bitop3:0xf6
    v_bitop3_b32 v4, v4, v147, s28 bitop3:0xf6
    v_bitop3_b32 v4, v4, v149, s28 bitop3:0xf6
    v_bitop3_b32 v4, v4, v151, s28 bitop3:0xf6
    v_bitop3_b32 v4, v4, v153, s28 bitop3:0xf6
    v_bitop3_b32 v4, v4, v155, s28 bitop3:0xf6
    v_bitop3_b32 v4, v4, v157, s28 bitop3:0xf6
    v_bitop3_b32 v4, v4, v159, s28 bitop3:0xf6
    v_bitop3_b32 v4, v4, v161, s28 bitop3:0xf6
    v_bitop3_b32 v4, v4, v163, s28 bitop3:0xf6
    v_bitop3_b32 v4, v4, v165, s28 bitop3:0xf6
    v_bitop3_b32 v4, v4, v167, s28 bitop3:0xf6
    v_bitop3_b32 v4, v4, v169, s28 bitop3:0xf6
    v_bitop3_b32 v4, v4, v171, s28 bitop3:0xf6
    v_bitop3_b32 v4, v4, v173, s28 bitop3:0xf6
    v_bitop3_b32 v4, v4, v175, s28 bitop3:0xf6
    v_bitop3_b32 v4, v4, v177, s28 bitop3:0xf6
    v_bitop3_b32 v4, v4, v179, s28 bitop3:0xf6
    v_bitop3_b32 v4, v4, v181, s28 bitop3:0xf6
    v_bitop3_b32 v4, v4, v183, s28 bitop3:0xf6
    v_bitop3_b32 v4, v4, v185, s28 bitop3:0xf6
    v_bitop3_b32 v4, v4, v187, s28 bitop3:0xf6
    v_bitop3_b32 v4, v4, v189, s28 bitop3:0xf6
    v_bitop3_b32 v4, v4, v191, s28 bitop3:0xf6
    v_cmp_ne_u32 vcc, 0, v4
    s_sub_u32 s33, s33, 1
    s_cbranch_scc1 adaLN_cond__linear_kernel_hedgehog__glu_gated_bilinear__prompt_kernel_pollx_42
    s_cbranch_vccnz adaLN_cond__linear_kernel_hedgehog__glu_gated_bilinear__prompt_kernel_poll_41
adaLN_cond__linear_kernel_hedgehog__glu_gated_bilinear__prompt_kernel_pollx_42:
adaLN_cond__linear_kernel_hedgehog__glu_gated_bilinear__prompt_kernel_skip_40:
    v_add_u32 v11, 151552, v1
    v_add_u32 v12, 151552, v7
    v_add_f32 v128, v128, v144
    v_add_f32 v130, v130, v146
    v_add_f32 v160, v160, v176
    v_add_f32 v162, v162, v178
    v_cvt_pk_bf16_f32 v4, v128, v130
    v_cvt_pk_bf16_f32 v5, v160, v162
    v_lshlrev_b32 v128, 16, v4
    v_and_b32 v130, 0xffff0000, v4
    v_lshlrev_b32 v129, 16, v5
    v_and_b32 v131, 0xffff0000, v5
    v_add_f32 v128, 1.0, v128
    v_add_f32 v130, 1.0, v130
    v_cvt_pk_bf16_f32 v4, v128, v130
    v_lshlrev_b32 v128, 16, v4
    v_and_b32 v130, 0xffff0000, v4
    ds_write_b128 v11, v[128:131] offset:0
    v_add_f32 v132, v132, v148
    v_add_f32 v134, v134, v150
    v_add_f32 v164, v164, v180
    v_add_f32 v166, v166, v182
    v_cvt_pk_bf16_f32 v4, v132, v134
    v_cvt_pk_bf16_f32 v5, v164, v166
    v_lshlrev_b32 v132, 16, v4
    v_and_b32 v134, 0xffff0000, v4
    v_lshlrev_b32 v133, 16, v5
    v_and_b32 v135, 0xffff0000, v5
    v_add_f32 v132, 1.0, v132
    v_add_f32 v134, 1.0, v134
    v_cvt_pk_bf16_f32 v4, v132, v134
    v_lshlrev_b32 v132, 16, v4
    v_and_b32 v134, 0xffff0000, v4
    ds_write_b128 v11, v[132:135] offset:1024
    v_add_f32 v136, v136, v152
    v_add_f32 v138, v138, v154
    v_add_f32 v168, v168, v184
    v_add_f32 v170, v170, v186
    v_cvt_pk_bf16_f32 v4, v136, v138
    v_cvt_pk_bf16_f32 v5, v168, v170
    v_lshlrev_b32 v136, 16, v4
    v_and_b32 v138, 0xffff0000, v4
    v_lshlrev_b32 v137, 16, v5
    v_and_b32 v139, 0xffff0000, v5
    v_add_f32 v136, 1.0, v136
    v_add_f32 v138, 1.0, v138
    v_cvt_pk_bf16_f32 v4, v136, v138
    v_lshlrev_b32 v136, 16, v4
    v_and_b32 v138, 0xffff0000, v4
    ds_write_b128 v11, v[136:139] offset:2048
    v_add_f32 v140, v140, v156
    v_add_f32 v142, v142, v158
    v_add_f32 v172, v172, v188
    v_add_f32 v174, v174, v190
    v_cvt_pk_bf16_f32 v4, v140, v142
    v_cvt_pk_bf16_f32 v5, v172, v174
    v_lshlrev_b32 v140, 16, v4
    v_and_b32 v142, 0xffff0000, v4
    v_lshlrev_b32 v141, 16, v5
    v_and_b32 v143, 0xffff0000, v5
    v_add_f32 v140, 1.0, v140
    v_add_f32 v142, 1.0, v142
    v_cvt_pk_bf16_f32 v4, v140, v142
    v_lshlrev_b32 v140, 16, v4
    v_and_b32 v142, 0xffff0000, v4
    ds_write_b128 v12, v[140:143] offset:0
    v_bfe_u32 v4, v8, 2, 1
    v_and_b32 v5, 3, v8
    v_lshl_add_u32 v4, v4, 4, v5
    v_lshrrev_b32 v5, 3, v8
    v_lshl_add_u32 v4, v5, 2, v4
    v_lshlrev_b32 v4, 3, v4
    v_add_u32 v4, 151552, v4
    s_waitcnt lgkmcnt(0)
    ds_read_b64 v[128:129], v4 offset:0
    ds_read_b64 v[130:131], v4 offset:64
    ds_read_b64 v[132:133], v4 offset:256
    ds_read_b64 v[134:135], v4 offset:320
    ds_read_b64 v[136:137], v4 offset:512
    ds_read_b64 v[138:139], v4 offset:576
    ds_read_b64 v[140:141], v4 offset:768
    ds_read_b64 v[142:143], v4 offset:832
    ds_read_b64 v[144:145], v4 offset:1024
    ds_read_b64 v[146:147], v4 offset:1088
    ds_read_b64 v[148:149], v4 offset:1280
    ds_read_b64 v[150:151], v4 offset:1344
    ds_read_b64 v[152:153], v4 offset:1536
    ds_read_b64 v[154:155], v4 offset:1600
    ds_read_b64 v[156:157], v4 offset:1792
    ds_read_b64 v[158:159], v4 offset:1856
    ds_read_b64 v[160:161], v4 offset:2048
    ds_read_b64 v[162:163], v4 offset:2112
    ds_read_b64 v[164:165], v4 offset:2304
    ds_read_b64 v[166:167], v4 offset:2368
    ds_read_b64 v[168:169], v4 offset:2560
    ds_read_b64 v[170:171], v4 offset:2624
    ds_read_b64 v[172:173], v4 offset:2816
    ds_read_b64 v[174:175], v4 offset:2880
    ds_read_b64 v[176:177], v4 offset:3072
    ds_read_b64 v[178:179], v4 offset:3136
    ds_read_b64 v[180:181], v4 offset:3328
    ds_read_b64 v[182:183], v4 offset:3392
    s_waitcnt vmcnt(37)
    v_lshlrev_b32 v192, 16, v16
    v_and_b32 v193, 0xffff0000, v16
    v_lshlrev_b32 v194, 16, v17
    v_and_b32 v195, 0xffff0000, v17
    v_lshlrev_b32 v196, 16, v18
    v_and_b32 v197, 0xffff0000, v18
    v_lshlrev_b32 v198, 16, v19
    v_and_b32 v199, 0xffff0000, v19
    s_waitcnt lgkmcnt(15)
    v_pk_mul_f32 v[220:221], v[192:193], v[128:129] op_sel_hi:[1,0]
    v_pk_mul_f32 v[228:229], v[192:193], v[128:129] op_sel:[0,1] op_sel_hi:[1,1]
    v_pk_mul_f32 v[222:223], v[194:195], v[128:129] op_sel_hi:[1,0]
    v_pk_mul_f32 v[230:231], v[194:195], v[128:129] op_sel:[0,1] op_sel_hi:[1,1]
    v_pk_mul_f32 v[224:225], v[196:197], v[128:129] op_sel_hi:[1,0]
    v_pk_mul_f32 v[232:233], v[196:197], v[128:129] op_sel:[0,1] op_sel_hi:[1,1]
    v_pk_mul_f32 v[226:227], v[198:199], v[128:129] op_sel_hi:[1,0]
    v_pk_mul_f32 v[234:235], v[198:199], v[128:129] op_sel:[0,1] op_sel_hi:[1,1]
    s_waitcnt vmcnt(36)
    v_lshlrev_b32 v192, 16, v20
    v_and_b32 v193, 0xffff0000, v20
    v_lshlrev_b32 v194, 16, v21
    v_and_b32 v195, 0xffff0000, v21
    v_lshlrev_b32 v196, 16, v22
    v_and_b32 v197, 0xffff0000, v22
    v_lshlrev_b32 v198, 16, v23
    v_and_b32 v199, 0xffff0000, v23
    v_pk_fma_f32 v[220:221], v[192:193], v[130:131], v[220:221] op_sel_hi:[1,0,1]
    v_pk_fma_f32 v[228:229], v[192:193], v[130:131], v[228:229] op_sel:[0,1,0] op_sel_hi:[1,1,1]
    v_pk_fma_f32 v[222:223], v[194:195], v[130:131], v[222:223] op_sel_hi:[1,0,1]
    v_pk_fma_f32 v[230:231], v[194:195], v[130:131], v[230:231] op_sel:[0,1,0] op_sel_hi:[1,1,1]
    v_pk_fma_f32 v[224:225], v[196:197], v[130:131], v[224:225] op_sel_hi:[1,0,1]
    v_pk_fma_f32 v[232:233], v[196:197], v[130:131], v[232:233] op_sel:[0,1,0] op_sel_hi:[1,1,1]
    v_pk_fma_f32 v[226:227], v[198:199], v[130:131], v[226:227] op_sel_hi:[1,0,1]
    v_pk_fma_f32 v[234:235], v[198:199], v[130:131], v[234:235] op_sel:[0,1,0] op_sel_hi:[1,1,1]
    s_waitcnt vmcnt(35)
    v_lshlrev_b32 v192, 16, v24
    v_and_b32 v193, 0xffff0000, v24
    v_lshlrev_b32 v194, 16, v25
    v_and_b32 v195, 0xffff0000, v25
    v_lshlrev_b32 v196, 16, v26
    v_and_b32 v197, 0xffff0000, v26
    v_lshlrev_b32 v198, 16, v27
    v_and_b32 v199, 0xffff0000, v27
    v_pk_fma_f32 v[220:221], v[192:193], v[132:133], v[220:221] op_sel_hi:[1,0,1]
    v_pk_fma_f32 v[228:229], v[192:193], v[132:133], v[228:229] op_sel:[0,1,0] op_sel_hi:[1,1,1]
    v_pk_fma_f32 v[222:223], v[194:195], v[132:133], v[222:223] op_sel_hi:[1,0,1]
    v_pk_fma_f32 v[230:231], v[194:195], v[132:133], v[230:231] op_sel:[0,1,0] op_sel_hi:[1,1,1]
    v_pk_fma_f32 v[224:225], v[196:197], v[132:133], v[224:225] op_sel_hi:[1,0,1]
    v_pk_fma_f32 v[232:233], v[196:197], v[132:133], v[232:233] op_sel:[0,1,0] op_sel_hi:[1,1,1]
    v_pk_fma_f32 v[226:227], v[198:199], v[132:133], v[226:227] op_sel_hi:[1,0,1]
    v_pk_fma_f32 v[234:235], v[198:199], v[132:133], v[234:235] op_sel:[0,1,0] op_sel_hi:[1,1,1]
    s_waitcnt vmcnt(34)
    v_lshlrev_b32 v192, 16, v28
    v_and_b32 v193, 0xffff0000, v28
    v_lshlrev_b32 v194, 16, v29
    v_and_b32 v195, 0xffff0000, v29
    v_lshlrev_b32 v196, 16, v30
    v_and_b32 v197, 0xffff0000, v30
    v_lshlrev_b32 v198, 16, v31
    v_and_b32 v199, 0xffff0000, v31
    v_pk_fma_f32 v[220:221], v[192:193], v[134:135], v[220:221] op_sel_hi:[1,0,1]
    v_pk_fma_f32 v[228:229], v[192:193], v[134:135], v[228:229] op_sel:[0,1,0] op_sel_hi:[1,1,1]
    v_pk_fma_f32 v[222:223], v[194:195], v[134:135], v[222:223] op_sel_hi:[1,0,1]
    v_pk_fma_f32 v[230:231], v[194:195], v[134:135], v[230:231] op_sel:[0,1,0] op_sel_hi:[1,1,1]
    v_pk_fma_f32 v[224:225], v[196:197], v[134:135], v[224:225] op_sel_hi:[1,0,1]
    v_pk_fma_f32 v[232:233], v[196:197], v[134:135], v[232:233] op_sel:[0,1,0] op_sel_hi:[1,1,1]
    v_pk_fma_f32 v[226:227], v[198:199], v[134:135], v[226:227] op_sel_hi:[1,0,1]
    v_pk_fma_f32 v[234:235], v[198:199], v[134:135], v[234:235] op_sel:[0,1,0] op_sel_hi:[1,1,1]
    s_waitcnt vmcnt(33)
    v_lshlrev_b32 v192, 16, v32
    v_and_b32 v193, 0xffff0000, v32
    v_lshlrev_b32 v194, 16, v33
    v_and_b32 v195, 0xffff0000, v33
    v_lshlrev_b32 v196, 16, v34
    v_and_b32 v197, 0xffff0000, v34
    v_lshlrev_b32 v198, 16, v35
    v_and_b32 v199, 0xffff0000, v35
    v_pk_fma_f32 v[220:221], v[192:193], v[136:137], v[220:221] op_sel_hi:[1,0,1]
    v_pk_fma_f32 v[228:229], v[192:193], v[136:137], v[228:229] op_sel:[0,1,0] op_sel_hi:[1,1,1]
    v_pk_fma_f32 v[222:223], v[194:195], v[136:137], v[222:223] op_sel_hi:[1,0,1]
    v_pk_fma_f32 v[230:231], v[194:195], v[136:137], v[230:231] op_sel:[0,1,0] op_sel_hi:[1,1,1]
    v_pk_fma_f32 v[224:225], v[196:197], v[136:137], v[224:225] op_sel_hi:[1,0,1]
    v_pk_fma_f32 v[232:233], v[196:197], v[136:137], v[232:233] op_sel:[0,1,0] op_sel_hi:[1,1,1]
    v_pk_fma_f32 v[226:227], v[198:199], v[136:137], v[226:227] op_sel_hi:[1,0,1]
    v_pk_fma_f32 v[234:235], v[198:199], v[136:137], v[234:235] op_sel:[0,1,0] op_sel_hi:[1,1,1]
    s_waitcnt vmcnt(32)
    v_lshlrev_b32 v192, 16, v36
    v_and_b32 v193, 0xffff0000, v36
    v_lshlrev_b32 v194, 16, v37
    v_and_b32 v195, 0xffff0000, v37
    v_lshlrev_b32 v196, 16, v38
    v_and_b32 v197, 0xffff0000, v38
    v_lshlrev_b32 v198, 16, v39
    v_and_b32 v199, 0xffff0000, v39
    v_pk_fma_f32 v[220:221], v[192:193], v[138:139], v[220:221] op_sel_hi:[1,0,1]
    v_pk_fma_f32 v[228:229], v[192:193], v[138:139], v[228:229] op_sel:[0,1,0] op_sel_hi:[1,1,1]
    v_pk_fma_f32 v[222:223], v[194:195], v[138:139], v[222:223] op_sel_hi:[1,0,1]
    v_pk_fma_f32 v[230:231], v[194:195], v[138:139], v[230:231] op_sel:[0,1,0] op_sel_hi:[1,1,1]
    v_pk_fma_f32 v[224:225], v[196:197], v[138:139], v[224:225] op_sel_hi:[1,0,1]
    v_pk_fma_f32 v[232:233], v[196:197], v[138:139], v[232:233] op_sel:[0,1,0] op_sel_hi:[1,1,1]
    v_pk_fma_f32 v[226:227], v[198:199], v[138:139], v[226:227] op_sel_hi:[1,0,1]
    v_pk_fma_f32 v[234:235], v[198:199], v[138:139], v[234:235] op_sel:[0,1,0] op_sel_hi:[1,1,1]
    s_waitcnt vmcnt(31)
    v_lshlrev_b32 v192, 16, v40
    v_and_b32 v193, 0xffff0000, v40
    v_lshlrev_b32 v194, 16, v41
    v_and_b32 v195, 0xffff0000, v41
    v_lshlrev_b32 v196, 16, v42
    v_and_b32 v197, 0xffff0000, v42
    v_lshlrev_b32 v198, 16, v43
    v_and_b32 v199, 0xffff0000, v43
    v_pk_fma_f32 v[220:221], v[192:193], v[140:141], v[220:221] op_sel_hi:[1,0,1]
    v_pk_fma_f32 v[228:229], v[192:193], v[140:141], v[228:229] op_sel:[0,1,0] op_sel_hi:[1,1,1]
    v_pk_fma_f32 v[222:223], v[194:195], v[140:141], v[222:223] op_sel_hi:[1,0,1]
    v_pk_fma_f32 v[230:231], v[194:195], v[140:141], v[230:231] op_sel:[0,1,0] op_sel_hi:[1,1,1]
    v_pk_fma_f32 v[224:225], v[196:197], v[140:141], v[224:225] op_sel_hi:[1,0,1]
    v_pk_fma_f32 v[232:233], v[196:197], v[140:141], v[232:233] op_sel:[0,1,0] op_sel_hi:[1,1,1]
    v_pk_fma_f32 v[226:227], v[198:199], v[140:141], v[226:227] op_sel_hi:[1,0,1]
    v_pk_fma_f32 v[234:235], v[198:199], v[140:141], v[234:235] op_sel:[0,1,0] op_sel_hi:[1,1,1]
    s_waitcnt vmcnt(30)
    v_lshlrev_b32 v192, 16, v44
    v_and_b32 v193, 0xffff0000, v44
    v_lshlrev_b32 v194, 16, v45
    v_and_b32 v195, 0xffff0000, v45
    v_lshlrev_b32 v196, 16, v46
    v_and_b32 v197, 0xffff0000, v46
    v_lshlrev_b32 v198, 16, v47
    v_and_b32 v199, 0xffff0000, v47
    v_pk_fma_f32 v[220:221], v[192:193], v[142:143], v[220:221] op_sel_hi:[1,0,1]
    v_pk_fma_f32 v[228:229], v[192:193], v[142:143], v[228:229] op_sel:[0,1,0] op_sel_hi:[1,1,1]
    v_pk_fma_f32 v[222:223], v[194:195], v[142:143], v[222:223] op_sel_hi:[1,0,1]
    v_pk_fma_f32 v[230:231], v[194:195], v[142:143], v[230:231] op_sel:[0,1,0] op_sel_hi:[1,1,1]
    v_pk_fma_f32 v[224:225], v[196:197], v[142:143], v[224:225] op_sel_hi:[1,0,1]
    v_pk_fma_f32 v[232:233], v[196:197], v[142:143], v[232:233] op_sel:[0,1,0] op_sel_hi:[1,1,1]
    v_pk_fma_f32 v[226:227], v[198:199], v[142:143], v[226:227] op_sel_hi:[1,0,1]
    v_pk_fma_f32 v[234:235], v[198:199], v[142:143], v[234:235] op_sel:[0,1,0] op_sel_hi:[1,1,1]
    s_waitcnt vmcnt(29)
    v_lshlrev_b32 v192, 16, v48
    v_and_b32 v193, 0xffff0000, v48
    v_lshlrev_b32 v194, 16, v49
    v_and_b32 v195, 0xffff0000, v49
    v_lshlrev_b32 v196, 16, v50
    v_and_b32 v197, 0xffff0000, v50
    v_lshlrev_b32 v198, 16, v51
    v_and_b32 v199, 0xffff0000, v51
    v_pk_fma_f32 v[220:221], v[192:193], v[144:145], v[220:221] op_sel_hi:[1,0,1]
    v_pk_fma_f32 v[228:229], v[192:193], v[144:145], v[228:229] op_sel:[0,1,0] op_sel_hi:[1,1,1]
    v_pk_fma_f32 v[222:223], v[194:195], v[144:145], v[222:223] op_sel_hi:[1,0,1]
    v_pk_fma_f32 v[230:231], v[194:195], v[144:145], v[230:231] op_sel:[0,1,0] op_sel_hi:[1,1,1]
    v_pk_fma_f32 v[224:225], v[196:197], v[144:145], v[224:225] op_sel_hi:[1,0,1]
    v_pk_fma_f32 v[232:233], v[196:197], v[144:145], v[232:233] op_sel:[0,1,0] op_sel_hi:[1,1,1]
    v_pk_fma_f32 v[226:227], v[198:199], v[144:145], v[226:227] op_sel_hi:[1,0,1]
    v_pk_fma_f32 v[234:235], v[198:199], v[144:145], v[234:235] op_sel:[0,1,0] op_sel_hi:[1,1,1]
    s_waitcnt vmcnt(28)
    v_lshlrev_b32 v192, 16, v52
    v_and_b32 v193, 0xffff0000, v52
    v_lshlrev_b32 v194, 16, v53
    v_and_b32 v195, 0xffff0000, v53
    v_lshlrev_b32 v196, 16, v54
    v_and_b32 v197, 0xffff0000, v54
    v_lshlrev_b32 v198, 16, v55
    v_and_b32 v199, 0xffff0000, v55
    v_pk_fma_f32 v[220:221], v[192:193], v[146:147], v[220:221] op_sel_hi:[1,0,1]
    v_pk_fma_f32 v[228:229], v[192:193], v[146:147], v[228:229] op_sel:[0,1,0] op_sel_hi:[1,1,1]
    v_pk_fma_f32 v[222:223], v[194:195], v[146:147], v[222:223] op_sel_hi:[1,0,1]
    v_pk_fma_f32 v[230:231], v[194:195], v[146:147], v[230:231] op_sel:[0,1,0] op_sel_hi:[1,1,1]
    v_pk_fma_f32 v[224:225], v[196:197], v[146:147], v[224:225] op_sel_hi:[1,0,1]
    v_pk_fma_f32 v[232:233], v[196:197], v[146:147], v[232:233] op_sel:[0,1,0] op_sel_hi:[1,1,1]
    v_pk_fma_f32 v[226:227], v[198:199], v[146:147], v[226:227] op_sel_hi:[1,0,1]
    v_pk_fma_f32 v[234:235], v[198:199], v[146:147], v[234:235] op_sel:[0,1,0] op_sel_hi:[1,1,1]
    s_waitcnt vmcnt(27)
    v_lshlrev_b32 v192, 16, v56
    v_and_b32 v193, 0xffff0000, v56
    v_lshlrev_b32 v194, 16, v57
    v_and_b32 v195, 0xffff0000, v57
    v_lshlrev_b32 v196, 16, v58
    v_and_b32 v197, 0xffff0000, v58
    v_lshlrev_b32 v198, 16, v59
    v_and_b32 v199, 0xffff0000, v59
    v_pk_fma_f32 v[220:221], v[192:193], v[148:149], v[220:221] op_sel_hi:[1,0,1]
    v_pk_fma_f32 v[228:229], v[192:193], v[148:149], v[228:229] op_sel:[0,1,0] op_sel_hi:[1,1,1]
    v_pk_fma_f32 v[222:223], v[194:195], v[148:149], v[222:223] op_sel_hi:[1,0,1]
    v_pk_fma_f32 v[230:231], v[194:195], v[148:149], v[230:231] op_sel:[0,1,0] op_sel_hi:[1,1,1]
    v_pk_fma_f32 v[224:225], v[196:197], v[148:149], v[224:225] op_sel_hi:[1,0,1]
    v_pk_fma_f32 v[232:233], v[196:197], v[148:149], v[232:233] op_sel:[0,1,0] op_sel_hi:[1,1,1]
    v_pk_fma_f32 v[226:227], v[198:199], v[148:149], v[226:227] op_sel_hi:[1,0,1]
    v_pk_fma_f32 v[234:235], v[198:199], v[148:149], v[234:235] op_sel:[0,1,0] op_sel_hi:[1,1,1]
    s_waitcnt vmcnt(26)
    v_lshlrev_b32 v192, 16, v60
    v_and_b32 v193, 0xffff0000, v60
    v_lshlrev_b32 v194, 16, v61
    v_and_b32 v195, 0xffff0000, v61
    v_lshlrev_b32 v196, 16, v62
    v_and_b32 v197, 0xffff0000, v62
    v_lshlrev_b32 v198, 16, v63
    v_and_b32 v199, 0xffff0000, v63
    v_pk_fma_f32 v[220:221], v[192:193], v[150:151], v[220:221] op_sel_hi:[1,0,1]
    v_pk_fma_f32 v[228:229], v[192:193], v[150:151], v[228:229] op_sel:[0,1,0] op_sel_hi:[1,1,1]
    v_pk_fma_f32 v[222:223], v[194:195], v[150:151], v[222:223] op_sel_hi:[1,0,1]
    v_pk_fma_f32 v[230:231], v[194:195], v[150:151], v[230:231] op_sel:[0,1,0] op_sel_hi:[1,1,1]
    v_pk_fma_f32 v[224:225], v[196:197], v[150:151], v[224:225] op_sel_hi:[1,0,1]
    v_pk_fma_f32 v[232:233], v[196:197], v[150:151], v[232:233] op_sel:[0,1,0] op_sel_hi:[1,1,1]
    v_pk_fma_f32 v[226:227], v[198:199], v[150:151], v[226:227] op_sel_hi:[1,0,1]
    v_pk_fma_f32 v[234:235], v[198:199], v[150:151], v[234:235] op_sel:[0,1,0] op_sel_hi:[1,1,1]
    s_waitcnt vmcnt(25)
    v_lshlrev_b32 v192, 16, v64
    v_and_b32 v193, 0xffff0000, v64
    v_lshlrev_b32 v194, 16, v65
    v_and_b32 v195, 0xffff0000, v65
    v_lshlrev_b32 v196, 16, v66
    v_and_b32 v197, 0xffff0000, v66
    v_lshlrev_b32 v198, 16, v67
    v_and_b32 v199, 0xffff0000, v67
    v_pk_fma_f32 v[220:221], v[192:193], v[152:153], v[220:221] op_sel_hi:[1,0,1]
    v_pk_fma_f32 v[228:229], v[192:193], v[152:153], v[228:229] op_sel:[0,1,0] op_sel_hi:[1,1,1]
    v_pk_fma_f32 v[222:223], v[194:195], v[152:153], v[222:223] op_sel_hi:[1,0,1]
    v_pk_fma_f32 v[230:231], v[194:195], v[152:153], v[230:231] op_sel:[0,1,0] op_sel_hi:[1,1,1]
    v_pk_fma_f32 v[224:225], v[196:197], v[152:153], v[224:225] op_sel_hi:[1,0,1]
    v_pk_fma_f32 v[232:233], v[196:197], v[152:153], v[232:233] op_sel:[0,1,0] op_sel_hi:[1,1,1]
    v_pk_fma_f32 v[226:227], v[198:199], v[152:153], v[226:227] op_sel_hi:[1,0,1]
    v_pk_fma_f32 v[234:235], v[198:199], v[152:153], v[234:235] op_sel:[0,1,0] op_sel_hi:[1,1,1]
    s_waitcnt vmcnt(24)
    v_lshlrev_b32 v192, 16, v68
    v_and_b32 v193, 0xffff0000, v68
    v_lshlrev_b32 v194, 16, v69
    v_and_b32 v195, 0xffff0000, v69
    v_lshlrev_b32 v196, 16, v70
    v_and_b32 v197, 0xffff0000, v70
    v_lshlrev_b32 v198, 16, v71
    v_and_b32 v199, 0xffff0000, v71
    s_waitcnt lgkmcnt(14)
    v_pk_fma_f32 v[220:221], v[192:193], v[154:155], v[220:221] op_sel_hi:[1,0,1]
    v_pk_fma_f32 v[228:229], v[192:193], v[154:155], v[228:229] op_sel:[0,1,0] op_sel_hi:[1,1,1]
    v_pk_fma_f32 v[222:223], v[194:195], v[154:155], v[222:223] op_sel_hi:[1,0,1]
    v_pk_fma_f32 v[230:231], v[194:195], v[154:155], v[230:231] op_sel:[0,1,0] op_sel_hi:[1,1,1]
    v_pk_fma_f32 v[224:225], v[196:197], v[154:155], v[224:225] op_sel_hi:[1,0,1]
    v_pk_fma_f32 v[232:233], v[196:197], v[154:155], v[232:233] op_sel:[0,1,0] op_sel_hi:[1,1,1]
    v_pk_fma_f32 v[226:227], v[198:199], v[154:155], v[226:227] op_sel_hi:[1,0,1]
    v_pk_fma_f32 v[234:235], v[198:199], v[154:155], v[234:235] op_sel:[0,1,0] op_sel_hi:[1,1,1]
    s_waitcnt vmcnt(23)
    v_lshlrev_b32 v192, 16, v72
    v_and_b32 v193, 0xffff0000, v72
    v_lshlrev_b32 v194, 16, v73
    v_and_b32 v195, 0xffff0000, v73
    v_lshlrev_b32 v196, 16, v74
    v_and_b32 v197, 0xffff0000, v74
    v_lshlrev_b32 v198, 16, v75
    v_and_b32 v199, 0xffff0000, v75
    s_waitcnt lgkmcnt(13)
    v_pk_fma_f32 v[220:221], v[192:193], v[156:157], v[220:221] op_sel_hi:[1,0,1]
    v_pk_fma_f32 v[228:229], v[192:193], v[156:157], v[228:229] op_sel:[0,1,0] op_sel_hi:[1,1,1]
    v_pk_fma_f32 v[222:223], v[194:195], v[156:157], v[222:223] op_sel_hi:[1,0,1]
    v_pk_fma_f32 v[230:231], v[194:195], v[156:157], v[230:231] op_sel:[0,1,0] op_sel_hi:[1,1,1]
    v_pk_fma_f32 v[224:225], v[196:197], v[156:157], v[224:225] op_sel_hi:[1,0,1]
    v_pk_fma_f32 v[232:233], v[196:197], v[156:157], v[232:233] op_sel:[0,1,0] op_sel_hi:[1,1,1]
    v_pk_fma_f32 v[226:227], v[198:199], v[156:157], v[226:227] op_sel_hi:[1,0,1]
    v_pk_fma_f32 v[234:235], v[198:199], v[156:157], v[234:235] op_sel:[0,1,0] op_sel_hi:[1,1,1]
    s_waitcnt vmcnt(22)
    v_lshlrev_b32 v192, 16, v76
    v_and_b32 v193, 0xffff0000, v76
    v_lshlrev_b32 v194, 16, v77
    v_and_b32 v195, 0xffff0000, v77
    v_lshlrev_b32 v196, 16, v78
    v_and_b32 v197, 0xffff0000, v78
    v_lshlrev_b32 v198, 16, v79
    v_and_b32 v199, 0xffff0000, v79
    s_waitcnt lgkmcnt(12)
    v_pk_fma_f32 v[220:221], v[192:193], v[158:159], v[220:221] op_sel_hi:[1,0,1]
    v_pk_fma_f32 v[228:229], v[192:193], v[158:159], v[228:229] op_sel:[0,1,0] op_sel_hi:[1,1,1]
    v_pk_fma_f32 v[222:223], v[194:195], v[158:159], v[222:223] op_sel_hi:[1,0,1]
    v_pk_fma_f32 v[230:231], v[194:195], v[158:159], v[230:231] op_sel:[0,1,0] op_sel_hi:[1,1,1]
    v_pk_fma_f32 v[224:225], v[196:197], v[158:159], v[224:225] op_sel_hi:[1,0,1]
    v_pk_fma_f32 v[232:233], v[196:197], v[158:159], v[232:233] op_sel:[0,1,0] op_sel_hi:[1,1,1]
    v_pk_fma_f32 v[226:227], v[198:199], v[158:159], v[226:227] op_sel_hi:[1,0,1]
    v_pk_fma_f32 v[234:235], v[198:199], v[158:159], v[234:235] op_sel:[0,1,0] op_sel_hi:[1,1,1]
    s_waitcnt vmcnt(21)
    v_lshlrev_b32 v192, 16, v80
    v_and_b32 v193, 0xffff0000, v80
    v_lshlrev_b32 v194, 16, v81
    v_and_b32 v195, 0xffff0000, v81
    v_lshlrev_b32 v196, 16, v82
    v_and_b32 v197, 0xffff0000, v82
    v_lshlrev_b32 v198, 16, v83
    v_and_b32 v199, 0xffff0000, v83
    s_waitcnt lgkmcnt(11)
    v_pk_fma_f32 v[220:221], v[192:193], v[160:161], v[220:221] op_sel_hi:[1,0,1]
    v_pk_fma_f32 v[228:229], v[192:193], v[160:161], v[228:229] op_sel:[0,1,0] op_sel_hi:[1,1,1]
    v_pk_fma_f32 v[222:223], v[194:195], v[160:161], v[222:223] op_sel_hi:[1,0,1]
    v_pk_fma_f32 v[230:231], v[194:195], v[160:161], v[230:231] op_sel:[0,1,0] op_sel_hi:[1,1,1]
    v_pk_fma_f32 v[224:225], v[196:197], v[160:161], v[224:225] op_sel_hi:[1,0,1]
    v_pk_fma_f32 v[232:233], v[196:197], v[160:161], v[232:233] op_sel:[0,1,0] op_sel_hi:[1,1,1]
    v_pk_fma_f32 v[226:227], v[198:199], v[160:161], v[226:227] op_sel_hi:[1,0,1]
    v_pk_fma_f32 v[234:235], v[198:199], v[160:161], v[234:235] op_sel:[0,1,0] op_sel_hi:[1,1,1]
    s_waitcnt vmcnt(20)
    v_lshlrev_b32 v192, 16, v84
    v_and_b32 v193, 0xffff0000, v84
    v_lshlrev_b32 v194, 16, v85
    v_and_b32 v195, 0xffff0000, v85
    v_lshlrev_b32 v196, 16, v86
    v_and_b32 v197, 0xffff0000, v86
    v_lshlrev_b32 v198, 16, v87
    v_and_b32 v199, 0xffff0000, v87
    s_waitcnt lgkmcnt(10)
    v_pk_fma_f32 v[220:221], v[192:193], v[162:163], v[220:221] op_sel_hi:[1,0,1]
    v_pk_fma_f32 v[228:229], v[192:193], v[162:163], v[228:229] op_sel:[0,1,0] op_sel_hi:[1,1,1]
    v_pk_fma_f32 v[222:223], v[194:195], v[162:163], v[222:223] op_sel_hi:[1,0,1]
    v_pk_fma_f32 v[230:231], v[194:195], v[162:163], v[230:231] op_sel:[0,1,0] op_sel_hi:[1,1,1]
    v_pk_fma_f32 v[224:225], v[196:197], v[162:163], v[224:225] op_sel_hi:[1,0,1]
    v_pk_fma_f32 v[232:233], v[196:197], v[162:163], v[232:233] op_sel:[0,1,0] op_sel_hi:[1,1,1]
    v_pk_fma_f32 v[226:227], v[198:199], v[162:163], v[226:227] op_sel_hi:[1,0,1]
    v_pk_fma_f32 v[234:235], v[198:199], v[162:163], v[234:235] op_sel:[0,1,0] op_sel_hi:[1,1,1]
    s_waitcnt vmcnt(19)
    v_lshlrev_b32 v192, 16, v88
    v_and_b32 v193, 0xffff0000, v88
    v_lshlrev_b32 v194, 16, v89
    v_and_b32 v195, 0xffff0000, v89
    v_lshlrev_b32 v196, 16, v90
    v_and_b32 v197, 0xffff0000, v90
    v_lshlrev_b32 v198, 16, v91
    v_and_b32 v199, 0xffff0000, v91
    s_waitcnt lgkmcnt(9)
    v_pk_fma_f32 v[220:221], v[192:193], v[164:165], v[220:221] op_sel_hi:[1,0,1]
    v_pk_fma_f32 v[228:229], v[192:193], v[164:165], v[228:229] op_sel:[0,1,0] op_sel_hi:[1,1,1]
    v_pk_fma_f32 v[222:223], v[194:195], v[164:165], v[222:223] op_sel_hi:[1,0,1]
    v_pk_fma_f32 v[230:231], v[194:195], v[164:165], v[230:231] op_sel:[0,1,0] op_sel_hi:[1,1,1]
    v_pk_fma_f32 v[224:225], v[196:197], v[164:165], v[224:225] op_sel_hi:[1,0,1]
    v_pk_fma_f32 v[232:233], v[196:197], v[164:165], v[232:233] op_sel:[0,1,0] op_sel_hi:[1,1,1]
    v_pk_fma_f32 v[226:227], v[198:199], v[164:165], v[226:227] op_sel_hi:[1,0,1]
    v_pk_fma_f32 v[234:235], v[198:199], v[164:165], v[234:235] op_sel:[0,1,0] op_sel_hi:[1,1,1]
    s_waitcnt vmcnt(18)
    v_lshlrev_b32 v192, 16, v92
    v_and_b32 v193, 0xffff0000, v92
    v_lshlrev_b32 v194, 16, v93
    v_and_b32 v195, 0xffff0000, v93
    v_lshlrev_b32 v196, 16, v94
    v_and_b32 v197, 0xffff0000, v94
    v_lshlrev_b32 v198, 16, v95
    v_and_b32 v199, 0xffff0000, v95
    s_waitcnt lgkmcnt(8)
    v_pk_fma_f32 v[220:221], v[192:193], v[166:167], v[220:221] op_sel_hi:[1,0,1]
    v_pk_fma_f32 v[228:229], v[192:193], v[166:167], v[228:229] op_sel:[0,1,0] op_sel_hi:[1,1,1]
    v_pk_fma_f32 v[222:223], v[194:195], v[166:167], v[222:223] op_sel_hi:[1,0,1]
    v_pk_fma_f32 v[230:231], v[194:195], v[166:167], v[230:231] op_sel:[0,1,0] op_sel_hi:[1,1,1]
    v_pk_fma_f32 v[224:225], v[196:197], v[166:167], v[224:225] op_sel_hi:[1,0,1]
    v_pk_fma_f32 v[232:233], v[196:197], v[166:167], v[232:233] op_sel:[0,1,0] op_sel_hi:[1,1,1]
    v_pk_fma_f32 v[226:227], v[198:199], v[166:167], v[226:227] op_sel_hi:[1,0,1]
    v_pk_fma_f32 v[234:235], v[198:199], v[166:167], v[234:235] op_sel:[0,1,0] op_sel_hi:[1,1,1]
    s_waitcnt vmcnt(17)
    v_lshlrev_b32 v192, 16, v96
    v_and_b32 v193, 0xffff0000, v96
    v_lshlrev_b32 v194, 16, v97
    v_and_b32 v195, 0xffff0000, v97
    v_lshlrev_b32 v196, 16, v98
    v_and_b32 v197, 0xffff0000, v98
    v_lshlrev_b32 v198, 16, v99
    v_and_b32 v199, 0xffff0000, v99
    s_waitcnt lgkmcnt(7)
    v_pk_fma_f32 v[220:221], v[192:193], v[168:169], v[220:221] op_sel_hi:[1,0,1]
    v_pk_fma_f32 v[228:229], v[192:193], v[168:169], v[228:229] op_sel:[0,1,0] op_sel_hi:[1,1,1]
    v_pk_fma_f32 v[222:223], v[194:195], v[168:169], v[222:223] op_sel_hi:[1,0,1]
    v_pk_fma_f32 v[230:231], v[194:195], v[168:169], v[230:231] op_sel:[0,1,0] op_sel_hi:[1,1,1]
    v_pk_fma_f32 v[224:225], v[196:197], v[168:169], v[224:225] op_sel_hi:[1,0,1]
    v_pk_fma_f32 v[232:233], v[196:197], v[168:169], v[232:233] op_sel:[0,1,0] op_sel_hi:[1,1,1]
    v_pk_fma_f32 v[226:227], v[198:199], v[168:169], v[226:227] op_sel_hi:[1,0,1]
    v_pk_fma_f32 v[234:235], v[198:199], v[168:169], v[234:235] op_sel:[0,1,0] op_sel_hi:[1,1,1]
    s_waitcnt vmcnt(16)
    v_lshlrev_b32 v192, 16, v100
    v_and_b32 v193, 0xffff0000, v100
    v_lshlrev_b32 v194, 16, v101
    v_and_b32 v195, 0xffff0000, v101
    v_lshlrev_b32 v196, 16, v102
    v_and_b32 v197, 0xffff0000, v102
    v_lshlrev_b32 v198, 16, v103
    v_and_b32 v199, 0xffff0000, v103
    s_waitcnt lgkmcnt(6)
    v_pk_fma_f32 v[220:221], v[192:193], v[170:171], v[220:221] op_sel_hi:[1,0,1]
    v_pk_fma_f32 v[228:229], v[192:193], v[170:171], v[228:229] op_sel:[0,1,0] op_sel_hi:[1,1,1]
    v_pk_fma_f32 v[222:223], v[194:195], v[170:171], v[222:223] op_sel_hi:[1,0,1]
    v_pk_fma_f32 v[230:231], v[194:195], v[170:171], v[230:231] op_sel:[0,1,0] op_sel_hi:[1,1,1]
    v_pk_fma_f32 v[224:225], v[196:197], v[170:171], v[224:225] op_sel_hi:[1,0,1]
    v_pk_fma_f32 v[232:233], v[196:197], v[170:171], v[232:233] op_sel:[0,1,0] op_sel_hi:[1,1,1]
    v_pk_fma_f32 v[226:227], v[198:199], v[170:171], v[226:227] op_sel_hi:[1,0,1]
    v_pk_fma_f32 v[234:235], v[198:199], v[170:171], v[234:235] op_sel:[0,1,0] op_sel_hi:[1,1,1]
    s_waitcnt vmcnt(15)
    v_lshlrev_b32 v192, 16, v104
    v_and_b32 v193, 0xffff0000, v104
    v_lshlrev_b32 v194, 16, v105
    v_and_b32 v195, 0xffff0000, v105
    v_lshlrev_b32 v196, 16, v106
    v_and_b32 v197, 0xffff0000, v106
    v_lshlrev_b32 v198, 16, v107
    v_and_b32 v199, 0xffff0000, v107
    s_waitcnt lgkmcnt(5)
    v_pk_fma_f32 v[220:221], v[192:193], v[172:173], v[220:221] op_sel_hi:[1,0,1]
    v_pk_fma_f32 v[228:229], v[192:193], v[172:173], v[228:229] op_sel:[0,1,0] op_sel_hi:[1,1,1]
    v_pk_fma_f32 v[222:223], v[194:195], v[172:173], v[222:223] op_sel_hi:[1,0,1]
    v_pk_fma_f32 v[230:231], v[194:195], v[172:173], v[230:231] op_sel:[0,1,0] op_sel_hi:[1,1,1]
    v_pk_fma_f32 v[224:225], v[196:197], v[172:173], v[224:225] op_sel_hi:[1,0,1]
    v_pk_fma_f32 v[232:233], v[196:197], v[172:173], v[232:233] op_sel:[0,1,0] op_sel_hi:[1,1,1]
    v_pk_fma_f32 v[226:227], v[198:199], v[172:173], v[226:227] op_sel_hi:[1,0,1]
    v_pk_fma_f32 v[234:235], v[198:199], v[172:173], v[234:235] op_sel:[0,1,0] op_sel_hi:[1,1,1]
    s_waitcnt vmcnt(14)
    v_lshlrev_b32 v192, 16, v108
    v_and_b32 v193, 0xffff0000, v108
    v_lshlrev_b32 v194, 16, v109
    v_and_b32 v195, 0xffff0000, v109
    v_lshlrev_b32 v196, 16, v110
    v_and_b32 v197, 0xffff0000, v110
    v_lshlrev_b32 v198, 16, v111
    v_and_b32 v199, 0xffff0000, v111
    s_waitcnt lgkmcnt(4)
    v_pk_fma_f32 v[220:221], v[192:193], v[174:175], v[220:221] op_sel_hi:[1,0,1]
    v_pk_fma_f32 v[228:229], v[192:193], v[174:175], v[228:229] op_sel:[0,1,0] op_sel_hi:[1,1,1]
    v_pk_fma_f32 v[222:223], v[194:195], v[174:175], v[222:223] op_sel_hi:[1,0,1]
    v_pk_fma_f32 v[230:231], v[194:195], v[174:175], v[230:231] op_sel:[0,1,0] op_sel_hi:[1,1,1]
    v_pk_fma_f32 v[224:225], v[196:197], v[174:175], v[224:225] op_sel_hi:[1,0,1]
    v_pk_fma_f32 v[232:233], v[196:197], v[174:175], v[232:233] op_sel:[0,1,0] op_sel_hi:[1,1,1]
    v_pk_fma_f32 v[226:227], v[198:199], v[174:175], v[226:227] op_sel_hi:[1,0,1]
    v_pk_fma_f32 v[234:235], v[198:199], v[174:175], v[234:235] op_sel:[0,1,0] op_sel_hi:[1,1,1]
    s_waitcnt vmcnt(13)
    v_lshlrev_b32 v192, 16, v112
    v_and_b32 v193, 0xffff0000, v112
    v_lshlrev_b32 v194, 16, v113
    v_and_b32 v195, 0xffff0000, v113
    v_lshlrev_b32 v196, 16, v114
    v_and_b32 v197, 0xffff0000, v114
    v_lshlrev_b32 v198, 16, v115
    v_and_b32 v199, 0xffff0000, v115
    s_waitcnt lgkmcnt(3)
    v_pk_fma_f32 v[220:221], v[192:193], v[176:177], v[220:221] op_sel_hi:[1,0,1]
    v_pk_fma_f32 v[228:229], v[192:193], v[176:177], v[228:229] op_sel:[0,1,0] op_sel_hi:[1,1,1]
    v_pk_fma_f32 v[222:223], v[194:195], v[176:177], v[222:223] op_sel_hi:[1,0,1]
    v_pk_fma_f32 v[230:231], v[194:195], v[176:177], v[230:231] op_sel:[0,1,0] op_sel_hi:[1,1,1]
    v_pk_fma_f32 v[224:225], v[196:197], v[176:177], v[224:225] op_sel_hi:[1,0,1]
    v_pk_fma_f32 v[232:233], v[196:197], v[176:177], v[232:233] op_sel:[0,1,0] op_sel_hi:[1,1,1]
    v_pk_fma_f32 v[226:227], v[198:199], v[176:177], v[226:227] op_sel_hi:[1,0,1]
    v_pk_fma_f32 v[234:235], v[198:199], v[176:177], v[234:235] op_sel:[0,1,0] op_sel_hi:[1,1,1]
    s_waitcnt vmcnt(12)
    v_lshlrev_b32 v192, 16, v116
    v_and_b32 v193, 0xffff0000, v116
    v_lshlrev_b32 v194, 16, v117
    v_and_b32 v195, 0xffff0000, v117
    v_lshlrev_b32 v196, 16, v118
    v_and_b32 v197, 0xffff0000, v118
    v_lshlrev_b32 v198, 16, v119
    v_and_b32 v199, 0xffff0000, v119
    s_waitcnt lgkmcnt(2)
    v_pk_fma_f32 v[220:221], v[192:193], v[178:179], v[220:221] op_sel_hi:[1,0,1]
    v_pk_fma_f32 v[228:229], v[192:193], v[178:179], v[228:229] op_sel:[0,1,0] op_sel_hi:[1,1,1]
    v_pk_fma_f32 v[222:223], v[194:195], v[178:179], v[222:223] op_sel_hi:[1,0,1]
    v_pk_fma_f32 v[230:231], v[194:195], v[178:179], v[230:231] op_sel:[0,1,0] op_sel_hi:[1,1,1]
    v_pk_fma_f32 v[224:225], v[196:197], v[178:179], v[224:225] op_sel_hi:[1,0,1]
    v_pk_fma_f32 v[232:233], v[196:197], v[178:179], v[232:233] op_sel:[0,1,0] op_sel_hi:[1,1,1]
    v_pk_fma_f32 v[226:227], v[198:199], v[178:179], v[226:227] op_sel_hi:[1,0,1]
    v_pk_fma_f32 v[234:235], v[198:199], v[178:179], v[234:235] op_sel:[0,1,0] op_sel_hi:[1,1,1]
    s_waitcnt vmcnt(11)
    v_lshlrev_b32 v192, 16, v120
    v_and_b32 v193, 0xffff0000, v120
    v_lshlrev_b32 v194, 16, v121
    v_and_b32 v195, 0xffff0000, v121
    v_lshlrev_b32 v196, 16, v122
    v_and_b32 v197, 0xffff0000, v122
    v_lshlrev_b32 v198, 16, v123
    v_and_b32 v199, 0xffff0000, v123
    s_waitcnt lgkmcnt(1)
    v_pk_fma_f32 v[220:221], v[192:193], v[180:181], v[220:221] op_sel_hi:[1,0,1]
    v_pk_fma_f32 v[228:229], v[192:193], v[180:181], v[228:229] op_sel:[0,1,0] op_sel_hi:[1,1,1]
    v_pk_fma_f32 v[222:223], v[194:195], v[180:181], v[222:223] op_sel_hi:[1,0,1]
    v_pk_fma_f32 v[230:231], v[194:195], v[180:181], v[230:231] op_sel:[0,1,0] op_sel_hi:[1,1,1]
    v_pk_fma_f32 v[224:225], v[196:197], v[180:181], v[224:225] op_sel_hi:[1,0,1]
    v_pk_fma_f32 v[232:233], v[196:197], v[180:181], v[232:233] op_sel:[0,1,0] op_sel_hi:[1,1,1]
    v_pk_fma_f32 v[226:227], v[198:199], v[180:181], v[226:227] op_sel_hi:[1,0,1]
    v_pk_fma_f32 v[234:235], v[198:199], v[180:181], v[234:235] op_sel:[0,1,0] op_sel_hi:[1,1,1]
    s_waitcnt vmcnt(10)
    v_lshlrev_b32 v192, 16, v124
    v_and_b32 v193, 0xffff0000, v124
    v_lshlrev_b32 v194, 16, v125
    v_and_b32 v195, 0xffff0000, v125
    v_lshlrev_b32 v196, 16, v126
    v_and_b32 v197, 0xffff0000, v126
    v_lshlrev_b32 v198, 16, v127
    v_and_b32 v199, 0xffff0000, v127
    s_waitcnt lgkmcnt(0)
    v_pk_fma_f32 v[220:221], v[192:193], v[182:183], v[220:221] op_sel_hi:[1,0,1]
    v_pk_fma_f32 v[228:229], v[192:193], v[182:183], v[228:229] op_sel:[0,1,0] op_sel_hi:[1,1,1]
    v_pk_fma_f32 v[222:223], v[194:195], v[182:183], v[222:223] op_sel_hi:[1,0,1]
    v_pk_fma_f32 v[230:231], v[194:195], v[182:183], v[230:231] op_sel:[0,1,0] op_sel_hi:[1,1,1]
    v_pk_fma_f32 v[224:225], v[196:197], v[182:183], v[224:225] op_sel_hi:[1,0,1]
    v_pk_fma_f32 v[232:233], v[196:197], v[182:183], v[232:233] op_sel:[0,1,0] op_sel_hi:[1,1,1]
    v_pk_fma_f32 v[226:227], v[198:199], v[182:183], v[226:227] op_sel_hi:[1,0,1]
    v_pk_fma_f32 v[234:235], v[198:199], v[182:183], v[234:235] op_sel:[0,1,0] op_sel_hi:[1,1,1]
    v_add_f32_dpp v220, v220, v220 row_ror:4 row_mask:0xf bank_mask:0xf
    v_add_f32_dpp v221, v221, v221 row_ror:4 row_mask:0xf bank_mask:0xf
    v_add_f32_dpp v222, v222, v222 row_ror:4 row_mask:0xf bank_mask:0xf
    v_add_f32_dpp v223, v223, v223 row_ror:4 row_mask:0xf bank_mask:0xf
    v_add_f32_dpp v224, v224, v224 row_ror:4 row_mask:0xf bank_mask:0xf
    v_add_f32_dpp v225, v225, v225 row_ror:4 row_mask:0xf bank_mask:0xf
    v_add_f32_dpp v226, v226, v226 row_ror:4 row_mask:0xf bank_mask:0xf
    v_add_f32_dpp v227, v227, v227 row_ror:4 row_mask:0xf bank_mask:0xf
    v_add_f32_dpp v228, v228, v228 row_ror:4 row_mask:0xf bank_mask:0xf
    v_add_f32_dpp v229, v229, v229 row_ror:4 row_mask:0xf bank_mask:0xf
    v_add_f32_dpp v230, v230, v230 row_ror:4 row_mask:0xf bank_mask:0xf
    v_add_f32_dpp v231, v231, v231 row_ror:4 row_mask:0xf bank_mask:0xf
    v_add_f32_dpp v232, v232, v232 row_ror:4 row_mask:0xf bank_mask:0xf
    v_add_f32_dpp v233, v233, v233 row_ror:4 row_mask:0xf bank_mask:0xf
    v_add_f32_dpp v234, v234, v234 row_ror:4 row_mask:0xf bank_mask:0xf
    v_add_f32_dpp v235, v235, v235 row_ror:4 row_mask:0xf bank_mask:0xf
    v_add_f32_dpp v220, v220, v220 row_ror:8 row_mask:0xf bank_mask:0xf
    v_add_f32_dpp v221, v221, v221 row_ror:8 row_mask:0xf bank_mask:0xf
    v_add_f32_dpp v222, v222, v222 row_ror:8 row_mask:0xf bank_mask:0xf
    v_add_f32_dpp v223, v223, v223 row_ror:8 row_mask:0xf bank_mask:0xf
    v_add_f32_dpp v224, v224, v224 row_ror:8 row_mask:0xf bank_mask:0xf
    v_add_f32_dpp v225, v225, v225 row_ror:8 row_mask:0xf bank_mask:0xf
    v_add_f32_dpp v226, v226, v226 row_ror:8 row_mask:0xf bank_mask:0xf
    v_add_f32_dpp v227, v227, v227 row_ror:8 row_mask:0xf bank_mask:0xf
    v_add_f32_dpp v228, v228, v228 row_ror:8 row_mask:0xf bank_mask:0xf
    v_add_f32_dpp v229, v229, v229 row_ror:8 row_mask:0xf bank_mask:0xf
    v_add_f32_dpp v230, v230, v230 row_ror:8 row_mask:0xf bank_mask:0xf
    v_add_f32_dpp v231, v231, v231 row_ror:8 row_mask:0xf bank_mask:0xf
    v_add_f32_dpp v232, v232, v232 row_ror:8 row_mask:0xf bank_mask:0xf
    v_add_f32_dpp v233, v233, v233 row_ror:8 row_mask:0xf bank_mask:0xf
    v_add_f32_dpp v234, v234, v234 row_ror:8 row_mask:0xf bank_mask:0xf
    v_add_f32_dpp v235, v235, v235 row_ror:8 row_mask:0xf bank_mask:0xf
    v_and_b32 v8, 3, v8
    v_bfe_u32 v5, v0, 4, 1
    v_lshl_add_u32 v13, v5, 2, v8
    v_mov_b32 v192, v220
    v_mov_b32 v193, v221
    v_mov_b32 v194, v222
    v_mov_b32 v195, v223
    v_mov_b32 v196, v224
    v_mov_b32 v197, v225
    v_mov_b32 v198, v226
    v_mov_b32 v199, v227
    v_mov_b32 v200, v228
    v_mov_b32 v201, v229
    v_mov_b32 v202, v230
    v_mov_b32 v203, v231
    v_mov_b32 v204, v232
    v_mov_b32 v205, v233
    v_mov_b32 v206, v234
    v_mov_b32 v207, v235
    v_permlane16_swap_b32 v220, v192
    v_permlane16_swap_b32 v221, v193
    v_permlane16_swap_b32 v222, v194
    v_permlane16_swap_b32 v223, v195
    v_permlane16_swap_b32 v224, v196
    v_permlane16_swap_b32 v225, v197
    v_permlane16_swap_b32 v226, v198
    v_permlane16_swap_b32 v227, v199
    v_permlane16_swap_b32 v228, v200
    v_permlane16_swap_b32 v229, v201
    v_permlane16_swap_b32 v230, v202
    v_permlane16_swap_b32 v231, v203
    v_permlane16_swap_b32 v232, v204
    v_permlane16_swap_b32 v233, v205
    v_permlane16_swap_b32 v234, v206
    v_permlane16_swap_b32 v235, v207
    v_pk_add_f32 v[220:221], v[220:221], v[192:193]
    v_pk_add_f32 v[222:223], v[222:223], v[194:195]
    v_pk_add_f32 v[224:225], v[224:225], v[196:197]
    v_pk_add_f32 v[226:227], v[226:227], v[198:199]
    v_pk_add_f32 v[228:229], v[228:229], v[200:201]
    v_pk_add_f32 v[230:231], v[230:231], v[202:203]
    v_pk_add_f32 v[232:233], v[232:233], v[204:205]
    v_pk_add_f32 v[234:235], v[234:235], v[206:207]
    v_cmp_eq_u32 vcc, 1, v13
    s_nop 1
    v_cndmask_b32 v220, v220, v221, vcc
    v_cndmask_b32 v228, v228, v229, vcc
    v_cmp_eq_u32 vcc, 2, v13
    s_nop 1
    v_cndmask_b32 v220, v220, v222, vcc
    v_cndmask_b32 v228, v228, v230, vcc
    v_cmp_eq_u32 vcc, 3, v13
    s_nop 1
    v_cndmask_b32 v220, v220, v223, vcc
    v_cndmask_b32 v228, v228, v231, vcc
    v_cmp_eq_u32 vcc, 4, v13
    s_nop 1
    v_cndmask_b32 v220, v220, v224, vcc
    v_cndmask_b32 v228, v228, v232, vcc
    v_cmp_eq_u32 vcc, 5, v13
    s_nop 1
    v_cndmask_b32 v220, v220, v225, vcc
    v_cndmask_b32 v228, v228, v233, vcc
    v_cmp_eq_u32 vcc, 6, v13
    s_nop 1
    v_cndmask_b32 v220, v220, v226, vcc
    v_cndmask_b32 v228, v228, v234, vcc
    v_cmp_eq_u32 vcc, 7, v13
    s_nop 1
    v_cndmask_b32 v220, v220, v227, vcc
    v_cndmask_b32 v228, v228, v235, vcc
    v_mov_b32 v192, v220
    v_mov_b32 v193, v228
    s_nop 0
    v_permlane32_swap_b32 v220, v192
    v_permlane32_swap_b32 v228, v193
    v_add_f32 v220, v220, v192
    v_add_f32 v228, v228, v193
    v_cvt_pk_bf16_f32 v193, v220, v228
    v_lshlrev_b32 v196, 16, v193
    v_and_b32 v197, 0xffff0000, v193
    v_sub_f32 v220, v220, v196
    v_sub_f32 v228, v228, v197
    v_cvt_pk_bf16_f32 v192, v196, v220
    v_cvt_pk_bf16_f32 v194, v228, v197
    v_mov_b32 v195, s28
    v_and_b32 v4, 3, v0
    v_lshl_add_u32 v4, v4, 3, v13
    v_lshrrev_b32 v5, 4, v4
    v_and_b32 v4, 15, v4
    v_lshlrev_b32 v4, 4, v4
    v_lshl_add_u32 v4, v5, 9, v4
    s_lshl_b32 s36, s36, 10
    s_add_u32 s36, s36, s50
    s_add_u32 s36, s36, 0x30000
    s_mov_b64 exec, 0xffffffff
    buffer_store_dwordx4 v[192:195], v4, s[8:11], s36 offen sc1
    s_mov_b64 exec, -1
adaLN_cond__linear_kernel_hedgehog__glu_gated_bilinear__prompt_kernel_skip_39:
    s_cmp_lt_u32 s74, 4
    s_cbranch_scc0 adaLN_cond__linear_kernel_hedgehog__glu_gated_bilinear__prompt_kernel_skip_43
    ds_read_b128 v[72:75], v6 offset:0
    ds_read_b128 v[76:79], v6 offset:1024
    ds_read_b128 v[80:83], v6 offset:2048
    ds_read_b128 v[84:87], v6 offset:3072
    ds_read_b128 v[88:91], v6 offset:4096
    ds_read_b128 v[92:95], v6 offset:5120
    ds_read_b128 v[96:99], v6 offset:6144
    ds_read_b128 v[100:103], v6 offset:7168
    ds_read_b128 v[104:107], v6 offset:8192
    ds_read_b128 v[108:111], v6 offset:9216
    ds_read_b128 v[112:115], v6 offset:10240
    ds_read_b128 v[116:119], v6 offset:11264
    ds_read_b128 v[120:123], v6 offset:12288
    ds_read_b128 v[124:127], v6 offset:13312
    ds_read_b128 v[128:131], v6 offset:14336
    ds_read_b128 v[132:135], v6 offset:15360
    s_mul_i32 s38, s72, 28672
    s_lshl_b32 s39, s73, 11
    s_add_u32 s38, s38, s39
    s_add_u32 s38, s38, 0x100000
    s_mul_i32 s40, s72, 7168
    s_lshl_b32 s39, s73, 9
    s_add_u32 s40, s40, s39
    v_lshrrev_b32 v7, 1, v1
    s_add_u32 s40, s40, 0x40000
    s_lshl_b32 s36, s72, 4
    s_add_u32 s36, s36, s73
    s_lshl_b32 s36, s36, 4
    s_add_u32 s36, s36, 0x24000
    s_mov_b32 s41, 0x3f803f80
    s_waitcnt lgkmcnt(15)
    v_mfma_f32_32x32x16_bf16 v[40:55], a[128:131], v[72:75], 0
    ds_read_b128 v[72:75], v6 offset:16384
    s_waitcnt lgkmcnt(15)
    v_mfma_f32_32x32x16_bf16 v[56:71], a[132:135], v[76:79], 0
    ds_read_b128 v[76:79], v6 offset:17408
    s_add_u32 m0, s75, 4096
    s_nop 0
    buffer_load_dwordx4 v244, s[24:27], s71 offen lds
    s_waitcnt lgkmcnt(15)
    v_mfma_f32_32x32x16_bf16 v[40:55], a[136:139], v[80:83], v[40:55]
    ds_read_b128 v[80:83], v6 offset:18432
    s_waitcnt lgkmcnt(15)
    v_mfma_f32_32x32x16_bf16 v[56:71], a[140:143], v[84:87], v[56:71]
    ds_read_b128 v[84:87], v6 offset:19456
    s_add_u32 m0, s75, 5120
    s_nop 0
    buffer_load_dwordx4 v245, s[24:27], s71 offen lds
    s_waitcnt lgkmcnt(15)
    v_mfma_f32_32x32x16_bf16 v[40:55], a[144:147], v[88:91], v[40:55]
    ds_read_b128 v[88:91], v6 offset:20480
    s_waitcnt lgkmcnt(15)
    v_mfma_f32_32x32x16_bf16 v[56:71], a[148:151], v[92:95], v[56:71]
    ds_read_b128 v[92:95], v6 offset:21504
    s_add_u32 m0, s75, 6144
    s_nop 0
    buffer_load_dwordx4 v246, s[24:27], s71 offen lds
    s_waitcnt lgkmcnt(15)
    v_mfma_f32_32x32x16_bf16 v[40:55], a[152:155], v[96:99], v[40:55]
    ds_read_b128 v[96:99], v6 offset:22528
    s_waitcnt lgkmcnt(15)
    v_mfma_f32_32x32x16_bf16 v[56:71], a[156:159], v[100:103], v[56:71]
    ds_read_b128 v[100:103], v6 offset:23552
    s_add_u32 s97, s97, 229376
    s_cmp_eq_u32 s97, 1605632
    s_cmov_b32 s97, 0
    s_add_u32 s71, s70, s97
    s_add_u32 m0, s75, 28800
    s_nop 0
    buffer_load_dwordx4 v240, s[24:27], s71 offen lds
    s_waitcnt lgkmcnt(15)
    v_mfma_f32_32x32x16_bf16 v[40:55], a[160:163], v[104:107], v[40:55]
    ds_read_b128 v[104:107], v6 offset:24576
    s_waitcnt lgkmcnt(15)
    v_mfma_f32_32x32x16_bf16 v[56:71], a[164:167], v[108:111], v[56:71]
    ds_read_b128 v[108:111], v6 offset:25600
    s_add_u32 m0, s75, 29824
    s_nop 0
    buffer_load_dwordx4 v241, s[24:27], s71 offen lds
    s_waitcnt lgkmcnt(15)
    v_mfma_f32_32x32x16_bf16 v[40:55], a[168:171], v[112:115], v[40:55]
    ds_read_b128 v[112:115], v6 offset:26624
    s_waitcnt lgkmcnt(15)
    v_mfma_f32_32x32x16_bf16 v[56:71], a[172:175], v[116:119], v[56:71]
    ds_read_b128 v[116:119], v6 offset:27648
    s_add_u32 m0, s75, 30848
    s_nop 0
    buffer_load_dwordx4 v242, s[24:27], s71 offen lds
    s_waitcnt lgkmcnt(15)
    v_mfma_f32_32x32x16_bf16 v[40:55], a[176:179], v[120:123], v[40:55]
    ds_read_b128 v[120:123], v6 offset:28672
    s_waitcnt lgkmcnt(15)
    v_mfma_f32_32x32x16_bf16 v[56:71], a[180:183], v[124:127], v[56:71]
    ds_read_b128 v[124:127], v6 offset:29696
    s_add_u32 m0, s75, 31872
    s_nop 0
    buffer_load_dwordx4 v243, s[24:27], s71 offen lds
    s_waitcnt lgkmcnt(15)
    v_mfma_f32_32x32x16_bf16 v[40:55], a[184:187], v[128:131], v[40:55]
    ds_read_b128 v[128:131], v6 offset:30720
    s_waitcnt lgkmcnt(15)
    v_mfma_f32_32x32x16_bf16 v[56:71], a[188:191], v[132:135], v[56:71]
    ds_read_b128 v[132:135], v6 offset:31744
    s_add_u32 m0, s75, 32896
    s_nop 0
    buffer_load_dwordx4 v244, s[24:27], s71 offen lds
    s_waitcnt lgkmcnt(15)
    v_mfma_f32_32x32x16_bf16 v[40:55], a[192:195], v[72:75], v[40:55]
    s_waitcnt lgkmcnt(14)
    v_mfma_f32_32x32x16_bf16 v[56:71], a[196:199], v[76:79], v[56:71]
    s_add_u32 m0, s75, 33920
    s_nop 0
    buffer_load_dwordx4 v245, s[24:27], s71 offen lds
    s_waitcnt lgkmcnt(13)
    v_mfma_f32_32x32x16_bf16 v[40:55], a[200:203], v[80:83], v[40:55]
    s_waitcnt lgkmcnt(12)
    v_mfma_f32_32x32x16_bf16 v[56:71], a[204:207], v[84:87], v[56:71]
    s_add_u32 m0, s75, 34944
    s_nop 0
    buffer_load_dwordx4 v246, s[24:27], s71 offen lds
    s_waitcnt lgkmcnt(11)
    v_mfma_f32_32x32x16_bf16 v[40:55], a[208:211], v[88:91], v[40:55]
    s_waitcnt lgkmcnt(10)
    v_mfma_f32_32x32x16_bf16 v[56:71], a[212:215], v[92:95], v[56:71]
    s_waitcnt lgkmcnt(9)
    v_mfma_f32_32x32x16_bf16 v[40:55], a[216:219], v[96:99], v[40:55]
    s_waitcnt lgkmcnt(8)
    v_mfma_f32_32x32x16_bf16 v[56:71], a[220:223], v[100:103], v[56:71]
    s_waitcnt lgkmcnt(7)
    v_mfma_f32_32x32x16_bf16 v[40:55], a[224:227], v[104:107], v[40:55]
    s_waitcnt lgkmcnt(6)
    v_mfma_f32_32x32x16_bf16 v[56:71], a[228:231], v[108:111], v[56:71]
    s_waitcnt lgkmcnt(5)
    v_mfma_f32_32x32x16_bf16 v[40:55], a[232:235], v[112:115], v[40:55]
    s_waitcnt lgkmcnt(4)
    v_mfma_f32_32x32x16_bf16 v[56:71], a[236:239], v[116:119], v[56:71]
    s_waitcnt lgkmcnt(3)
    v_mfma_f32_32x32x16_bf16 v[40:55], a[240:243], v[120:123], v[40:55]
    s_waitcnt lgkmcnt(2)
    v_mfma_f32_32x32x16_bf16 v[56:71], a[244:247], v[124:127], v[56:71]
    s_waitcnt lgkmcnt(1)
    v_mfma_f32_32x32x16_bf16 v[40:55], a[248:251], v[128:131], v[40:55]
    s_waitcnt lgkmcnt(0)
    v_mfma_f32_32x32x16_bf16 v[56:71], a[252:255], v[132:135], v[56:71]
    s_nop 11
    v_pk_add_f32 v[40:41], v[40:41], v[56:57]
    v_pk_add_f32 v[42:43], v[42:43], v[58:59]
    v_pk_add_f32 v[44:45], v[44:45], v[60:61]
    v_pk_add_f32 v[46:47], v[46:47], v[62:63]
    v_pk_add_f32 v[48:49], v[48:49], v[64:65]
    v_pk_add_f32 v[50:51], v[50:51], v[66:67]
    v_pk_add_f32 v[52:53], v[52:53], v[68:69]
    v_pk_add_f32 v[54:55], v[54:55], v[70:71]
    v_pk_fma_f32 v[136:137], v[40:41], v[152:153], v[136:137]
    v_pk_fma_f32 v[138:139], v[42:43], v[154:155], v[138:139]
    v_pk_fma_f32 v[140:141], v[44:45], v[156:157], v[140:141]
    v_pk_fma_f32 v[142:143], v[46:47], v[158:159], v[142:143]
    v_pk_fma_f32 v[144:145], v[48:49], v[160:161], v[144:145]
    v_pk_fma_f32 v[146:147], v[50:51], v[162:163], v[146:147]
    v_pk_fma_f32 v[148:149], v[52:53], v[164:165], v[148:149]
    v_pk_fma_f32 v[150:151], v[54:55], v[166:167], v[150:151]
    v_pk_mul_f32 v[16:17], v[16:17], v[136:137]
    v_pk_mul_f32 v[18:19], v[18:19], v[138:139]
    v_pk_mul_f32 v[20:21], v[20:21], v[140:141]
    v_pk_mul_f32 v[22:23], v[22:23], v[142:143]
    v_pk_mul_f32 v[24:25], v[24:25], v[144:145]
    v_pk_mul_f32 v[26:27], v[26:27], v[146:147]
    v_pk_mul_f32 v[28:29], v[28:29], v[148:149]
    v_pk_mul_f32 v[30:31], v[30:31], v[150:151]
    v_cvt_pk_bf16_f32 v80, v16, v17
    v_cvt_pk_bf16_f32 v81, v18, v19
    v_cvt_pk_bf16_f32 v82, v20, v21
    v_cvt_pk_bf16_f32 v83, v22, v23
    v_cvt_pk_bf16_f32 v84, v24, v25
    v_cvt_pk_bf16_f32 v85, v26, v27
    v_cvt_pk_bf16_f32 v86, v28, v29
    v_cvt_pk_bf16_f32 v87, v30, v31
    s_add_u32 s39, s38, 0x1c0000
    s_cmp_eq_u32 s6, 1
    buffer_store_dwordx4 v[80:83], v1, s[8:11], s39 offen sc1
    buffer_store_dwordx4 v[84:87], v1, s[8:11], s39 offen offset:1024 sc1
    v_cvt_pk_bf16_f32 v72, v136, v137
    v_cvt_pk_bf16_f32 v73, v138, v139
    v_cvt_pk_bf16_f32 v74, v140, v141
    v_cvt_pk_bf16_f32 v75, v142, v143
    v_cvt_pk_bf16_f32 v76, v144, v145
    v_cvt_pk_bf16_f32 v77, v146, v147
    v_cvt_pk_bf16_f32 v78, v148, v149
    v_cvt_pk_bf16_f32 v79, v150, v151
    v_mov_b32 v104, 0
    v_mov_b32 v105, 0
    v_dot2c_f32_bf16 v104, s41, v72
    v_dot2c_f32_bf16 v105, v72, v72
    v_dot2c_f32_bf16 v104, s41, v73
    v_dot2c_f32_bf16 v105, v73, v73
    v_dot2c_f32_bf16 v104, s41, v74
    v_dot2c_f32_bf16 v105, v74, v74
    v_dot2c_f32_bf16 v104, s41, v75
    v_dot2c_f32_bf16 v105, v75, v75
    v_dot2c_f32_bf16 v104, s41, v76
    v_dot2c_f32_bf16 v105, v76, v76
    v_dot2c_f32_bf16 v104, s41, v77
    v_dot2c_f32_bf16 v105, v77, v77
    v_dot2c_f32_bf16 v104, s41, v78
    v_dot2c_f32_bf16 v105, v78, v78
    v_dot2c_f32_bf16 v104, s41, v79
    v_dot2c_f32_bf16 v105, v79, v79
    s_nop 2
    buffer_store_dwordx2 v[104:105], v7, s[8:11], s40 offen sc1
    buffer_store_dwordx4 v[72:75], v1, s[8:11], s38 offen sc1
    buffer_store_dwordx4 v[76:79], v1, s[8:11], s38 offen offset:1024 sc1
    s_waitcnt vmcnt(0)
    v_mov_b32 v4, s28
    v_mov_b32 v5, 0
    s_cmp_eq_u32 s6, 1
    s_mov_b64 exec, 1
    buffer_store_dword v4, v5, s[8:11], s36 offen sc1
    s_mov_b64 exec, -1
adaLN_cond__linear_kernel_hedgehog__glu_gated_bilinear__prompt_kernel_skip_43:
    buffer_load_dword v176, v1, s[8:11], s49 offen offset:0 sc1
    buffer_load_dword v177, v1, s[8:11], s49 offen offset:1024 sc1
    buffer_load_dword v178, v1, s[8:11], s49 offen offset:2048 sc1
    buffer_load_dword v179, v1, s[8:11], s49 offen offset:3072 sc1
    s_mul_i32 s38, s31, 7168
    s_add_u32 s38, s38, 0x40000
    s_mul_i32 s44, s31, 28672
    s_add_u32 s44, s44, 0x2c0000
    s_mul_i32 s43, s30, 3584
    s_add_u32 s43, s43, 0x30000
    s_mov_b32 s72, s52
    s_mov_b32 s73, s53
    s_mov_b32 s78, s54
    s_lshl_b32 s96, s101, 12
    s_barrier
    s_add_u32 s97, s97, 229376
    s_cmp_eq_u32 s97, 1605632
    s_cmov_b32 s97, 0
    s_add_u32 s71, s70, s97
    s_add_u32 m0, s75, 57600
    s_nop 0
    buffer_load_dwordx4 v240, s[24:27], s71 offen lds
    s_waitcnt vmcnt(8)
    s_add_u32 m0, s75, 58624
    s_nop 0
    buffer_load_dwordx4 v241, s[24:27], s71 offen lds
    s_waitcnt vmcnt(8)
    s_add_u32 m0, s75, 59648
    s_nop 0
    buffer_load_dwordx4 v242, s[24:27], s71 offen lds
    s_waitcnt vmcnt(8)
    s_add_u32 m0, s75, 60672
    s_nop 0
    buffer_load_dwordx4 v243, s[24:27], s71 offen lds
    s_waitcnt vmcnt(8)
    s_add_u32 m0, s75, 61696
    s_nop 0
    buffer_load_dwordx4 v244, s[24:27], s71 offen lds
    s_waitcnt vmcnt(8)
    s_add_u32 m0, s75, 62720
    s_nop 0
    buffer_load_dwordx4 v245, s[24:27], s71 offen lds
    s_waitcnt vmcnt(8)
    s_add_u32 m0, s75, 63744
    s_nop 0
    buffer_load_dwordx4 v246, s[24:27], s71 offen lds
    s_waitcnt vmcnt(8)
    s_add_u32 s97, s97, 229376
    s_cmp_eq_u32 s97, 1605632
    s_cmov_b32 s97, 0
    s_add_u32 s71, s70, s97
    s_add_u32 m0, s75, 86400
    s_nop 0
    buffer_load_dwordx4 v240, s[24:27], s71 offen lds
    s_waitcnt vmcnt(8)
    s_add_u32 m0, s75, 87424
    s_nop 0
    buffer_load_dwordx4 v241, s[24:27], s71 offen lds
    s_waitcnt vmcnt(8)
    s_add_u32 m0, s75, 88448
    s_nop 0
    buffer_load_dwordx4 v242, s[24:27], s71 offen lds
    s_waitcnt vmcnt(8)
    s_add_u32 m0, s75, 89472
    s_nop 0
    buffer_load_dwordx4 v243, s[24:27], s71 offen lds
    s_waitcnt vmcnt(8)
    s_add_u32 m0, s75, 90496
    s_nop 0
    buffer_load_dwordx4 v244, s[24:27], s71 offen lds
    s_waitcnt vmcnt(8)
    s_add_u32 m0, s75, 91520
    s_nop 0
    buffer_load_dwordx4 v245, s[24:27], s71 offen lds
    s_waitcnt vmcnt(8)
    s_add_u32 m0, s75, 92544
    s_nop 0
    buffer_load_dwordx4 v246, s[24:27], s71 offen lds
    s_waitcnt vmcnt(8)
    v_xor_b32 v4, s28, v176
    v_bitop3_b32 v4, v4, v177, s28 bitop3:0xf6
    v_bitop3_b32 v4, v4, v178, s28 bitop3:0xf6
    v_bitop3_b32 v4, v4, v179, s28 bitop3:0xf6
    v_cmp_ne_u32 vcc, 0, v4
    s_nop 1
    s_cbranch_vccz adaLN_cond__linear_kernel_hedgehog__glu_gated_bilinear__prompt_kernel_skip_44
    s_mov_b32 s33, 40000
adaLN_cond__linear_kernel_hedgehog__glu_gated_bilinear__prompt_kernel_poll_45:
    buffer_load_dword v176, v1, s[8:11], s49 offen offset:0 sc1
    buffer_load_dword v177, v1, s[8:11], s49 offen offset:1024 sc1
    buffer_load_dword v178, v1, s[8:11], s49 offen offset:2048 sc1
    buffer_load_dword v179, v1, s[8:11], s49 offen offset:3072 sc1
    s_waitcnt vmcnt(0)
    v_xor_b32 v4, s28, v176
    v_bitop3_b32 v4, v4, v177, s28 bitop3:0xf6
    v_bitop3_b32 v4, v4, v178, s28 bitop3:0xf6
    v_bitop3_b32 v4, v4, v179, s28 bitop3:0xf6
    v_cmp_ne_u32 vcc, 0, v4
    s_sub_u32 s33, s33, 1
    s_cbranch_scc1 adaLN_cond__linear_kernel_hedgehog__glu_gated_bilinear__prompt_kernel_pollx_46
    s_cbranch_vccnz adaLN_cond__linear_kernel_hedgehog__glu_gated_bilinear__prompt_kernel_poll_45
adaLN_cond__linear_kernel_hedgehog__glu_gated_bilinear__prompt_kernel_pollx_46:
adaLN_cond__linear_kernel_hedgehog__glu_gated_bilinear__prompt_kernel_skip_44:
    s_cmp_eq_u32 s3, 0
    s_cbranch_scc0 adaLN_cond__linear_kernel_hedgehog__glu_gated_bilinear__prompt_kernel_skip_47
    s_lshl_b32 s36, s29, 10
    s_add_u32 s36, s36, 0x24000
    v_and_b32 v4, 0xf0, v1
    v_min_u32 v4, 208, v4
    v_and_b32 v5, 0x300, v1
    v_add_u32 v4, v4, v5
    s_mov_b32 s33, 40000
adaLN_cond__linear_kernel_hedgehog__glu_gated_bilinear__prompt_kernel_poll_48:
    buffer_load_dword v232, v4, s[8:11], s36 offen sc1
    s_waitcnt vmcnt(0)
    v_xor_b32 v233, s28, v232
    v_cmp_ne_u32 vcc, 0, v233
    s_sub_u32 s33, s33, 1
    s_cbranch_scc1 adaLN_cond__linear_kernel_hedgehog__glu_gated_bilinear__prompt_kernel_pollx_49
    s_cbranch_vccnz adaLN_cond__linear_kernel_hedgehog__glu_gated_bilinear__prompt_kernel_poll_48
adaLN_cond__linear_kernel_hedgehog__glu_gated_bilinear__prompt_kernel_pollx_49:
adaLN_cond__linear_kernel_hedgehog__glu_gated_bilinear__prompt_kernel_skip_47:
    v_bfe_u32 v4, v0, 2, 2
    v_lshl_add_u32 v4, v3, 2, v4
    v_mul_u32_u24 v4, 224, v4
    v_and_b32 v5, 3, v0
    v_lshl_add_u32 v4, v5, 3, v4
    v_bfe_u32 v5, v0, 4, 1
    v_mul_u32_u24 v5, 14464, v5
    v_add_u32 v4, v4, v5
    v_add_u32 v5, 57600, v4
    v_add_u32 v6, 115200, v4
    v_and_b32 v7, 0x1f0, v1
    s_waitcnt vmcnt(0) lgkmcnt(0)
    s_barrier
    s_add_u32 s41, s44, s96
    buffer_load_dwordx4 v[8:11], v1, s[8:11], s41 offen offset:0 sc1
    buffer_load_dwordx4 v[12:15], v1, s[8:11], s41 offen offset:1024 sc1
    buffer_load_dwordx4 v[16:19], v1, s[8:11], s41 offen offset:2048 sc1
    buffer_load_dwordx4 v[20:23], v1, s[8:11], s41 offen offset:3072 sc1
    s_add_u32 s96, s96, 4096
    s_cmp_eq_u32 s96, 28672
    s_cmov_b32 s96, 0
    s_add_u32 s41, s44, s96
    buffer_load_dwordx4 v[24:27], v1, s[8:11], s41 offen offset:0 sc1
    buffer_load_dwordx4 v[28:31], v1, s[8:11], s41 offen offset:1024 sc1
    buffer_load_dwordx4 v[32:35], v1, s[8:11], s41 offen offset:2048 sc1
    buffer_load_dwordx4 v[36:39], v1, s[8:11], s41 offen offset:3072 sc1
    ds_read_b64_tr_b16 a[0:1], v4 offset:0
    ds_read_b64_tr_b16 a[2:3], v4 offset:1792
    ds_read_b64_tr_b16 a[4:5], v4 offset:32
    ds_read_b64_tr_b16 a[6:7], v4 offset:1824
    ds_read_b64_tr_b16 a[8:9], v4 offset:64
    ds_read_b64_tr_b16 a[10:11], v4 offset:1856
    ds_read_b64_tr_b16 a[12:13], v4 offset:96
    ds_read_b64_tr_b16 a[14:15], v4 offset:1888
    ds_read_b64_tr_b16 a[16:17], v4 offset:128
    ds_read_b64_tr_b16 a[18:19], v4 offset:1920
    ds_read_b64_tr_b16 a[20:21], v4 offset:160
    ds_read_b64_tr_b16 a[22:23], v4 offset:1952
    ds_read_b64_tr_b16 a[24:25], v4 offset:192
    ds_read_b64_tr_b16 a[26:27], v4 offset:1984
    s_add_u32 s96, s96, 4096
    s_cmp_eq_u32 s96, 28672
    s_cmov_b32 s96, 0
    s_add_u32 s41, s44, s96
    buffer_load_dwordx4 v[40:43], v1, s[8:11], s41 offen offset:0 sc1
    buffer_load_dwordx4 v[44:47], v1, s[8:11], s41 offen offset:1024 sc1
    buffer_load_dwordx4 v[48:51], v1, s[8:11], s41 offen offset:2048 sc1
    buffer_load_dwordx4 v[52:55], v1, s[8:11], s41 offen offset:3072 sc1
    s_waitcnt lgkmcnt(0)
    s_waitcnt vmcnt(11)
    v_mfma_f32_32x32x16_bf16 v[120:135], a[0:3], v[8:11], 0
    ds_read_b64_tr_b16 a[28:29], v4 offset:3584
    ds_read_b64_tr_b16 a[30:31], v4 offset:5376
    ds_read_b64_tr_b16 a[32:33], v4 offset:3616
    v_mfma_f32_32x32x16_bf16 v[136:151], a[4:7], v[8:11], 0
    ds_read_b64_tr_b16 a[34:35], v4 offset:5408
    ds_read_b64_tr_b16 a[36:37], v4 offset:3648
    ds_read_b64_tr_b16 a[38:39], v4 offset:5440
    v_mfma_f32_32x32x16_bf16 v[152:167], a[8:11], v[8:11], 0
    ds_read_b64_tr_b16 a[40:41], v4 offset:3680
    ds_read_b64_tr_b16 a[42:43], v4 offset:5472
    ds_read_b64_tr_b16 a[44:45], v4 offset:3712
    v_mfma_f32_32x32x16_bf16 v[168:183], a[12:15], v[8:11], 0
    ds_read_b64_tr_b16 a[46:47], v4 offset:5504
    ds_read_b64_tr_b16 a[48:49], v4 offset:3744
    ds_read_b64_tr_b16 a[50:51], v4 offset:5536
    v_mfma_f32_32x32x16_bf16 v[184:199], a[16:19], v[8:11], 0
    ds_read_b64_tr_b16 a[52:53], v4 offset:3776
    ds_read_b64_tr_b16 a[54:55], v4 offset:5568
    v_mfma_f32_32x32x16_bf16 v[200:215], a[20:23], v[8:11], 0
    v_mfma_f32_32x32x16_bf16 v[216:231], a[24:27], v[8:11], 0
    s_waitcnt lgkmcnt(0)
    s_waitcnt vmcnt(10)
    v_mfma_f32_32x32x16_bf16 v[120:135], a[28:31], v[12:15], v[120:135]
    ds_read_b64_tr_b16 a[0:1], v4 offset:7168
    ds_read_b64_tr_b16 a[2:3], v4 offset:8960
    ds_read_b64_tr_b16 a[4:5], v4 offset:7200
    v_mfma_f32_32x32x16_bf16 v[136:151], a[32:35], v[12:15], v[136:151]
    ds_read_b64_tr_b16 a[6:7], v4 offset:8992
    ds_read_b64_tr_b16 a[8:9], v4 offset:7232
    ds_read_b64_tr_b16 a[10:11], v4 offset:9024
    v_mfma_f32_32x32x16_bf16 v[152:167], a[36:39], v[12:15], v[152:167]
    ds_read_b64_tr_b16 a[12:13], v4 offset:7264
    ds_read_b64_tr_b16 a[14:15], v4 offset:9056
    ds_read_b64_tr_b16 a[16:17], v4 offset:7296
    v_mfma_f32_32x32x16_bf16 v[168:183], a[40:43], v[12:15], v[168:183]
    ds_read_b64_tr_b16 a[18:19], v4 offset:9088
    ds_read_b64_tr_b16 a[20:21], v4 offset:7328
    ds_read_b64_tr_b16 a[22:23], v4 offset:9120
    v_mfma_f32_32x32x16_bf16 v[184:199], a[44:47], v[12:15], v[184:199]
    ds_read_b64_tr_b16 a[24:25], v4 offset:7360
    ds_read_b64_tr_b16 a[26:27], v4 offset:9152
    v_mfma_f32_32x32x16_bf16 v[200:215], a[48:51], v[12:15], v[200:215]
    v_mfma_f32_32x32x16_bf16 v[216:231], a[52:55], v[12:15], v[216:231]
    s_waitcnt lgkmcnt(0)
    s_waitcnt vmcnt(9)
    v_mfma_f32_32x32x16_bf16 v[120:135], a[0:3], v[16:19], v[120:135]
    ds_read_b64_tr_b16 a[28:29], v4 offset:10752
    ds_read_b64_tr_b16 a[30:31], v4 offset:12544
    ds_read_b64_tr_b16 a[32:33], v4 offset:10784
    s_add_u32 s96, s96, 4096
    v_mfma_f32_32x32x16_bf16 v[136:151], a[4:7], v[16:19], v[136:151]
    ds_read_b64_tr_b16 a[34:35], v4 offset:12576
    ds_read_b64_tr_b16 a[36:37], v4 offset:10816
    ds_read_b64_tr_b16 a[38:39], v4 offset:12608
    s_cmp_eq_u32 s96, 28672
    v_mfma_f32_32x32x16_bf16 v[152:167], a[8:11], v[16:19], v[152:167]
    ds_read_b64_tr_b16 a[40:41], v4 offset:10848
    ds_read_b64_tr_b16 a[42:43], v4 offset:12640
    ds_read_b64_tr_b16 a[44:45], v4 offset:10880
    s_cmov_b32 s96, 0
    v_mfma_f32_32x32x16_bf16 v[168:183], a[12:15], v[16:19], v[168:183]
    ds_read_b64_tr_b16 a[46:47], v4 offset:12672
    ds_read_b64_tr_b16 a[48:49], v4 offset:10912
    ds_read_b64_tr_b16 a[50:51], v4 offset:12704
    s_add_u32 s41, s44, s96
    v_mfma_f32_32x32x16_bf16 v[184:199], a[16:19], v[16:19], v[184:199]
    ds_read_b64_tr_b16 a[52:53], v4 offset:10944
    ds_read_b64_tr_b16 a[54:55], v4 offset:12736
    buffer_load_dwordx4 v[56:59], v1, s[8:11], s41 offen offset:0 sc1
    v_mfma_f32_32x32x16_bf16 v[200:215], a[20:23], v[16:19], v[200:215]
    buffer_load_dwordx4 v[60:63], v1, s[8:11], s41 offen offset:1024 sc1
    v_mfma_f32_32x32x16_bf16 v[216:231], a[24:27], v[16:19], v[216:231]
    buffer_load_dwordx4 v[64:67], v1, s[8:11], s41 offen offset:2048 sc1
    buffer_load_dwordx4 v[68:71], v1, s[8:11], s41 offen offset:3072 sc1
    s_waitcnt lgkmcnt(0)
    s_waitcnt vmcnt(12)
    v_mfma_f32_32x32x16_bf16 v[120:135], a[28:31], v[20:23], v[120:135]
    ds_read_b64_tr_b16 a[0:1], v4 offset:28800
    ds_read_b64_tr_b16 a[2:3], v4 offset:30592
    ds_read_b64_tr_b16 a[4:5], v4 offset:28832
    s_add_u32 s96, s96, 4096
    v_mfma_f32_32x32x16_bf16 v[136:151], a[32:35], v[20:23], v[136:151]
    ds_read_b64_tr_b16 a[6:7], v4 offset:30624
    ds_read_b64_tr_b16 a[8:9], v4 offset:28864
    ds_read_b64_tr_b16 a[10:11], v4 offset:30656
    s_cmp_eq_u32 s96, 28672
    v_mfma_f32_32x32x16_bf16 v[152:167], a[36:39], v[20:23], v[152:167]
    ds_read_b64_tr_b16 a[12:13], v4 offset:28896
    ds_read_b64_tr_b16 a[14:15], v4 offset:30688
    ds_read_b64_tr_b16 a[16:17], v4 offset:28928
    s_cmov_b32 s96, 0
    v_mfma_f32_32x32x16_bf16 v[168:183], a[40:43], v[20:23], v[168:183]
    ds_read_b64_tr_b16 a[18:19], v4 offset:30720
    ds_read_b64_tr_b16 a[20:21], v4 offset:28960
    ds_read_b64_tr_b16 a[22:23], v4 offset:30752
    s_add_u32 s41, s44, s96
    v_mfma_f32_32x32x16_bf16 v[184:199], a[44:47], v[20:23], v[184:199]
    ds_read_b64_tr_b16 a[24:25], v4 offset:28992
    ds_read_b64_tr_b16 a[26:27], v4 offset:30784
    buffer_load_dwordx4 v[72:75], v1, s[8:11], s41 offen offset:0 sc1
    v_mfma_f32_32x32x16_bf16 v[200:215], a[48:51], v[20:23], v[200:215]
    buffer_load_dwordx4 v[76:79], v1, s[8:11], s41 offen offset:1024 sc1
    v_mfma_f32_32x32x16_bf16 v[216:231], a[52:55], v[20:23], v[216:231]
    buffer_load_dwordx4 v[80:83], v1, s[8:11], s41 offen offset:2048 sc1
    s_waitcnt lgkmcnt(0)
    s_waitcnt vmcnt(14)
    v_mfma_f32_32x32x16_bf16 v[120:135], a[0:3], v[24:27], v[120:135]
    ds_read_b64_tr_b16 a[28:29], v4 offset:32384
    ds_read_b64_tr_b16 a[30:31], v4 offset:34176
    ds_read_b64_tr_b16 a[32:33], v4 offset:32416
    buffer_load_dwordx4 v[84:87], v1, s[8:11], s41 offen offset:3072 sc1
    v_mfma_f32_32x32x16_bf16 v[136:151], a[4:7], v[24:27], v[136:151]
    ds_read_b64_tr_b16 a[34:35], v4 offset:34208
    ds_read_b64_tr_b16 a[36:37], v4 offset:32448
    ds_read_b64_tr_b16 a[38:39], v4 offset:34240
    s_add_u32 s96, s96, 4096
    v_mfma_f32_32x32x16_bf16 v[152:167], a[8:11], v[24:27], v[152:167]
    ds_read_b64_tr_b16 a[40:41], v4 offset:32480
    ds_read_b64_tr_b16 a[42:43], v4 offset:34272
    ds_read_b64_tr_b16 a[44:45], v4 offset:32512
    s_cmp_eq_u32 s96, 28672
    v_mfma_f32_32x32x16_bf16 v[168:183], a[12:15], v[24:27], v[168:183]
    ds_read_b64_tr_b16 a[46:47], v4 offset:34304
    ds_read_b64_tr_b16 a[48:49], v4 offset:32544
    ds_read_b64_tr_b16 a[50:51], v4 offset:34336
    s_cmov_b32 s96, 0
    v_mfma_f32_32x32x16_bf16 v[184:199], a[16:19], v[24:27], v[184:199]
    ds_read_b64_tr_b16 a[52:53], v4 offset:32576
    ds_read_b64_tr_b16 a[54:55], v4 offset:34368
    s_add_u32 s41, s44, s96
    v_mfma_f32_32x32x16_bf16 v[200:215], a[20:23], v[24:27], v[200:215]
    buffer_load_dwordx4 v[88:91], v1, s[8:11], s41 offen offset:0 sc1
    v_mfma_f32_32x32x16_bf16 v[216:231], a[24:27], v[24:27], v[216:231]
    buffer_load_dwordx4 v[92:95], v1, s[8:11], s41 offen offset:1024 sc1
    buffer_load_dwordx4 v[96:99], v1, s[8:11], s41 offen offset:2048 sc1
    s_waitcnt lgkmcnt(0)
    s_waitcnt vmcnt(17)
    v_mfma_f32_32x32x16_bf16 v[120:135], a[28:31], v[28:31], v[120:135]
    ds_read_b64_tr_b16 a[0:1], v4 offset:35968
    ds_read_b64_tr_b16 a[2:3], v4 offset:37760
    ds_read_b64_tr_b16 a[4:5], v4 offset:36000
    buffer_load_dwordx4 v[100:103], v1, s[8:11], s41 offen offset:3072 sc1
    v_mfma_f32_32x32x16_bf16 v[136:151], a[32:35], v[28:31], v[136:151]
    ds_read_b64_tr_b16 a[6:7], v4 offset:37792
    ds_read_b64_tr_b16 a[8:9], v4 offset:36032
    ds_read_b64_tr_b16 a[10:11], v4 offset:37824
    s_add_u32 s96, s96, 4096
    v_mfma_f32_32x32x16_bf16 v[152:167], a[36:39], v[28:31], v[152:167]
    ds_read_b64_tr_b16 a[12:13], v4 offset:36064
    ds_read_b64_tr_b16 a[14:15], v4 offset:37856
    ds_read_b64_tr_b16 a[16:17], v4 offset:36096
    s_cmp_eq_u32 s96, 28672
    v_mfma_f32_32x32x16_bf16 v[168:183], a[40:43], v[28:31], v[168:183]
    ds_read_b64_tr_b16 a[18:19], v4 offset:37888
    ds_read_b64_tr_b16 a[20:21], v4 offset:36128
    ds_read_b64_tr_b16 a[22:23], v4 offset:37920
    s_cmov_b32 s96, 0
    v_mfma_f32_32x32x16_bf16 v[184:199], a[44:47], v[28:31], v[184:199]
    ds_read_b64_tr_b16 a[24:25], v4 offset:36160
    ds_read_b64_tr_b16 a[26:27], v4 offset:37952
    s_add_u32 s41, s44, s96
    v_mfma_f32_32x32x16_bf16 v[200:215], a[48:51], v[28:31], v[200:215]
    buffer_load_dwordx4 v[104:107], v1, s[8:11], s41 offen offset:0 sc1
    v_mfma_f32_32x32x16_bf16 v[216:231], a[52:55], v[28:31], v[216:231]
    buffer_load_dwordx4 v[108:111], v1, s[8:11], s41 offen offset:1024 sc1
    s_waitcnt lgkmcnt(0)
    s_waitcnt vmcnt(19)
    v_mfma_f32_32x32x16_bf16 v[120:135], a[0:3], v[32:35], v[120:135]
    ds_read_b64_tr_b16 a[28:29], v4 offset:39552
    ds_read_b64_tr_b16 a[30:31], v4 offset:41344
    ds_read_b64_tr_b16 a[32:33], v4 offset:39584
    buffer_load_dwordx4 v[112:115], v1, s[8:11], s41 offen offset:2048 sc1
    v_mfma_f32_32x32x16_bf16 v[136:151], a[4:7], v[32:35], v[136:151]
    ds_read_b64_tr_b16 a[34:35], v4 offset:41376
    ds_read_b64_tr_b16 a[36:37], v4 offset:39616
    ds_read_b64_tr_b16 a[38:39], v4 offset:41408
    buffer_load_dwordx4 v[116:119], v1, s[8:11], s41 offen offset:3072 sc1
    v_mfma_f32_32x32x16_bf16 v[152:167], a[8:11], v[32:35], v[152:167]
    ds_read_b64_tr_b16 a[40:41], v4 offset:39648
    ds_read_b64_tr_b16 a[42:43], v4 offset:41440
    ds_read_b64_tr_b16 a[44:45], v4 offset:39680
    s_add_u32 s97, s97, 229376
    v_mfma_f32_32x32x16_bf16 v[168:183], a[12:15], v[32:35], v[168:183]
    ds_read_b64_tr_b16 a[46:47], v4 offset:41472
    ds_read_b64_tr_b16 a[48:49], v4 offset:39712
    ds_read_b64_tr_b16 a[50:51], v4 offset:41504
    s_cmp_eq_u32 s97, 1605632
    v_mfma_f32_32x32x16_bf16 v[184:199], a[16:19], v[32:35], v[184:199]
    ds_read_b64_tr_b16 a[52:53], v4 offset:39744
    ds_read_b64_tr_b16 a[54:55], v4 offset:41536
    s_cmov_b32 s97, 0
    v_mfma_f32_32x32x16_bf16 v[200:215], a[20:23], v[32:35], v[200:215]
    s_add_u32 s71, s70, s97
    v_mfma_f32_32x32x16_bf16 v[216:231], a[24:27], v[32:35], v[216:231]
    s_add_u32 m0, s75, 115200
    s_nop 0
    buffer_load_dwordx4 v240, s[24:27], s71 offen lds
    s_barrier
    s_waitcnt lgkmcnt(0)
    s_waitcnt vmcnt(21)
    v_mfma_f32_32x32x16_bf16 v[120:135], a[28:31], v[36:39], v[120:135]
    ds_read_b64_tr_b16 a[0:1], v5 offset:0
    ds_read_b64_tr_b16 a[2:3], v5 offset:1792
    ds_read_b64_tr_b16 a[4:5], v5 offset:32
    v_mfma_f32_32x32x16_bf16 v[136:151], a[32:35], v[36:39], v[136:151]
    ds_read_b64_tr_b16 a[6:7], v5 offset:1824
    ds_read_b64_tr_b16 a[8:9], v5 offset:64
    ds_read_b64_tr_b16 a[10:11], v5 offset:1856
    s_add_u32 m0, s75, 116224
    v_mfma_f32_32x32x16_bf16 v[152:167], a[36:39], v[36:39], v[152:167]
    ds_read_b64_tr_b16 a[12:13], v5 offset:96
    ds_read_b64_tr_b16 a[14:15], v5 offset:1888
    ds_read_b64_tr_b16 a[16:17], v5 offset:128
    v_mfma_f32_32x32x16_bf16 v[168:183], a[40:43], v[36:39], v[168:183]
    ds_read_b64_tr_b16 a[18:19], v5 offset:1920
    ds_read_b64_tr_b16 a[20:21], v5 offset:160
    ds_read_b64_tr_b16 a[22:23], v5 offset:1952
    buffer_load_dwordx4 v241, s[24:27], s71 offen lds
    v_mfma_f32_32x32x16_bf16 v[184:199], a[44:47], v[36:39], v[184:199]
    ds_read_b64_tr_b16 a[24:25], v5 offset:192
    ds_read_b64_tr_b16 a[26:27], v5 offset:1984
    v_mfma_f32_32x32x16_bf16 v[200:215], a[48:51], v[36:39], v[200:215]
    s_add_u32 m0, s75, 117248
    v_mfma_f32_32x32x16_bf16 v[216:231], a[52:55], v[36:39], v[216:231]
    buffer_load_dwordx4 v242, s[24:27], s71 offen lds
    s_waitcnt lgkmcnt(0)
    s_waitcnt vmcnt(22)
    v_mfma_f32_32x32x16_bf16 v[120:135], a[0:3], v[40:43], v[120:135]
    ds_read_b64_tr_b16 a[28:29], v5 offset:3584
    ds_read_b64_tr_b16 a[30:31], v5 offset:5376
    ds_read_b64_tr_b16 a[32:33], v5 offset:3616
    s_add_u32 m0, s75, 118272
    v_mfma_f32_32x32x16_bf16 v[136:151], a[4:7], v[40:43], v[136:151]
    ds_read_b64_tr_b16 a[34:35], v5 offset:5408
    ds_read_b64_tr_b16 a[36:37], v5 offset:3648
    ds_read_b64_tr_b16 a[38:39], v5 offset:5440
    buffer_load_dwordx4 v243, s[24:27], s71 offen lds
    v_mfma_f32_32x32x16_bf16 v[152:167], a[8:11], v[40:43], v[152:167]
    ds_read_b64_tr_b16 a[40:41], v5 offset:3680
    ds_read_b64_tr_b16 a[42:43], v5 offset:5472
    ds_read_b64_tr_b16 a[44:45], v5 offset:3712
    s_add_u32 m0, s75, 119296
    v_mfma_f32_32x32x16_bf16 v[168:183], a[12:15], v[40:43], v[168:183]
    ds_read_b64_tr_b16 a[46:47], v5 offset:5504
    ds_read_b64_tr_b16 a[48:49], v5 offset:3744
    ds_read_b64_tr_b16 a[50:51], v5 offset:5536
    buffer_load_dwordx4 v244, s[24:27], s71 offen lds
    v_mfma_f32_32x32x16_bf16 v[184:199], a[16:19], v[40:43], v[184:199]
    ds_read_b64_tr_b16 a[52:53], v5 offset:3776
    ds_read_b64_tr_b16 a[54:55], v5 offset:5568
    v_lshrrev_b32 v232, 1, v1
    v_mfma_f32_32x32x16_bf16 v[200:215], a[20:23], v[40:43], v[200:215]
    buffer_load_dwordx2 v[8:9], v232, s[8:11], s38 offen offset:0 sc1
    v_mfma_f32_32x32x16_bf16 v[216:231], a[24:27], v[40:43], v[216:231]
    buffer_load_dwordx2 v[10:11], v232, s[8:11], s38 offen offset:512 sc1
    s_waitcnt lgkmcnt(0)
    s_waitcnt vmcnt(25)
    v_mfma_f32_32x32x16_bf16 v[120:135], a[28:31], v[44:47], v[120:135]
    ds_read_b64_tr_b16 a[0:1], v5 offset:7168
    ds_read_b64_tr_b16 a[2:3], v5 offset:8960
    ds_read_b64_tr_b16 a[4:5], v5 offset:7200
    v_mfma_f32_32x32x16_bf16 v[136:151], a[32:35], v[44:47], v[136:151]
    ds_read_b64_tr_b16 a[6:7], v5 offset:8992
    ds_read_b64_tr_b16 a[8:9], v5 offset:7232
    ds_read_b64_tr_b16 a[10:11], v5 offset:9024
    s_add_u32 m0, s75, 120320
    v_mfma_f32_32x32x16_bf16 v[152:167], a[36:39], v[44:47], v[152:167]
    ds_read_b64_tr_b16 a[12:13], v5 offset:7264
    ds_read_b64_tr_b16 a[14:15], v5 offset:9056
    ds_read_b64_tr_b16 a[16:17], v5 offset:7296
    buffer_load_dwordx4 v245, s[24:27], s71 offen lds
    v_mfma_f32_32x32x16_bf16 v[168:183], a[40:43], v[44:47], v[168:183]
    ds_read_b64_tr_b16 a[18:19], v5 offset:9088
    ds_read_b64_tr_b16 a[20:21], v5 offset:7328
    ds_read_b64_tr_b16 a[22:23], v5 offset:9120
    v_mfma_f32_32x32x16_bf16 v[184:199], a[44:47], v[44:47], v[184:199]
    ds_read_b64_tr_b16 a[24:25], v5 offset:7360
    ds_read_b64_tr_b16 a[26:27], v5 offset:9152
    s_add_u32 m0, s75, 121344
    v_mfma_f32_32x32x16_bf16 v[200:215], a[48:51], v[44:47], v[200:215]
    buffer_load_dwordx4 v246, s[24:27], s71 offen lds
    v_mfma_f32_32x32x16_bf16 v[216:231], a[52:55], v[44:47], v[216:231]
    buffer_load_dwordx2 v[12:13], v232, s[8:11], s38 offen offset:1024 sc1
    s_waitcnt lgkmcnt(0)
    s_waitcnt vmcnt(27)
    v_mfma_f32_32x32x16_bf16 v[120:135], a[0:3], v[48:51], v[120:135]
    ds_read_b64_tr_b16 a[28:29], v5 offset:10752
    ds_read_b64_tr_b16 a[30:31], v5 offset:12544
    ds_read_b64_tr_b16 a[32:33], v5 offset:10784
    s_add_u32 s97, s97, 229376
    v_mfma_f32_32x32x16_bf16 v[136:151], a[4:7], v[48:51], v[136:151]
    ds_read_b64_tr_b16 a[34:35], v5 offset:12576
    ds_read_b64_tr_b16 a[36:37], v5 offset:10816
    ds_read_b64_tr_b16 a[38:39], v5 offset:12608
    s_cmp_eq_u32 s97, 1605632
    v_mfma_f32_32x32x16_bf16 v[152:167], a[8:11], v[48:51], v[152:167]
    ds_read_b64_tr_b16 a[40:41], v5 offset:10848
    ds_read_b64_tr_b16 a[42:43], v5 offset:12640
    ds_read_b64_tr_b16 a[44:45], v5 offset:10880
    s_cmov_b32 s97, 0
    v_mfma_f32_32x32x16_bf16 v[168:183], a[12:15], v[48:51], v[168:183]
    ds_read_b64_tr_b16 a[46:47], v5 offset:12672
    ds_read_b64_tr_b16 a[48:49], v5 offset:10912
    ds_read_b64_tr_b16 a[50:51], v5 offset:12704
    s_add_u32 s71, s70, s97
    v_mfma_f32_32x32x16_bf16 v[184:199], a[16:19], v[48:51], v[184:199]
    ds_read_b64_tr_b16 a[52:53], v5 offset:10944
    ds_read_b64_tr_b16 a[54:55], v5 offset:12736
    s_add_u32 m0, s75, 0
    v_mfma_f32_32x32x16_bf16 v[200:215], a[20:23], v[48:51], v[200:215]
    buffer_load_dwordx4 v240, s[24:27], s71 offen lds
    v_mfma_f32_32x32x16_bf16 v[216:231], a[24:27], v[48:51], v[216:231]
    s_add_u32 m0, s75, 1024
    s_nop 0
    buffer_load_dwordx4 v241, s[24:27], s71 offen lds
    s_barrier
    s_waitcnt lgkmcnt(0)
    s_waitcnt vmcnt(28)
    v_mfma_f32_32x32x16_bf16 v[120:135], a[28:31], v[52:55], v[120:135]
    ds_read_b64_tr_b16 a[0:1], v5 offset:28800
    ds_read_b64_tr_b16 a[2:3], v5 offset:30592
    ds_read_b64_tr_b16 a[4:5], v5 offset:28832
    v_mfma_f32_32x32x16_bf16 v[136:151], a[32:35], v[52:55], v[136:151]
    ds_read_b64_tr_b16 a[6:7], v5 offset:30624
    ds_read_b64_tr_b16 a[8:9], v5 offset:28864
    ds_read_b64_tr_b16 a[10:11], v5 offset:30656
    s_add_u32 m0, s75, 2048
    v_mfma_f32_32x32x16_bf16 v[152:167], a[36:39], v[52:55], v[152:167]
    ds_read_b64_tr_b16 a[12:13], v5 offset:28896
    ds_read_b64_tr_b16 a[14:15], v5 offset:30688
    ds_read_b64_tr_b16 a[16:17], v5 offset:28928
    buffer_load_dwordx4 v242, s[24:27], s71 offen lds
    v_mfma_f32_32x32x16_bf16 v[168:183], a[40:43], v[52:55], v[168:183]
    ds_read_b64_tr_b16 a[18:19], v5 offset:30720
    ds_read_b64_tr_b16 a[20:21], v5 offset:28960
    ds_read_b64_tr_b16 a[22:23], v5 offset:30752
    v_mfma_f32_32x32x16_bf16 v[184:199], a[44:47], v[52:55], v[184:199]
    ds_read_b64_tr_b16 a[24:25], v5 offset:28992
    ds_read_b64_tr_b16 a[26:27], v5 offset:30784
    s_add_u32 m0, s75, 3072
    v_mfma_f32_32x32x16_bf16 v[200:215], a[48:51], v[52:55], v[200:215]
    buffer_load_dwordx4 v243, s[24:27], s71 offen lds
    v_mfma_f32_32x32x16_bf16 v[216:231], a[52:55], v[52:55], v[216:231]
    buffer_load_dwordx2 v[14:15], v232, s[8:11], s38 offen offset:1536 sc1
    s_waitcnt lgkmcnt(0)
    s_waitcnt vmcnt(30)
    v_mfma_f32_32x32x16_bf16 v[120:135], a[0:3], v[56:59], v[120:135]
    ds_read_b64_tr_b16 a[28:29], v5 offset:32384
    ds_read_b64_tr_b16 a[30:31], v5 offset:34176
    ds_read_b64_tr_b16 a[32:33], v5 offset:32416
    v_mfma_f32_32x32x16_bf16 v[136:151], a[4:7], v[56:59], v[136:151]
    ds_read_b64_tr_b16 a[34:35], v5 offset:34208
    ds_read_b64_tr_b16 a[36:37], v5 offset:32448
    ds_read_b64_tr_b16 a[38:39], v5 offset:34240
    s_add_u32 m0, s75, 4096
    v_mfma_f32_32x32x16_bf16 v[152:167], a[8:11], v[56:59], v[152:167]
    ds_read_b64_tr_b16 a[40:41], v5 offset:32480
    ds_read_b64_tr_b16 a[42:43], v5 offset:34272
    ds_read_b64_tr_b16 a[44:45], v5 offset:32512
    buffer_load_dwordx4 v244, s[24:27], s71 offen lds
    v_mfma_f32_32x32x16_bf16 v[168:183], a[12:15], v[56:59], v[168:183]
    ds_read_b64_tr_b16 a[46:47], v5 offset:34304
    ds_read_b64_tr_b16 a[48:49], v5 offset:32544
    ds_read_b64_tr_b16 a[50:51], v5 offset:34336
    v_mfma_f32_32x32x16_bf16 v[184:199], a[16:19], v[56:59], v[184:199]
    ds_read_b64_tr_b16 a[52:53], v5 offset:32576
    ds_read_b64_tr_b16 a[54:55], v5 offset:34368
    s_add_u32 m0, s75, 5120
    v_mfma_f32_32x32x16_bf16 v[200:215], a[20:23], v[56:59], v[200:215]
    buffer_load_dwordx4 v245, s[24:27], s71 offen lds
    v_mfma_f32_32x32x16_bf16 v[216:231], a[24:27], v[56:59], v[216:231]
    buffer_load_dwordx2 v[16:17], v232, s[8:11], s38 offen offset:2048 sc1
    s_waitcnt lgkmcnt(0)
    s_waitcnt vmcnt(32)
    v_mfma_f32_32x32x16_bf16 v[120:135], a[28:31], v[60:63], v[120:135]
    ds_read_b64_tr_b16 a[0:1], v5 offset:35968
    ds_read_b64_tr_b16 a[2:3], v5 offset:37760
    ds_read_b64_tr_b16 a[4:5], v5 offset:36000
    s_add_u32 m0, s75, 6144
    v_mfma_f32_32x32x16_bf16 v[136:151], a[32:35], v[60:63], v[136:151]
    ds_read_b64_tr_b16 a[6:7], v5 offset:37792
    ds_read_b64_tr_b16 a[8:9], v5 offset:36032
    ds_read_b64_tr_b16 a[10:11], v5 offset:37824
    buffer_load_dwordx4 v246, s[24:27], s71 offen lds
    v_mfma_f32_32x32x16_bf16 v[152:167], a[36:39], v[60:63], v[152:167]
    ds_read_b64_tr_b16 a[12:13], v5 offset:36064
    ds_read_b64_tr_b16 a[14:15], v5 offset:37856
    ds_read_b64_tr_b16 a[16:17], v5 offset:36096
    s_add_u32 s97, s97, 229376
    v_mfma_f32_32x32x16_bf16 v[168:183], a[40:43], v[60:63], v[168:183]
    ds_read_b64_tr_b16 a[18:19], v5 offset:37888
    ds_read_b64_tr_b16 a[20:21], v5 offset:36128
    ds_read_b64_tr_b16 a[22:23], v5 offset:37920
    s_cmp_eq_u32 s97, 1605632
    s_cmov_b32 s97, 0
    v_mfma_f32_32x32x16_bf16 v[184:199], a[44:47], v[60:63], v[184:199]
    ds_read_b64_tr_b16 a[24:25], v5 offset:36160
    ds_read_b64_tr_b16 a[26:27], v5 offset:37952
    s_add_u32 s71, s70, s97
    v_mfma_f32_32x32x16_bf16 v[200:215], a[48:51], v[60:63], v[200:215]
    s_add_u32 m0, s75, 28800
    v_mfma_f32_32x32x16_bf16 v[216:231], a[52:55], v[60:63], v[216:231]
    buffer_load_dwordx4 v240, s[24:27], s71 offen lds
    buffer_load_dwordx2 v[18:19], v232, s[8:11], s38 offen offset:2560 sc1
    s_waitcnt lgkmcnt(0)
    s_waitcnt vmcnt(34)
    v_mfma_f32_32x32x16_bf16 v[120:135], a[0:3], v[64:67], v[120:135]
    ds_read_b64_tr_b16 a[28:29], v5 offset:39552
    ds_read_b64_tr_b16 a[30:31], v5 offset:41344
    ds_read_b64_tr_b16 a[32:33], v5 offset:39584
    v_mfma_f32_32x32x16_bf16 v[136:151], a[4:7], v[64:67], v[136:151]
    ds_read_b64_tr_b16 a[34:35], v5 offset:41376
    ds_read_b64_tr_b16 a[36:37], v5 offset:39616
    ds_read_b64_tr_b16 a[38:39], v5 offset:41408
    s_add_u32 m0, s75, 29824
    v_mfma_f32_32x32x16_bf16 v[152:167], a[8:11], v[64:67], v[152:167]
    ds_read_b64_tr_b16 a[40:41], v5 offset:39648
    ds_read_b64_tr_b16 a[42:43], v5 offset:41440
    ds_read_b64_tr_b16 a[44:45], v5 offset:39680
    buffer_load_dwordx4 v241, s[24:27], s71 offen lds
    v_mfma_f32_32x32x16_bf16 v[168:183], a[12:15], v[64:67], v[168:183]
    ds_read_b64_tr_b16 a[46:47], v5 offset:41472
    ds_read_b64_tr_b16 a[48:49], v5 offset:39712
    ds_read_b64_tr_b16 a[50:51], v5 offset:41504
    v_mfma_f32_32x32x16_bf16 v[184:199], a[16:19], v[64:67], v[184:199]
    ds_read_b64_tr_b16 a[52:53], v5 offset:39744
    ds_read_b64_tr_b16 a[54:55], v5 offset:41536
    s_add_u32 m0, s75, 30848
    v_mfma_f32_32x32x16_bf16 v[200:215], a[20:23], v[64:67], v[200:215]
    buffer_load_dwordx4 v242, s[24:27], s71 offen lds
    v_mfma_f32_32x32x16_bf16 v[216:231], a[24:27], v[64:67], v[216:231]
    buffer_load_dwordx2 v[20:21], v232, s[8:11], s38 offen offset:3072 sc1
    s_waitcnt vmcnt(15)
    s_barrier
    s_waitcnt lgkmcnt(0)
    v_mfma_f32_32x32x16_bf16 v[120:135], a[28:31], v[68:71], v[120:135]
    ds_read_b64_tr_b16 a[0:1], v6 offset:0
    ds_read_b64_tr_b16 a[2:3], v6 offset:1792
    ds_read_b64_tr_b16 a[4:5], v6 offset:32
    v_mfma_f32_32x32x16_bf16 v[136:151], a[32:35], v[68:71], v[136:151]
    ds_read_b64_tr_b16 a[6:7], v6 offset:1824
    ds_read_b64_tr_b16 a[8:9], v6 offset:64
    ds_read_b64_tr_b16 a[10:11], v6 offset:1856
    s_add_u32 m0, s75, 31872
    v_mfma_f32_32x32x16_bf16 v[152:167], a[36:39], v[68:71], v[152:167]
    ds_read_b64_tr_b16 a[12:13], v6 offset:96
    ds_read_b64_tr_b16 a[14:15], v6 offset:1888
    ds_read_b64_tr_b16 a[16:17], v6 offset:128
    buffer_load_dwordx4 v243, s[24:27], s71 offen lds
    v_mfma_f32_32x32x16_bf16 v[168:183], a[40:43], v[68:71], v[168:183]
    ds_read_b64_tr_b16 a[18:19], v6 offset:1920
    ds_read_b64_tr_b16 a[20:21], v6 offset:160
    ds_read_b64_tr_b16 a[22:23], v6 offset:1952
    v_mfma_f32_32x32x16_bf16 v[184:199], a[44:47], v[68:71], v[184:199]
    ds_read_b64_tr_b16 a[24:25], v6 offset:192
    ds_read_b64_tr_b16 a[26:27], v6 offset:1984
    s_add_u32 m0, s75, 32896
    v_mfma_f32_32x32x16_bf16 v[200:215], a[48:51], v[68:71], v[200:215]
    buffer_load_dwordx4 v244, s[24:27], s71 offen lds
    v_mfma_f32_32x32x16_bf16 v[216:231], a[52:55], v[68:71], v[216:231]
    buffer_load_dwordx2 v[22:23], v232, s[8:11], s38 offen offset:3584 sc1
    s_waitcnt lgkmcnt(0)
    v_mfma_f32_32x32x16_bf16 v[120:135], a[0:3], v[72:75], v[120:135]
    ds_read_b64_tr_b16 a[28:29], v6 offset:3584
    ds_read_b64_tr_b16 a[30:31], v6 offset:5376
    ds_read_b64_tr_b16 a[32:33], v6 offset:3616
    v_mfma_f32_32x32x16_bf16 v[136:151], a[4:7], v[72:75], v[136:151]
    ds_read_b64_tr_b16 a[34:35], v6 offset:5408
    ds_read_b64_tr_b16 a[36:37], v6 offset:3648
    ds_read_b64_tr_b16 a[38:39], v6 offset:5440
    s_add_u32 m0, s75, 33920
    v_mfma_f32_32x32x16_bf16 v[152:167], a[8:11], v[72:75], v[152:167]
    ds_read_b64_tr_b16 a[40:41], v6 offset:3680
    ds_read_b64_tr_b16 a[42:43], v6 offset:5472
    ds_read_b64_tr_b16 a[44:45], v6 offset:3712
    v_mfma_f32_32x32x16_bf16 v[168:183], a[12:15], v[72:75], v[168:183]
    ds_read_b64_tr_b16 a[46:47], v6 offset:5504
    ds_read_b64_tr_b16 a[48:49], v6 offset:3744
    ds_read_b64_tr_b16 a[50:51], v6 offset:5536
    buffer_load_dwordx4 v245, s[24:27], s71 offen lds
    v_mfma_f32_32x32x16_bf16 v[184:199], a[16:19], v[72:75], v[184:199]
    ds_read_b64_tr_b16 a[52:53], v6 offset:3776
    ds_read_b64_tr_b16 a[54:55], v6 offset:5568
    v_mfma_f32_32x32x16_bf16 v[200:215], a[20:23], v[72:75], v[200:215]
    s_add_u32 m0, s75, 34944
    v_mfma_f32_32x32x16_bf16 v[216:231], a[24:27], v[72:75], v[216:231]
    buffer_load_dwordx4 v246, s[24:27], s71 offen lds
    s_waitcnt lgkmcnt(0)
    v_mfma_f32_32x32x16_bf16 v[120:135], a[28:31], v[76:79], v[120:135]
    ds_read_b64_tr_b16 a[0:1], v6 offset:7168
    ds_read_b64_tr_b16 a[2:3], v6 offset:8960
    ds_read_b64_tr_b16 a[4:5], v6 offset:7200
    s_add_u32 s38, s38, 4096
    v_mfma_f32_32x32x16_bf16 v[136:151], a[32:35], v[76:79], v[136:151]
    ds_read_b64_tr_b16 a[6:7], v6 offset:8992
    ds_read_b64_tr_b16 a[8:9], v6 offset:7232
    ds_read_b64_tr_b16 a[10:11], v6 offset:9024
    buffer_load_dwordx2 v[24:25], v232, s[8:11], s38 offen offset:0 sc1
    v_mfma_f32_32x32x16_bf16 v[152:167], a[36:39], v[76:79], v[152:167]
    ds_read_b64_tr_b16 a[12:13], v6 offset:7264
    ds_read_b64_tr_b16 a[14:15], v6 offset:9056
    ds_read_b64_tr_b16 a[16:17], v6 offset:7296
    buffer_load_dwordx2 v[26:27], v232, s[8:11], s38 offen offset:512 sc1
    v_mfma_f32_32x32x16_bf16 v[168:183], a[40:43], v[76:79], v[168:183]
    ds_read_b64_tr_b16 a[18:19], v6 offset:9088
    ds_read_b64_tr_b16 a[20:21], v6 offset:7328
    ds_read_b64_tr_b16 a[22:23], v6 offset:9120
    buffer_load_dwordx2 v[28:29], v232, s[8:11], s38 offen offset:1024 sc1
    v_mfma_f32_32x32x16_bf16 v[184:199], a[44:47], v[76:79], v[184:199]
    ds_read_b64_tr_b16 a[24:25], v6 offset:7360
    ds_read_b64_tr_b16 a[26:27], v6 offset:9152
    buffer_load_dwordx2 v[30:31], v232, s[8:11], s38 offen offset:1536 sc1
    v_mfma_f32_32x32x16_bf16 v[200:215], a[48:51], v[76:79], v[200:215]
    buffer_load_dwordx2 v[32:33], v232, s[8:11], s38 offen offset:2048 sc1
    v_mfma_f32_32x32x16_bf16 v[216:231], a[52:55], v[76:79], v[216:231]
    buffer_load_dwordx2 v[34:35], v232, s[8:11], s38 offen offset:2560 sc1
    buffer_load_dwordx4 v[36:39], v7, s[8:11], s43 offen offset:0 sc1
    s_waitcnt lgkmcnt(0)
    v_mfma_f32_32x32x16_bf16 v[120:135], a[0:3], v[80:83], v[120:135]
    ds_read_b64_tr_b16 a[28:29], v6 offset:10752
    ds_read_b64_tr_b16 a[30:31], v6 offset:12544
    ds_read_b64_tr_b16 a[32:33], v6 offset:10784
    v_mfma_f32_32x32x16_bf16 v[136:151], a[4:7], v[80:83], v[136:151]
    ds_read_b64_tr_b16 a[34:35], v6 offset:12576
    ds_read_b64_tr_b16 a[36:37], v6 offset:10816
    ds_read_b64_tr_b16 a[38:39], v6 offset:12608
    buffer_load_dwordx4 v[40:43], v7, s[8:11], s43 offen offset:512 sc1
    v_mfma_f32_32x32x16_bf16 v[152:167], a[8:11], v[80:83], v[152:167]
    ds_read_b64_tr_b16 a[40:41], v6 offset:10848
    ds_read_b64_tr_b16 a[42:43], v6 offset:12640
    ds_read_b64_tr_b16 a[44:45], v6 offset:10880
    buffer_load_dwordx4 v[44:47], v7, s[8:11], s43 offen offset:1024 sc1
    v_mfma_f32_32x32x16_bf16 v[168:183], a[12:15], v[80:83], v[168:183]
    ds_read_b64_tr_b16 a[46:47], v6 offset:12672
    ds_read_b64_tr_b16 a[48:49], v6 offset:10912
    ds_read_b64_tr_b16 a[50:51], v6 offset:12704
    buffer_load_dwordx4 v[48:51], v7, s[8:11], s43 offen offset:1536 sc1
    v_mfma_f32_32x32x16_bf16 v[184:199], a[16:19], v[80:83], v[184:199]
    ds_read_b64_tr_b16 a[52:53], v6 offset:10944
    ds_read_b64_tr_b16 a[54:55], v6 offset:12736
    buffer_load_dwordx4 v[52:55], v7, s[8:11], s43 offen offset:2048 sc1
    v_mfma_f32_32x32x16_bf16 v[200:215], a[20:23], v[80:83], v[200:215]
    buffer_load_dwordx4 v[56:59], v7, s[8:11], s43 offen offset:2560 sc1
    v_mfma_f32_32x32x16_bf16 v[216:231], a[24:27], v[80:83], v[216:231]
    buffer_load_dwordx4 v[60:63], v7, s[8:11], s43 offen offset:3072 sc1
    s_waitcnt vmcnt(23)
    s_barrier
    s_waitcnt lgkmcnt(0)
    v_mfma_f32_32x32x16_bf16 v[120:135], a[28:31], v[84:87], v[120:135]
    ds_read_b64_tr_b16 a[0:1], v4 offset:0
    ds_read_b64_tr_b16 a[2:3], v4 offset:1792
    ds_read_b64_tr_b16 a[4:5], v4 offset:32
    v_mfma_f32_32x32x16_bf16 v[136:151], a[32:35], v[84:87], v[136:151]
    ds_read_b64_tr_b16 a[6:7], v4 offset:1824
    ds_read_b64_tr_b16 a[8:9], v4 offset:64
    ds_read_b64_tr_b16 a[10:11], v4 offset:1856
    v_mfma_f32_32x32x16_bf16 v[152:167], a[36:39], v[84:87], v[152:167]
    ds_read_b64_tr_b16 a[12:13], v4 offset:96
    ds_read_b64_tr_b16 a[14:15], v4 offset:1888
    ds_read_b64_tr_b16 a[16:17], v4 offset:128
    s_add_u32 s57, s76, s77
    v_mfma_f32_32x32x16_bf16 v[168:183], a[40:43], v[84:87], v[168:183]
    ds_read_b64_tr_b16 a[18:19], v4 offset:1920
    ds_read_b64_tr_b16 a[20:21], v4 offset:160
    ds_read_b64_tr_b16 a[22:23], v4 offset:1952
    v_mfma_f32_32x32x16_bf16 v[184:199], a[44:47], v[84:87], v[184:199]
    ds_read_b64_tr_b16 a[24:25], v4 offset:192
    ds_read_b64_tr_b16 a[26:27], v4 offset:1984
    buffer_load_dwordx4 a[64:67], v1, s[8:11], s57 offen offset:0 sc1
    v_mfma_f32_32x32x16_bf16 v[200:215], a[48:51], v[84:87], v[200:215]
    v_mfma_f32_32x32x16_bf16 v[216:231], a[52:55], v[84:87], v[216:231]
    buffer_load_dwordx4 a[68:71], v1, s[8:11], s57 offen offset:1024 sc1
    s_waitcnt lgkmcnt(0)
    v_mfma_f32_32x32x16_bf16 v[120:135], a[0:3], v[88:91], v[120:135]
    ds_read_b64_tr_b16 a[28:29], v4 offset:3584
    ds_read_b64_tr_b16 a[30:31], v4 offset:5376
    ds_read_b64_tr_b16 a[32:33], v4 offset:3616
    v_mfma_f32_32x32x16_bf16 v[136:151], a[4:7], v[88:91], v[136:151]
    ds_read_b64_tr_b16 a[34:35], v4 offset:5408
    ds_read_b64_tr_b16 a[36:37], v4 offset:3648
    ds_read_b64_tr_b16 a[38:39], v4 offset:5440
    buffer_load_dwordx4 a[72:75], v1, s[8:11], s57 offen offset:2048 sc1
    v_mfma_f32_32x32x16_bf16 v[152:167], a[8:11], v[88:91], v[152:167]
    ds_read_b64_tr_b16 a[40:41], v4 offset:3680
    ds_read_b64_tr_b16 a[42:43], v4 offset:5472
    ds_read_b64_tr_b16 a[44:45], v4 offset:3712
    buffer_load_dwordx4 a[76:79], v1, s[8:11], s57 offen offset:3072 sc1
    v_mfma_f32_32x32x16_bf16 v[168:183], a[12:15], v[88:91], v[168:183]
    ds_read_b64_tr_b16 a[46:47], v4 offset:5504
    ds_read_b64_tr_b16 a[48:49], v4 offset:3744
    ds_read_b64_tr_b16 a[50:51], v4 offset:5536
    v_mfma_f32_32x32x16_bf16 v[184:199], a[16:19], v[88:91], v[184:199]
    ds_read_b64_tr_b16 a[52:53], v4 offset:3776
    ds_read_b64_tr_b16 a[54:55], v4 offset:5568
    s_add_u32 s57, s57, 4096
    v_mfma_f32_32x32x16_bf16 v[200:215], a[20:23], v[88:91], v[200:215]
    buffer_load_dwordx4 a[80:83], v1, s[8:11], s57 offen offset:0 sc1
    v_mfma_f32_32x32x16_bf16 v[216:231], a[24:27], v[88:91], v[216:231]
    buffer_load_dwordx4 a[84:87], v1, s[8:11], s57 offen offset:1024 sc1
    s_waitcnt lgkmcnt(0)
    v_mfma_f32_32x32x16_bf16 v[120:135], a[28:31], v[92:95], v[120:135]
    ds_read_b64_tr_b16 a[0:1], v4 offset:7168
    ds_read_b64_tr_b16 a[2:3], v4 offset:8960
    ds_read_b64_tr_b16 a[4:5], v4 offset:7200
    buffer_load_dwordx4 a[88:91], v1, s[8:11], s57 offen offset:2048 sc1
    buffer_load_dwordx4 a[92:95], v1, s[8:11], s57 offen offset:3072 sc1
    v_mfma_f32_32x32x16_bf16 v[136:151], a[32:35], v[92:95], v[136:151]
    ds_read_b64_tr_b16 a[6:7], v4 offset:8992
    ds_read_b64_tr_b16 a[8:9], v4 offset:7232
    ds_read_b64_tr_b16 a[10:11], v4 offset:9024
    s_add_u32 s77, s77, 8192
    s_cmp_eq_u32 s77, 57344
    v_mfma_f32_32x32x16_bf16 v[152:167], a[36:39], v[92:95], v[152:167]
    ds_read_b64_tr_b16 a[12:13], v4 offset:7264
    ds_read_b64_tr_b16 a[14:15], v4 offset:9056
    ds_read_b64_tr_b16 a[16:17], v4 offset:7296
    s_cmov_b32 s77, 0
    s_add_u32 s57, s76, s77
    buffer_load_dwordx4 a[96:99], v1, s[8:11], s57 offen offset:0 sc1
    v_mfma_f32_32x32x16_bf16 v[168:183], a[40:43], v[92:95], v[168:183]
    ds_read_b64_tr_b16 a[18:19], v4 offset:9088
    ds_read_b64_tr_b16 a[20:21], v4 offset:7328
    ds_read_b64_tr_b16 a[22:23], v4 offset:9120
    buffer_load_dwordx4 a[100:103], v1, s[8:11], s57 offen offset:1024 sc1
    v_add_f32 v8, v8, v10
    v_mfma_f32_32x32x16_bf16 v[184:199], a[44:47], v[92:95], v[184:199]
    ds_read_b64_tr_b16 a[24:25], v4 offset:7360
    ds_read_b64_tr_b16 a[26:27], v4 offset:9152
    v_add_f32 v9, v9, v11
    v_add_f32 v8, v8, v12
    v_add_f32 v9, v9, v13
    v_mfma_f32_32x32x16_bf16 v[200:215], a[48:51], v[92:95], v[200:215]
    v_add_f32 v8, v8, v14
    v_add_f32 v9, v9, v15
    v_mfma_f32_32x32x16_bf16 v[216:231], a[52:55], v[92:95], v[216:231]
    v_add_f32 v8, v8, v16
    v_add_f32 v9, v9, v17
    s_waitcnt vmcnt(31)
    v_add_f32 v8, v8, v18
    s_waitcnt lgkmcnt(0)
    v_mfma_f32_32x32x16_bf16 v[120:135], a[0:3], v[96:99], v[120:135]
    ds_read_b64_tr_b16 a[28:29], v4 offset:10752
    ds_read_b64_tr_b16 a[30:31], v4 offset:12544
    ds_read_b64_tr_b16 a[32:33], v4 offset:10784
    buffer_load_dwordx4 a[104:107], v1, s[8:11], s57 offen offset:2048 sc1
    v_mfma_f32_32x32x16_bf16 v[136:151], a[4:7], v[96:99], v[136:151]
    ds_read_b64_tr_b16 a[34:35], v4 offset:12576
    ds_read_b64_tr_b16 a[36:37], v4 offset:10816
    ds_read_b64_tr_b16 a[38:39], v4 offset:12608
    buffer_load_dwordx4 a[108:111], v1, s[8:11], s57 offen offset:3072 sc1
    v_add_f32 v9, v9, v19
    v_mfma_f32_32x32x16_bf16 v[152:167], a[8:11], v[96:99], v[152:167]
    ds_read_b64_tr_b16 a[40:41], v4 offset:10848
    ds_read_b64_tr_b16 a[42:43], v4 offset:12640
    ds_read_b64_tr_b16 a[44:45], v4 offset:10880
    s_waitcnt vmcnt(30)
    v_add_f32 v8, v8, v20
    v_mfma_f32_32x32x16_bf16 v[168:183], a[12:15], v[96:99], v[168:183]
    ds_read_b64_tr_b16 a[46:47], v4 offset:12672
    ds_read_b64_tr_b16 a[48:49], v4 offset:10912
    ds_read_b64_tr_b16 a[50:51], v4 offset:12704
    v_add_f32 v9, v9, v21
    s_waitcnt vmcnt(27)
    v_add_f32 v8, v8, v22
    v_mfma_f32_32x32x16_bf16 v[184:199], a[16:19], v[96:99], v[184:199]
    ds_read_b64_tr_b16 a[52:53], v4 offset:10944
    ds_read_b64_tr_b16 a[54:55], v4 offset:12736
    v_add_f32 v9, v9, v23
    v_mfma_f32_32x32x16_bf16 v[200:215], a[20:23], v[96:99], v[200:215]
    s_waitcnt vmcnt(24)
    v_add_f32 v8, v8, v24
    v_add_f32 v9, v9, v25
    v_mfma_f32_32x32x16_bf16 v[216:231], a[24:27], v[96:99], v[216:231]
    s_waitcnt vmcnt(23)
    v_add_f32 v8, v8, v26
    v_add_f32 v9, v9, v27
    s_barrier
    s_waitcnt lgkmcnt(0)
    v_mfma_f32_32x32x16_bf16 v[120:135], a[28:31], v[100:103], v[120:135]
    ds_read_b64_tr_b16 a[0:1], v4 offset:28800
    ds_read_b64_tr_b16 a[2:3], v4 offset:30592
    ds_read_b64_tr_b16 a[4:5], v4 offset:28832
    s_add_u32 s57, s57, 4096
    buffer_load_dwordx4 a[112:115], v1, s[8:11], s57 offen offset:0 sc1
    v_mfma_f32_32x32x16_bf16 v[136:151], a[32:35], v[100:103], v[136:151]
    ds_read_b64_tr_b16 a[6:7], v4 offset:30624
    ds_read_b64_tr_b16 a[8:9], v4 offset:28864
    ds_read_b64_tr_b16 a[10:11], v4 offset:30656
    buffer_load_dwordx4 a[116:119], v1, s[8:11], s57 offen offset:1024 sc1
    buffer_load_dwordx4 a[120:123], v1, s[8:11], s57 offen offset:2048 sc1
    v_mfma_f32_32x32x16_bf16 v[152:167], a[36:39], v[100:103], v[152:167]
    ds_read_b64_tr_b16 a[12:13], v4 offset:28896
    ds_read_b64_tr_b16 a[14:15], v4 offset:30688
    ds_read_b64_tr_b16 a[16:17], v4 offset:28928
    buffer_load_dwordx4 a[124:127], v1, s[8:11], s57 offen offset:3072 sc1
    s_waitcnt vmcnt(26)
    v_add_f32 v8, v8, v28
    v_mfma_f32_32x32x16_bf16 v[168:183], a[40:43], v[100:103], v[168:183]
    ds_read_b64_tr_b16 a[18:19], v4 offset:30720
    ds_read_b64_tr_b16 a[20:21], v4 offset:28960
    ds_read_b64_tr_b16 a[22:23], v4 offset:30752
    v_add_f32 v9, v9, v29
    s_waitcnt vmcnt(25)
    v_add_f32 v8, v8, v30
    v_mfma_f32_32x32x16_bf16 v[184:199], a[44:47], v[100:103], v[184:199]
    ds_read_b64_tr_b16 a[24:25], v4 offset:28992
    ds_read_b64_tr_b16 a[26:27], v4 offset:30784
    v_add_f32 v9, v9, v31
    s_waitcnt vmcnt(24)
    v_add_f32 v8, v8, v32
    v_mfma_f32_32x32x16_bf16 v[200:215], a[48:51], v[100:103], v[200:215]
    v_add_f32 v9, v9, v33
    s_waitcnt vmcnt(23)
    v_add_f32 v8, v8, v34
    v_mfma_f32_32x32x16_bf16 v[216:231], a[52:55], v[100:103], v[216:231]
    v_add_f32 v9, v9, v35
    v_mov_b32 v10, v8
    s_waitcnt lgkmcnt(0)
    v_mfma_f32_32x32x16_bf16 v[120:135], a[0:3], v[104:107], v[120:135]
    ds_read_b64_tr_b16 a[28:29], v4 offset:32384
    ds_read_b64_tr_b16 a[30:31], v4 offset:34176
    ds_read_b64_tr_b16 a[32:33], v4 offset:32416
    s_add_u32 s77, s77, 8192
    s_cmp_eq_u32 s77, 57344
    v_mfma_f32_32x32x16_bf16 v[136:151], a[4:7], v[104:107], v[136:151]
    ds_read_b64_tr_b16 a[34:35], v4 offset:34208
    ds_read_b64_tr_b16 a[36:37], v4 offset:32448
    ds_read_b64_tr_b16 a[38:39], v4 offset:34240
    s_cmov_b32 s77, 0
    s_add_u32 s57, s76, s77
    v_mfma_f32_32x32x16_bf16 v[152:167], a[8:11], v[104:107], v[152:167]
    ds_read_b64_tr_b16 a[40:41], v4 offset:32480
    ds_read_b64_tr_b16 a[42:43], v4 offset:34272
    ds_read_b64_tr_b16 a[44:45], v4 offset:32512
    buffer_load_dwordx4 a[128:131], v1, s[8:11], s57 offen offset:0 sc1
    buffer_load_dwordx4 a[132:135], v1, s[8:11], s57 offen offset:1024 sc1
    buffer_load_dwordx4 a[136:139], v1, s[8:11], s57 offen offset:2048 sc1
    v_mfma_f32_32x32x16_bf16 v[168:183], a[12:15], v[104:107], v[168:183]
    ds_read_b64_tr_b16 a[46:47], v4 offset:34304
    ds_read_b64_tr_b16 a[48:49], v4 offset:32544
    ds_read_b64_tr_b16 a[50:51], v4 offset:34336
    buffer_load_dwordx4 a[140:143], v1, s[8:11], s57 offen offset:3072 sc1
    v_mov_b32 v11, v9
    v_mfma_f32_32x32x16_bf16 v[184:199], a[16:19], v[104:107], v[184:199]
    ds_read_b64_tr_b16 a[52:53], v4 offset:32576
    ds_read_b64_tr_b16 a[54:55], v4 offset:34368
    v_permlane32_swap_b32 v8, v10
    v_permlane32_swap_b32 v9, v11
    v_add_f32 v8, v8, v10
    v_mfma_f32_32x32x16_bf16 v[200:215], a[20:23], v[104:107], v[200:215]
    v_add_f32 v9, v9, v11
    v_mul_f32 v12, 0xbb124925, v8
    v_mfma_f32_32x32x16_bf16 v[216:231], a[24:27], v[104:107], v[216:231]
    v_mov_b32 v10, 0x3727c5ac
    v_mov_b32 v13, v10
    v_fmac_f32 v13, 0x3b124925, v9
    s_waitcnt lgkmcnt(0)
    v_mfma_f32_32x32x16_bf16 v[120:135], a[28:31], v[108:111], v[120:135]
    ds_read_b64_tr_b16 a[0:1], v4 offset:35968
    ds_read_b64_tr_b16 a[2:3], v4 offset:37760
    ds_read_b64_tr_b16 a[4:5], v4 offset:36000
    s_add_u32 s57, s57, 4096
    v_mfma_f32_32x32x16_bf16 v[136:151], a[32:35], v[108:111], v[136:151]
    ds_read_b64_tr_b16 a[6:7], v4 offset:37792
    ds_read_b64_tr_b16 a[8:9], v4 offset:36032
    ds_read_b64_tr_b16 a[10:11], v4 offset:37824
    buffer_load_dwordx4 a[144:147], v1, s[8:11], s57 offen offset:0 sc1
    buffer_load_dwordx4 a[148:151], v1, s[8:11], s57 offen offset:1024 sc1
    v_mfma_f32_32x32x16_bf16 v[152:167], a[36:39], v[108:111], v[152:167]
    ds_read_b64_tr_b16 a[12:13], v4 offset:36064
    ds_read_b64_tr_b16 a[14:15], v4 offset:37856
    ds_read_b64_tr_b16 a[16:17], v4 offset:36096
    v_fma_f32 v13, -v12, v12, v13
    v_max_f32 v13, v13, v10
    v_mfma_f32_32x32x16_bf16 v[168:183], a[40:43], v[108:111], v[168:183]
    ds_read_b64_tr_b16 a[18:19], v4 offset:37888
    ds_read_b64_tr_b16 a[20:21], v4 offset:36128
    ds_read_b64_tr_b16 a[22:23], v4 offset:37920
    v_rcp_f32 v14, v13
    v_mfma_f32_32x32x16_bf16 v[184:199], a[44:47], v[108:111], v[184:199]
    ds_read_b64_tr_b16 a[24:25], v4 offset:36160
    ds_read_b64_tr_b16 a[26:27], v4 offset:37952
    v_sqrt_f32 v13, v13
    v_cvt_pk_bf16_f32 v64, v12, v12
    v_mfma_f32_32x32x16_bf16 v[200:215], a[48:51], v[108:111], v[200:215]
    v_cvt_pk_bf16_f32 v11, v13, v13
    v_and_b32 v10, 0xffff0000, v64
    v_mfma_f32_32x32x16_bf16 v[216:231], a[52:55], v[108:111], v[216:231]
    v_and_b32 v11, 0xffff0000, v11
    v_sub_f32 v12, v12, v10
    s_waitcnt lgkmcnt(0)
    v_mfma_f32_32x32x16_bf16 v[120:135], a[0:3], v[112:115], v[120:135]
    ds_read_b64_tr_b16 a[28:29], v4 offset:39552
    ds_read_b64_tr_b16 a[30:31], v4 offset:41344
    ds_read_b64_tr_b16 a[32:33], v4 offset:39584
    buffer_load_dwordx4 a[152:155], v1, s[8:11], s57 offen offset:2048 sc1
    buffer_load_dwordx4 a[156:159], v1, s[8:11], s57 offen offset:3072 sc1
    v_mfma_f32_32x32x16_bf16 v[136:151], a[4:7], v[112:115], v[136:151]
    ds_read_b64_tr_b16 a[34:35], v4 offset:41376
    ds_read_b64_tr_b16 a[36:37], v4 offset:39616
    ds_read_b64_tr_b16 a[38:39], v4 offset:41408
    s_add_u32 s77, s77, 8192
    s_cmp_eq_u32 s77, 57344
    v_mfma_f32_32x32x16_bf16 v[152:167], a[8:11], v[112:115], v[152:167]
    ds_read_b64_tr_b16 a[40:41], v4 offset:39648
    ds_read_b64_tr_b16 a[42:43], v4 offset:41440
    ds_read_b64_tr_b16 a[44:45], v4 offset:39680
    s_cmov_b32 s77, 0
    s_add_u32 s57, s76, s77
    v_mfma_f32_32x32x16_bf16 v[168:183], a[12:15], v[112:115], v[168:183]
    ds_read_b64_tr_b16 a[46:47], v4 offset:41472
    ds_read_b64_tr_b16 a[48:49], v4 offset:39712
    ds_read_b64_tr_b16 a[50:51], v4 offset:41504
    buffer_load_dwordx4 a[160:163], v1, s[8:11], s57 offen offset:0 sc1
    buffer_load_dwordx4 a[164:167], v1, s[8:11], s57 offen offset:1024 sc1
    v_sub_f32 v13, v13, v11
    v_mfma_f32_32x32x16_bf16 v[184:199], a[16:19], v[112:115], v[184:199]
    ds_read_b64_tr_b16 a[52:53], v4 offset:39744
    ds_read_b64_tr_b16 a[54:55], v4 offset:41536
    v_cvt_pk_bf16_f32 v65, v12, v11
    v_cvt_pk_bf16_f32 v66, v11, v13
    v_mfma_f32_32x32x16_bf16 v[200:215], a[20:23], v[112:115], v[200:215]
    v_mov_b32 v67, 0
    v_cmp_eq_u32 vcc, 1, v3
    v_mfma_f32_32x32x16_bf16 v[216:231], a[24:27], v[112:115], v[216:231]
    s_nop 0
    v_cndmask_b32 v64, v64, 0, vcc
    v_cndmask_b32 v65, v65, 0, vcc
    v_cndmask_b32 v66, v66, 0, vcc
    s_waitcnt lgkmcnt(0)
    v_mfma_f32_32x32x16_bf16 v[120:135], a[28:31], v[116:119], v[120:135]
    v_mfma_f32_32x32x16_bf16 v[136:151], a[32:35], v[116:119], v[136:151]
    buffer_load_dwordx4 a[168:171], v1, s[8:11], s57 offen offset:2048 sc1
    v_mfma_f32_32x32x16_bf16 v[152:167], a[36:39], v[116:119], v[152:167]
    buffer_load_dwordx4 a[172:175], v1, s[8:11], s57 offen offset:3072 sc1
    v_mfma_f32_32x32x16_bf16 v[168:183], a[40:43], v[116:119], v[168:183]
    v_mfma_f32_32x32x16_bf16 v[184:199], a[44:47], v[116:119], v[184:199]
    s_add_u32 s57, s57, 4096
    v_mfma_f32_32x32x16_bf16 v[200:215], a[48:51], v[116:119], v[200:215]
    buffer_load_dwordx4 a[176:179], v1, s[8:11], s57 offen offset:0 sc1
    v_mfma_f32_32x32x16_bf16 v[216:231], a[52:55], v[116:119], v[216:231]
    buffer_load_dwordx4 a[180:183], v1, s[8:11], s57 offen offset:1024 sc1
    s_waitcnt vmcnt(36)
    v_xor_b32 v10, s28, v39
    s_waitcnt vmcnt(35)
    v_bitop3_b32 v10, v10, v43, s28 bitop3:0xf6
    s_waitcnt vmcnt(34)
    v_bitop3_b32 v10, v10, v47, s28 bitop3:0xf6
    s_waitcnt vmcnt(33)
    v_bitop3_b32 v10, v10, v51, s28 bitop3:0xf6
    s_waitcnt vmcnt(32)
    v_bitop3_b32 v10, v10, v55, s28 bitop3:0xf6
    s_waitcnt vmcnt(31)
    v_bitop3_b32 v10, v10, v59, s28 bitop3:0xf6
    s_waitcnt vmcnt(30)
    v_bitop3_b32 v10, v10, v63, s28 bitop3:0xf6
    v_cmp_ne_u32 vcc, 0, v10
    s_nop 1
    s_cbranch_vccz adaLN_cond__linear_kernel_hedgehog__glu_gated_bilinear__prompt_kernel_skip_50
    s_mov_b32 s33, 40000
adaLN_cond__linear_kernel_hedgehog__glu_gated_bilinear__prompt_kernel_poll_51:
    buffer_load_dwordx4 v[36:39], v7, s[8:11], s43 offen offset:0 sc1
    buffer_load_dwordx4 v[40:43], v7, s[8:11], s43 offen offset:512 sc1
    buffer_load_dwordx4 v[44:47], v7, s[8:11], s43 offen offset:1024 sc1
    buffer_load_dwordx4 v[48:51], v7, s[8:11], s43 offen offset:1536 sc1
    buffer_load_dwordx4 v[52:55], v7, s[8:11], s43 offen offset:2048 sc1
    buffer_load_dwordx4 v[56:59], v7, s[8:11], s43 offen offset:2560 sc1
    buffer_load_dwordx4 v[60:63], v7, s[8:11], s43 offen offset:3072 sc1
    s_waitcnt vmcnt(0)
    v_xor_b32 v10, s28, v39
    v_bitop3_b32 v10, v10, v43, s28 bitop3:0xf6
    v_bitop3_b32 v10, v10, v47, s28 bitop3:0xf6
    v_bitop3_b32 v10, v10, v51, s28 bitop3:0xf6
    v_bitop3_b32 v10, v10, v55, s28 bitop3:0xf6
    v_bitop3_b32 v10, v10, v59, s28 bitop3:0xf6
    v_bitop3_b32 v10, v10, v63, s28 bitop3:0xf6
    v_cmp_ne_u32 vcc, 0, v10
    s_sub_u32 s33, s33, 1
    s_cbranch_scc1 adaLN_cond__linear_kernel_hedgehog__glu_gated_bilinear__prompt_kernel_pollx_52
    s_cbranch_vccnz adaLN_cond__linear_kernel_hedgehog__glu_gated_bilinear__prompt_kernel_poll_51
adaLN_cond__linear_kernel_hedgehog__glu_gated_bilinear__prompt_kernel_pollx_52:
adaLN_cond__linear_kernel_hedgehog__glu_gated_bilinear__prompt_kernel_skip_50:
    v_mov_b32 v39, 0
    v_mov_b32 v43, 0
    v_mov_b32 v47, 0
    v_mov_b32 v51, 0
    v_mov_b32 v55, 0
    v_mov_b32 v59, 0
    v_mov_b32 v63, 0
    v_mfma_f32_32x32x16_bf16 v[120:135], v[36:39], v[64:67], v[120:135]
    v_mfma_f32_32x32x16_bf16 v[136:151], v[40:43], v[64:67], v[136:151]
    v_mfma_f32_32x32x16_bf16 v[152:167], v[44:47], v[64:67], v[152:167]
    v_mfma_f32_32x32x16_bf16 v[168:183], v[48:51], v[64:67], v[168:183]
    v_mfma_f32_32x32x16_bf16 v[184:199], v[52:55], v[64:67], v[184:199]
    v_mfma_f32_32x32x16_bf16 v[200:215], v[56:59], v[64:67], v[200:215]
    v_mfma_f32_32x32x16_bf16 v[216:231], v[60:63], v[64:67], v[216:231]
    s_mul_i32 s38, s31, 114688
    s_mul_i32 s39, s30, 7168
    s_add_u32 s38, s38, s39
    s_add_u32 s38, s38, 0x920000
    s_add_u32 s39, s38, 4096
    s_cmp_eq_u32 s6, 1
    v_pk_mul_f32 v[120:121], v[120:121], v[128:129]
    v_pk_mul_f32 v[122:123], v[122:123], v[130:131]
    v_pk_mul_f32 v[124:125], v[124:125], v[132:133]
    v_pk_mul_f32 v[126:127], v[126:127], v[134:135]
    v_pk_mul_f32 v[120:121], v[120:121], v[14:15] op_sel_hi:[1,0]
    v_pk_mul_f32 v[122:123], v[122:123], v[14:15] op_sel_hi:[1,0]
    v_pk_mul_f32 v[124:125], v[124:125], v[14:15] op_sel_hi:[1,0]
    v_pk_mul_f32 v[126:127], v[126:127], v[14:15] op_sel_hi:[1,0]
    v_cvt_pk_bf16_f32 v128, v120, v121
    v_cvt_pk_bf16_f32 v129, v122, v123
    v_cvt_pk_bf16_f32 v130, v124, v125
    v_cvt_pk_bf16_f32 v131, v126, v127
    buffer_store_dwordx4 v[128:131], v1, s[8:11], s38 offen offset:0 sc1
    v_pk_mul_f32 v[136:137], v[136:137], v[144:145]
    v_pk_mul_f32 v[138:139], v[138:139], v[146:147]
    v_pk_mul_f32 v[140:141], v[140:141], v[148:149]
    v_pk_mul_f32 v[142:143], v[142:143], v[150:151]
    v_pk_mul_f32 v[136:137], v[136:137], v[14:15] op_sel_hi:[1,0]
    v_pk_mul_f32 v[138:139], v[138:139], v[14:15] op_sel_hi:[1,0]
    v_pk_mul_f32 v[140:141], v[140:141], v[14:15] op_sel_hi:[1,0]
    v_pk_mul_f32 v[142:143], v[142:143], v[14:15] op_sel_hi:[1,0]
    v_cvt_pk_bf16_f32 v144, v136, v137
    v_cvt_pk_bf16_f32 v145, v138, v139
    v_cvt_pk_bf16_f32 v146, v140, v141
    v_cvt_pk_bf16_f32 v147, v142, v143
    buffer_store_dwordx4 v[144:147], v1, s[8:11], s38 offen offset:1024 sc1
    v_pk_mul_f32 v[152:153], v[152:153], v[160:161]
    v_pk_mul_f32 v[154:155], v[154:155], v[162:163]
    v_pk_mul_f32 v[156:157], v[156:157], v[164:165]
    v_pk_mul_f32 v[158:159], v[158:159], v[166:167]
    v_pk_mul_f32 v[152:153], v[152:153], v[14:15] op_sel_hi:[1,0]
    v_pk_mul_f32 v[154:155], v[154:155], v[14:15] op_sel_hi:[1,0]
    v_pk_mul_f32 v[156:157], v[156:157], v[14:15] op_sel_hi:[1,0]
    v_pk_mul_f32 v[158:159], v[158:159], v[14:15] op_sel_hi:[1,0]
    v_cvt_pk_bf16_f32 v160, v152, v153
    v_cvt_pk_bf16_f32 v161, v154, v155
    v_cvt_pk_bf16_f32 v162, v156, v157
    v_cvt_pk_bf16_f32 v163, v158, v159
    buffer_store_dwordx4 v[160:163], v1, s[8:11], s38 offen offset:2048 sc1
    v_pk_mul_f32 v[168:169], v[168:169], v[176:177]
    v_pk_mul_f32 v[170:171], v[170:171], v[178:179]
    v_pk_mul_f32 v[172:173], v[172:173], v[180:181]
    v_pk_mul_f32 v[174:175], v[174:175], v[182:183]
    v_pk_mul_f32 v[168:169], v[168:169], v[14:15] op_sel_hi:[1,0]
    v_pk_mul_f32 v[170:171], v[170:171], v[14:15] op_sel_hi:[1,0]
    v_pk_mul_f32 v[172:173], v[172:173], v[14:15] op_sel_hi:[1,0]
    v_pk_mul_f32 v[174:175], v[174:175], v[14:15] op_sel_hi:[1,0]
    v_cvt_pk_bf16_f32 v176, v168, v169
    v_cvt_pk_bf16_f32 v177, v170, v171
    v_cvt_pk_bf16_f32 v178, v172, v173
    v_cvt_pk_bf16_f32 v179, v174, v175
    buffer_store_dwordx4 v[176:179], v1, s[8:11], s38 offen offset:3072 sc1
    v_pk_mul_f32 v[184:185], v[184:185], v[192:193]
    v_pk_mul_f32 v[186:187], v[186:187], v[194:195]
    v_pk_mul_f32 v[188:189], v[188:189], v[196:197]
    v_pk_mul_f32 v[190:191], v[190:191], v[198:199]
    v_pk_mul_f32 v[184:185], v[184:185], v[14:15] op_sel_hi:[1,0]
    v_pk_mul_f32 v[186:187], v[186:187], v[14:15] op_sel_hi:[1,0]
    v_pk_mul_f32 v[188:189], v[188:189], v[14:15] op_sel_hi:[1,0]
    v_pk_mul_f32 v[190:191], v[190:191], v[14:15] op_sel_hi:[1,0]
    v_cvt_pk_bf16_f32 v192, v184, v185
    v_cvt_pk_bf16_f32 v193, v186, v187
    v_cvt_pk_bf16_f32 v194, v188, v189
    v_cvt_pk_bf16_f32 v195, v190, v191
    buffer_store_dwordx4 v[192:195], v1, s[8:11], s39 offen offset:0 sc1
    v_pk_mul_f32 v[200:201], v[200:201], v[208:209]
    v_pk_mul_f32 v[202:203], v[202:203], v[210:211]
    v_pk_mul_f32 v[204:205], v[204:205], v[212:213]
    v_pk_mul_f32 v[206:207], v[206:207], v[214:215]
    v_pk_mul_f32 v[200:201], v[200:201], v[14:15] op_sel_hi:[1,0]
    v_pk_mul_f32 v[202:203], v[202:203], v[14:15] op_sel_hi:[1,0]
    v_pk_mul_f32 v[204:205], v[204:205], v[14:15] op_sel_hi:[1,0]
    v_pk_mul_f32 v[206:207], v[206:207], v[14:15] op_sel_hi:[1,0]
    v_cvt_pk_bf16_f32 v208, v200, v201
    v_cvt_pk_bf16_f32 v209, v202, v203
    v_cvt_pk_bf16_f32 v210, v204, v205
    v_cvt_pk_bf16_f32 v211, v206, v207
    buffer_store_dwordx4 v[208:211], v1, s[8:11], s39 offen offset:1024 sc1
    v_pk_mul_f32 v[216:217], v[216:217], v[224:225]
    v_pk_mul_f32 v[218:219], v[218:219], v[226:227]
    v_pk_mul_f32 v[220:221], v[220:221], v[228:229]
    v_pk_mul_f32 v[222:223], v[222:223], v[230:231]
    v_pk_mul_f32 v[216:217], v[216:217], v[14:15] op_sel_hi:[1,0]
    v_pk_mul_f32 v[218:219], v[218:219], v[14:15] op_sel_hi:[1,0]
    v_pk_mul_f32 v[220:221], v[220:221], v[14:15] op_sel_hi:[1,0]
    v_pk_mul_f32 v[222:223], v[222:223], v[14:15] op_sel_hi:[1,0]
    v_cvt_pk_bf16_f32 v224, v216, v217
    v_cvt_pk_bf16_f32 v225, v218, v219
    v_cvt_pk_bf16_f32 v226, v220, v221
    v_cvt_pk_bf16_f32 v227, v222, v223
    buffer_store_dwordx4 v[224:227], v1, s[8:11], s39 offen offset:2048 sc1
    s_lshl_b32 s38, s31, 4
    s_add_u32 s38, s38, s30
    s_lshl_b32 s38, s38, 4
    s_add_u32 s38, s38, 0x28000
    s_waitcnt vmcnt(0)
    v_mov_b32 v4, s28
    v_mov_b32 v5, 0
    s_cmp_eq_u32 s6, 1
    s_mov_b64 exec, 1
    buffer_store_dword v4, v5, s[8:11], s38 offen sc1
    s_mov_b64 exec, -1
    s_barrier
    s_cmp_eq_u32 s2, 0
    s_cbranch_scc0 adaLN_cond__linear_kernel_hedgehog__glu_gated_bilinear__prompt_kernel_skip_53
    v_mov_b32 v4, s28
    v_mov_b32 v5, 0
    s_mov_b64 exec, 1
    buffer_store_dword v4, v5, s[8:11], 0 offen offset:0
    s_mov_b64 exec, -1
adaLN_cond__linear_kernel_hedgehog__glu_gated_bilinear__prompt_kernel_skip_53:
    s_cmp_eq_u32 s69, 1
    s_cbranch_scc0 adaLN_cond__linear_kernel_hedgehog__glu_gated_bilinear__prompt_kernel_skip_54
    s_load_dwordx2 s[20:21], s[0:1], 80
    s_waitcnt lgkmcnt(0)
    s_mov_b32 s24, s20
    s_and_b32 s25, s21, 0xffff
    s_mov_b32 s26, 0x1c0000
    s_mov_b32 s27, 0x20000
    s_mul_i32 s39, s72, 229376
    s_mul_i32 s40, s3, 28672
    s_add_u32 s39, s39, s40
    s_add_u32 s39, s39, 0x920000
    s_and_b32 s42, s3, 1
    s_lshr_b32 s43, s3, 1
    s_lshl_b32 s44, s73, 1
    s_add_u32 s44, s44, s42
    s_lshl_b32 s45, s72, 1
    s_add_u32 s45, s45, s43
    v_and_b32 v2, 0x1f0, v1
    v_lshrrev_b32 v3, 9, v1
    v_mul_u32_u24 v7, 56, v2
    v_lshl_add_u32 v7, v3, 4, v7
    s_lshl_b32 s46, s72, 9
    s_lshl_b32 s47, s3, 6
    s_add_u32 s46, s46, s47
    s_add_u32 s46, s46, 0x28000
    v_and_b32 v4, 0x30, v1
    v_and_b32 v5, 0x40, v1
    v_lshl_add_u32 v4, v5, 2, v4
    s_mul_i32 s36, s45, 28672
    s_lshl_b32 s47, s44, 11
    s_add_u32 s36, s36, s47
    s_add_u32 s36, s36, 0x100000
    s_lshl_b32 s96, s78, 12
    buffer_load_dwordx4 a[184:187], v1, s[8:11], s57 offen offset:2048 sc1
    buffer_load_dwordx4 a[188:191], v1, s[8:11], s57 offen offset:3072 sc1
    s_add_u32 s77, s77, 8192
    s_cmp_eq_u32 s77, 57344
    s_cmov_b32 s77, 0
    s_add_u32 s57, s76, s77
    buffer_load_dwordx4 a[192:195], v1, s[8:11], s57 offen offset:0 sc1
    buffer_load_dwordx4 a[196:199], v1, s[8:11], s57 offen offset:1024 sc1
    buffer_load_dwordx4 a[200:203], v1, s[8:11], s57 offen offset:2048 sc1
    buffer_load_dwordx4 a[204:207], v1, s[8:11], s57 offen offset:3072 sc1
    s_add_u32 s57, s57, 4096
    buffer_load_dwordx4 a[208:211], v1, s[8:11], s57 offen offset:0 sc1
    buffer_load_dwordx4 a[212:215], v1, s[8:11], s57 offen offset:1024 sc1
    buffer_load_dwordx4 a[216:219], v1, s[8:11], s57 offen offset:2048 sc1
    buffer_load_dwordx4 a[220:223], v1, s[8:11], s57 offen offset:3072 sc1
    s_add_u32 s77, s77, 8192
    s_cmp_eq_u32 s77, 57344
    s_cmov_b32 s77, 0
    s_add_u32 s57, s76, s77
    buffer_load_dwordx4 a[224:227], v1, s[8:11], s57 offen offset:0 sc1
    buffer_load_dwordx4 a[228:231], v1, s[8:11], s57 offen offset:1024 sc1
    buffer_load_dwordx4 a[232:235], v1, s[8:11], s57 offen offset:2048 sc1
    buffer_load_dwordx4 a[236:239], v1, s[8:11], s57 offen offset:3072 sc1
    s_add_u32 s57, s57, 4096
    buffer_load_dwordx4 a[240:243], v1, s[8:11], s57 offen offset:0 sc1
    buffer_load_dwordx4 a[244:247], v1, s[8:11], s57 offen offset:1024 sc1
    buffer_load_dwordx4 a[248:251], v1, s[8:11], s57 offen offset:2048 sc1
    buffer_load_dwordx4 a[252:255], v1, s[8:11], s57 offen offset:3072 sc1
    s_add_u32 s77, s77, 8192
    s_cmp_eq_u32 s77, 57344
    s_cmov_b32 s77, 0
    s_add_u32 s57, s76, s77
    buffer_load_dwordx4 v[240:243], v1, s[8:11], s57 offen offset:0 sc1
    buffer_load_dwordx4 v[244:247], v1, s[8:11], s57 offen offset:1024 sc1
    buffer_load_dwordx4 v[248:251], v1, s[8:11], s57 offen offset:2048 sc1
    buffer_load_dwordx4 v[252:255], v1, s[8:11], s57 offen offset:3072 sc1
    v_lshlrev_b32 v5, 7, v3
    s_lshl_b32 s50, s44, 8
    s_add_u32 s50, s50, 0xc000
    s_add_u32 s51, s50, 0x1000
    buffer_load_dwordx4 v[160:163], v5, s[8:11], s50 offen offset:0 sc1
    buffer_load_dwordx4 v[164:167], v5, s[8:11], s50 offen offset:16 sc1
    buffer_load_dwordx4 v[168:171], v5, s[8:11], s50 offen offset:32 sc1
    buffer_load_dwordx4 v[172:175], v5, s[8:11], s50 offen offset:48 sc1
    buffer_load_dwordx4 v[176:179], v5, s[8:11], s50 offen offset:64 sc1
    buffer_load_dwordx4 v[180:183], v5, s[8:11], s50 offen offset:80 sc1
    buffer_load_dwordx4 v[184:187], v5, s[8:11], s50 offen offset:96 sc1
    buffer_load_dwordx4 v[188:191], v5, s[8:11], s50 offen offset:112 sc1
    buffer_load_dwordx4 v[192:195], v5, s[8:11], s51 offen offset:0 sc1
    buffer_load_dwordx4 v[196:199], v5, s[8:11], s51 offen offset:16 sc1
    buffer_load_dwordx4 v[200:203], v5, s[8:11], s51 offen offset:32 sc1
    buffer_load_dwordx4 v[204:207], v5, s[8:11], s51 offen offset:48 sc1
    buffer_load_dwordx4 v[208:211], v5, s[8:11], s51 offen offset:64 sc1
    buffer_load_dwordx4 v[212:215], v5, s[8:11], s51 offen offset:80 sc1
    buffer_load_dwordx4 v[216:219], v5, s[8:11], s51 offen offset:96 sc1
    buffer_load_dwordx4 v[220:223], v5, s[8:11], s51 offen offset:112 sc1
    buffer_load_dwordx4 v[224:227], v1, s[8:11], s36 offen offset:0 sc1
    buffer_load_dwordx4 v[228:231], v1, s[8:11], s36 offen offset:1024 sc1
    s_mov_b32 s33, 40000
adaLN_cond__linear_kernel_hedgehog__glu_gated_bilinear__prompt_kernel_poll_55:
    buffer_load_dword v11, v4, s[8:11], s46 offen sc1
    s_waitcnt vmcnt(0)
    v_xor_b32 v12, s28, v11
    v_cmp_ne_u32 vcc, 0, v12
    s_sub_u32 s33, s33, 1
    s_cbranch_scc1 adaLN_cond__linear_kernel_hedgehog__glu_gated_bilinear__prompt_kernel_pollx_56
    s_cbranch_vccnz adaLN_cond__linear_kernel_hedgehog__glu_gated_bilinear__prompt_kernel_poll_55
adaLN_cond__linear_kernel_hedgehog__glu_gated_bilinear__prompt_kernel_pollx_56:
    s_add_u32 s40, s39, s96
    s_add_u32 s38, s40, 114688
    buffer_load_dwordx4 v[16:19], v1, s[8:11], s40 offen offset:0 sc1
    buffer_load_dwordx4 v[20:23], v1, s[8:11], s38 offen offset:0 sc1
    buffer_load_dwordx4 v[24:27], v1, s[8:11], s40 offen offset:1024 sc1
    buffer_load_dwordx4 v[28:31], v1, s[8:11], s38 offen offset:1024 sc1
    buffer_load_dwordx4 v[32:35], v1, s[8:11], s40 offen offset:2048 sc1
    buffer_load_dwordx4 v[36:39], v1, s[8:11], s38 offen offset:2048 sc1
    buffer_load_dwordx4 v[40:43], v1, s[8:11], s40 offen offset:3072 sc1
    buffer_load_dwordx4 v[44:47], v1, s[8:11], s38 offen offset:3072 sc1
    s_add_u32 s96, s96, 4096
    s_cmp_eq_u32 s96, 28672
    s_cmov_b32 s96, 0
    s_add_u32 s40, s39, s96
    s_add_u32 s38, s40, 114688
    buffer_load_dwordx4 v[48:51], v1, s[8:11], s40 offen offset:0 sc1
    buffer_load_dwordx4 v[52:55], v1, s[8:11], s38 offen offset:0 sc1
    buffer_load_dwordx4 v[56:59], v1, s[8:11], s40 offen offset:1024 sc1
    buffer_load_dwordx4 v[60:63], v1, s[8:11], s38 offen offset:1024 sc1
    buffer_load_dwordx4 v[64:67], v1, s[8:11], s40 offen offset:2048 sc1
    buffer_load_dwordx4 v[68:71], v1, s[8:11], s38 offen offset:2048 sc1
    v_xor_b32 v4, s28, v161
    v_bitop3_b32 v4, v4, v163, s28 bitop3:0xf6
    v_bitop3_b32 v4, v4, v165, s28 bitop3:0xf6
    v_bitop3_b32 v4, v4, v167, s28 bitop3:0xf6
    v_bitop3_b32 v4, v4, v169, s28 bitop3:0xf6
    v_bitop3_b32 v4, v4, v171, s28 bitop3:0xf6
    v_bitop3_b32 v4, v4, v173, s28 bitop3:0xf6
    v_bitop3_b32 v4, v4, v175, s28 bitop3:0xf6
    v_bitop3_b32 v4, v4, v177, s28 bitop3:0xf6
    v_bitop3_b32 v4, v4, v179, s28 bitop3:0xf6
    v_bitop3_b32 v4, v4, v181, s28 bitop3:0xf6
    v_bitop3_b32 v4, v4, v183, s28 bitop3:0xf6
    v_bitop3_b32 v4, v4, v185, s28 bitop3:0xf6
    v_bitop3_b32 v4, v4, v187, s28 bitop3:0xf6
    v_bitop3_b32 v4, v4, v189, s28 bitop3:0xf6
    v_bitop3_b32 v4, v4, v191, s28 bitop3:0xf6
    v_bitop3_b32 v4, v4, v193, s28 bitop3:0xf6
    v_bitop3_b32 v4, v4, v195, s28 bitop3:0xf6
    v_bitop3_b32 v4, v4, v197, s28 bitop3:0xf6
    v_bitop3_b32 v4, v4, v199, s28 bitop3:0xf6
    v_bitop3_b32 v4, v4, v201, s28 bitop3:0xf6
    v_bitop3_b32 v4, v4, v203, s28 bitop3:0xf6
    v_bitop3_b32 v4, v4, v205, s28 bitop3:0xf6
    v_bitop3_b32 v4, v4, v207, s28 bitop3:0xf6
    v_bitop3_b32 v4, v4, v209, s28 bitop3:0xf6
    v_bitop3_b32 v4, v4, v211, s28 bitop3:0xf6
    v_bitop3_b32 v4, v4, v213, s28 bitop3:0xf6
    v_bitop3_b32 v4, v4, v215, s28 bitop3:0xf6
    v_bitop3_b32 v4, v4, v217, s28 bitop3:0xf6
    v_bitop3_b32 v4, v4, v219, s28 bitop3:0xf6
    v_bitop3_b32 v4, v4, v221, s28 bitop3:0xf6
    v_bitop3_b32 v4, v4, v223, s28 bitop3:0xf6
    v_cmp_ne_u32 vcc, 0, v4
    s_nop 1
    s_cbranch_vccz adaLN_cond__linear_kernel_hedgehog__glu_gated_bilinear__prompt_kernel_skip_57
    s_mov_b32 s33, 40000
adaLN_cond__linear_kernel_hedgehog__glu_gated_bilinear__prompt_kernel_poll_58:
    buffer_load_dwordx4 v[160:163], v5, s[8:11], s50 offen offset:0 sc1
    buffer_load_dwordx4 v[164:167], v5, s[8:11], s50 offen offset:16 sc1
    buffer_load_dwordx4 v[168:171], v5, s[8:11], s50 offen offset:32 sc1
    buffer_load_dwordx4 v[172:175], v5, s[8:11], s50 offen offset:48 sc1
    buffer_load_dwordx4 v[176:179], v5, s[8:11], s50 offen offset:64 sc1
    buffer_load_dwordx4 v[180:183], v5, s[8:11], s50 offen offset:80 sc1
    buffer_load_dwordx4 v[184:187], v5, s[8:11], s50 offen offset:96 sc1
    buffer_load_dwordx4 v[188:191], v5, s[8:11], s50 offen offset:112 sc1
    buffer_load_dwordx4 v[192:195], v5, s[8:11], s51 offen offset:0 sc1
    buffer_load_dwordx4 v[196:199], v5, s[8:11], s51 offen offset:16 sc1
    buffer_load_dwordx4 v[200:203], v5, s[8:11], s51 offen offset:32 sc1
    buffer_load_dwordx4 v[204:207], v5, s[8:11], s51 offen offset:48 sc1
    buffer_load_dwordx4 v[208:211], v5, s[8:11], s51 offen offset:64 sc1
    buffer_load_dwordx4 v[212:215], v5, s[8:11], s51 offen offset:80 sc1
    buffer_load_dwordx4 v[216:219], v5, s[8:11], s51 offen offset:96 sc1
    buffer_load_dwordx4 v[220:223], v5, s[8:11], s51 offen offset:112 sc1
    s_waitcnt vmcnt(0)
    v_xor_b32 v4, s28, v161
    v_bitop3_b32 v4, v4, v163, s28 bitop3:0xf6
    v_bitop3_b32 v4, v4, v165, s28 bitop3:0xf6
    v_bitop3_b32 v4, v4, v167, s28 bitop3:0xf6
    v_bitop3_b32 v4, v4, v169, s28 bitop3:0xf6
    v_bitop3_b32 v4, v4, v171, s28 bitop3:0xf6
    v_bitop3_b32 v4, v4, v173, s28 bitop3:0xf6
    v_bitop3_b32 v4, v4, v175, s28 bitop3:0xf6
    v_bitop3_b32 v4, v4, v177, s28 bitop3:0xf6
    v_bitop3_b32 v4, v4, v179, s28 bitop3:0xf6
    v_bitop3_b32 v4, v4, v181, s28 bitop3:0xf6
    v_bitop3_b32 v4, v4, v183, s28 bitop3:0xf6
    v_bitop3_b32 v4, v4, v185, s28 bitop3:0xf6
    v_bitop3_b32 v4, v4, v187, s28 bitop3:0xf6
    v_bitop3_b32 v4, v4, v189, s28 bitop3:0xf6
    v_bitop3_b32 v4, v4, v191, s28 bitop3:0xf6
    v_bitop3_b32 v4, v4, v193, s28 bitop3:0xf6
    v_bitop3_b32 v4, v4, v195, s28 bitop3:0xf6
    v_bitop3_b32 v4, v4, v197, s28 bitop3:0xf6
    v_bitop3_b32 v4, v4, v199, s28 bitop3:0xf6
    v_bitop3_b32 v4, v4, v201, s28 bitop3:0xf6
    v_bitop3_b32 v4, v4, v203, s28 bitop3:0xf6
    v_bitop3_b32 v4, v4, v205, s28 bitop3:0xf6
    v_bitop3_b32 v4, v4, v207, s28 bitop3:0xf6
    v_bitop3_b32 v4, v4, v209, s28 bitop3:0xf6
    v_bitop3_b32 v4, v4, v211, s28 bitop3:0xf6
    v_bitop3_b32 v4, v4, v213, s28 bitop3:0xf6
    v_bitop3_b32 v4, v4, v215, s28 bitop3:0xf6
    v_bitop3_b32 v4, v4, v217, s28 bitop3:0xf6
    v_bitop3_b32 v4, v4, v219, s28 bitop3:0xf6
    v_bitop3_b32 v4, v4, v221, s28 bitop3:0xf6
    v_bitop3_b32 v4, v4, v223, s28 bitop3:0xf6
    v_cmp_ne_u32 vcc, 0, v4
    s_sub_u32 s33, s33, 1
    s_cbranch_scc1 adaLN_cond__linear_kernel_hedgehog__glu_gated_bilinear__prompt_kernel_pollx_59
    s_cbranch_vccnz adaLN_cond__linear_kernel_hedgehog__glu_gated_bilinear__prompt_kernel_poll_58
adaLN_cond__linear_kernel_hedgehog__glu_gated_bilinear__prompt_kernel_pollx_59:
adaLN_cond__linear_kernel_hedgehog__glu_gated_bilinear__prompt_kernel_skip_57:
    s_lshl_b32 s33, s3, 13
    s_add_u32 s33, s33, 65536
    v_add_u32 v10, s33, v1
    s_waitcnt vmcnt(13)
    v_mfma_f32_32x32x16_bf16 a[0:15], a[64:67], v[16:19], 0
    v_mfma_f32_32x32x16_bf16 a[16:31], a[68:71], v[16:19], 0
    s_waitcnt vmcnt(12)
    v_mfma_f32_32x32x16_bf16 a[32:47], a[64:67], v[20:23], 0
    v_mfma_f32_32x32x16_bf16 a[48:63], a[68:71], v[20:23], 0
    buffer_load_dwordx4 v[72:75], v1, s[8:11], s40 offen offset:3072 sc1
    buffer_load_dwordx4 v[76:79], v1, s[8:11], s38 offen offset:3072 sc1
    s_waitcnt vmcnt(13)
    v_mfma_f32_32x32x16_bf16 a[0:15], a[72:75], v[24:27], a[0:15]
    v_mfma_f32_32x32x16_bf16 a[16:31], a[76:79], v[24:27], a[16:31]
    s_waitcnt vmcnt(12)
    v_mfma_f32_32x32x16_bf16 a[32:47], a[72:75], v[28:31], a[32:47]
    v_mfma_f32_32x32x16_bf16 a[48:63], a[76:79], v[28:31], a[48:63]
    s_add_u32 s96, s96, 4096
    s_cmp_eq_u32 s96, 28672
    s_cmov_b32 s96, 0
    s_add_u32 s40, s39, s96
    s_add_u32 s38, s40, 114688
    buffer_load_dwordx4 v[80:83], v1, s[8:11], s40 offen offset:0 sc1
    buffer_load_dwordx4 v[84:87], v1, s[8:11], s38 offen offset:0 sc1
    s_waitcnt vmcnt(13)
    v_mfma_f32_32x32x16_bf16 a[0:15], a[80:83], v[32:35], a[0:15]
    v_mfma_f32_32x32x16_bf16 a[16:31], a[84:87], v[32:35], a[16:31]
    s_waitcnt vmcnt(12)
    v_mfma_f32_32x32x16_bf16 a[32:47], a[80:83], v[36:39], a[32:47]
    v_mfma_f32_32x32x16_bf16 a[48:63], a[84:87], v[36:39], a[48:63]
    buffer_load_dwordx4 v[88:91], v1, s[8:11], s40 offen offset:1024 sc1
    buffer_load_dwordx4 v[92:95], v1, s[8:11], s38 offen offset:1024 sc1
    s_waitcnt vmcnt(13)
    v_mfma_f32_32x32x16_bf16 a[0:15], a[88:91], v[40:43], a[0:15]
    v_mfma_f32_32x32x16_bf16 a[16:31], a[92:95], v[40:43], a[16:31]
    s_waitcnt vmcnt(12)
    v_mfma_f32_32x32x16_bf16 a[32:47], a[88:91], v[44:47], a[32:47]
    v_mfma_f32_32x32x16_bf16 a[48:63], a[92:95], v[44:47], a[48:63]
    buffer_load_dwordx4 v[96:99], v1, s[8:11], s40 offen offset:2048 sc1
    buffer_load_dwordx4 v[100:103], v1, s[8:11], s38 offen offset:2048 sc1
    v_add_f32 v160, v160, v192
    v_add_f32 v162, v162, v194
    v_add_f32 v164, v164, v196
    v_add_f32 v166, v166, v198
    s_waitcnt vmcnt(13)
    v_mfma_f32_32x32x16_bf16 a[0:15], a[96:99], v[48:51], a[0:15]
    v_mfma_f32_32x32x16_bf16 a[16:31], a[100:103], v[48:51], a[16:31]
    s_waitcnt vmcnt(12)
    v_mfma_f32_32x32x16_bf16 a[32:47], a[96:99], v[52:55], a[32:47]
    v_mfma_f32_32x32x16_bf16 a[48:63], a[100:103], v[52:55], a[48:63]
    buffer_load_dwordx4 v[104:107], v1, s[8:11], s40 offen offset:3072 sc1
    buffer_load_dwordx4 v[108:111], v1, s[8:11], s38 offen offset:3072 sc1
    s_add_u32 s57, s57, 4096
    buffer_load_dwordx4 v[16:19], v1, s[8:11], s57 offen offset:0 sc1
    buffer_load_dwordx4 v[20:23], v1, s[8:11], s57 offen offset:1024 sc1
    v_add_f32 v168, v168, v200
    v_add_f32 v170, v170, v202
    v_add_f32 v172, v172, v204
    v_add_f32 v174, v174, v206
    s_waitcnt vmcnt(15)
    v_mfma_f32_32x32x16_bf16 a[0:15], a[104:107], v[56:59], a[0:15]
    v_mfma_f32_32x32x16_bf16 a[16:31], a[108:111], v[56:59], a[16:31]
    s_waitcnt vmcnt(14)
    v_mfma_f32_32x32x16_bf16 a[32:47], a[104:107], v[60:63], a[32:47]
    v_mfma_f32_32x32x16_bf16 a[48:63], a[108:111], v[60:63], a[48:63]
    s_add_u32 s96, s96, 4096
    s_cmp_eq_u32 s96, 28672
    s_cmov_b32 s96, 0
    s_add_u32 s40, s39, s96
    s_add_u32 s38, s40, 114688
    buffer_load_dwordx4 v[112:115], v1, s[8:11], s40 offen offset:0 sc1
    buffer_load_dwordx4 v[116:119], v1, s[8:11], s38 offen offset:0 sc1
    buffer_load_dwordx4 v[24:27], v1, s[8:11], s57 offen offset:2048 sc1
    buffer_load_dwordx4 v[28:31], v1, s[8:11], s57 offen offset:3072 sc1
    v_add_f32 v176, v176, v208
    v_add_f32 v178, v178, v210
    v_add_f32 v180, v180, v212
    v_add_f32 v182, v182, v214
    s_waitcnt vmcnt(17)
    v_mfma_f32_32x32x16_bf16 a[0:15], a[112:115], v[64:67], a[0:15]
    v_mfma_f32_32x32x16_bf16 a[16:31], a[116:119], v[64:67], a[16:31]
    s_waitcnt vmcnt(16)
    v_mfma_f32_32x32x16_bf16 a[32:47], a[112:115], v[68:71], a[32:47]
    v_mfma_f32_32x32x16_bf16 a[48:63], a[116:119], v[68:71], a[48:63]
    buffer_load_dwordx4 v[120:123], v1, s[8:11], s40 offen offset:1024 sc1
    buffer_load_dwordx4 v[124:127], v1, s[8:11], s38 offen offset:1024 sc1
    v_add_f32 v184, v184, v216
    v_add_f32 v186, v186, v218
    v_add_f32 v188, v188, v220
    v_add_f32 v190, v190, v222
    s_waitcnt vmcnt(17)
    v_mfma_f32_32x32x16_bf16 a[0:15], a[120:123], v[72:75], a[0:15]
    v_mfma_f32_32x32x16_bf16 a[16:31], a[124:127], v[72:75], a[16:31]
    s_waitcnt vmcnt(16)
    v_mfma_f32_32x32x16_bf16 a[32:47], a[120:123], v[76:79], a[32:47]
    v_mfma_f32_32x32x16_bf16 a[48:63], a[124:127], v[76:79], a[48:63]
    buffer_load_dwordx4 v[128:131], v1, s[8:11], s40 offen offset:2048 sc1
    buffer_load_dwordx4 v[132:135], v1, s[8:11], s38 offen offset:2048 sc1
    v_cvt_pk_bf16_f32 v161, v160, v162
    v_lshlrev_b32 v192, 16, v161
    v_and_b32 v193, 0xffff0000, v161
    v_cvt_pk_bf16_f32 v165, v164, v166
    s_waitcnt vmcnt(17)
    v_mfma_f32_32x32x16_bf16 a[0:15], a[128:131], v[80:83], a[0:15]
    v_mfma_f32_32x32x16_bf16 a[16:31], a[132:135], v[80:83], a[16:31]
    s_waitcnt vmcnt(16)
    v_mfma_f32_32x32x16_bf16 a[32:47], a[128:131], v[84:87], a[32:47]
    v_mfma_f32_32x32x16_bf16 a[48:63], a[132:135], v[84:87], a[48:63]
    buffer_load_dwordx4 v[136:139], v1, s[8:11], s40 offen offset:3072 sc1
    buffer_load_dwordx4 v[140:143], v1, s[8:11], s38 offen offset:3072 sc1
    v_lshlrev_b32 v194, 16, v165
    v_and_b32 v195, 0xffff0000, v165
    v_cvt_pk_bf16_f32 v169, v168, v170
    v_lshlrev_b32 v196, 16, v169
    s_waitcnt vmcnt(17)
    v_mfma_f32_32x32x16_bf16 a[0:15], a[136:139], v[88:91], a[0:15]
    v_mfma_f32_32x32x16_bf16 a[16:31], a[140:143], v[88:91], a[16:31]
    s_waitcnt vmcnt(16)
    v_mfma_f32_32x32x16_bf16 a[32:47], a[136:139], v[92:95], a[32:47]
    v_mfma_f32_32x32x16_bf16 a[48:63], a[140:143], v[92:95], a[48:63]
    s_add_u32 s96, s96, 4096
    s_cmp_eq_u32 s96, 28672
    s_cmov_b32 s96, 0
    s_add_u32 s40, s39, s96
    s_add_u32 s38, s40, 114688
    buffer_load_dwordx4 v[144:147], v1, s[8:11], s40 offen offset:0 sc1
    buffer_load_dwordx4 v[148:151], v1, s[8:11], s38 offen offset:0 sc1
    v_and_b32 v197, 0xffff0000, v169
    v_cvt_pk_bf16_f32 v173, v172, v174
    v_lshlrev_b32 v198, 16, v173
    v_and_b32 v199, 0xffff0000, v173
    s_waitcnt vmcnt(17)
    v_mfma_f32_32x32x16_bf16 a[0:15], a[144:147], v[96:99], a[0:15]
    v_mfma_f32_32x32x16_bf16 a[16:31], a[148:151], v[96:99], a[16:31]
    s_waitcnt vmcnt(16)
    v_mfma_f32_32x32x16_bf16 a[32:47], a[144:147], v[100:103], a[32:47]
    v_mfma_f32_32x32x16_bf16 a[48:63], a[148:151], v[100:103], a[48:63]
    buffer_load_dwordx4 v[152:155], v1, s[8:11], s40 offen offset:1024 sc1
    buffer_load_dwordx4 v[156:159], v1, s[8:11], s38 offen offset:1024 sc1
    v_cvt_pk_bf16_f32 v177, v176, v178
    v_lshlrev_b32 v200, 16, v177
    v_and_b32 v201, 0xffff0000, v177
    v_cvt_pk_bf16_f32 v181, v180, v182
    s_waitcnt vmcnt(17)
    v_mfma_f32_32x32x16_bf16 a[0:15], a[152:155], v[104:107], a[0:15]
    v_mfma_f32_32x32x16_bf16 a[16:31], a[156:159], v[104:107], a[16:31]
    s_waitcnt vmcnt(16)
    v_mfma_f32_32x32x16_bf16 a[32:47], a[152:155], v[108:111], a[32:47]
    v_mfma_f32_32x32x16_bf16 a[48:63], a[156:159], v[108:111], a[48:63]
    buffer_load_dwordx4 v[160:163], v1, s[8:11], s40 offen offset:2048 sc1
    buffer_load_dwordx4 v[164:167], v1, s[8:11], s38 offen offset:2048 sc1
    v_lshlrev_b32 v202, 16, v181
    v_and_b32 v203, 0xffff0000, v181
    v_cvt_pk_bf16_f32 v185, v184, v186
    v_lshlrev_b32 v204, 16, v185
    s_waitcnt vmcnt(15)
    v_mfma_f32_32x32x16_bf16 a[0:15], a[160:163], v[112:115], a[0:15]
    v_mfma_f32_32x32x16_bf16 a[16:31], a[164:167], v[112:115], a[16:31]
    s_waitcnt vmcnt(14)
    v_mfma_f32_32x32x16_bf16 a[32:47], a[160:163], v[116:119], a[32:47]
    v_mfma_f32_32x32x16_bf16 a[48:63], a[164:167], v[116:119], a[48:63]
    buffer_load_dwordx4 v[168:171], v1, s[8:11], s40 offen offset:3072 sc1
    buffer_load_dwordx4 v[172:175], v1, s[8:11], s38 offen offset:3072 sc1
    v_and_b32 v205, 0xffff0000, v185
    v_cvt_pk_bf16_f32 v189, v188, v190
    v_lshlrev_b32 v206, 16, v189
    v_and_b32 v207, 0xffff0000, v189
    s_waitcnt vmcnt(13)
    v_mfma_f32_32x32x16_bf16 a[0:15], a[168:171], v[120:123], a[0:15]
    v_mfma_f32_32x32x16_bf16 a[16:31], a[172:175], v[120:123], a[16:31]
    s_waitcnt vmcnt(12)
    v_mfma_f32_32x32x16_bf16 a[32:47], a[168:171], v[124:127], a[32:47]
    v_mfma_f32_32x32x16_bf16 a[48:63], a[172:175], v[124:127], a[48:63]
    s_add_u32 s96, s96, 4096
    s_cmp_eq_u32 s96, 28672
    s_cmov_b32 s96, 0
    s_add_u32 s40, s39, s96
    s_add_u32 s38, s40, 114688
    buffer_load_dwordx4 v[176:179], v1, s[8:11], s40 offen offset:0 sc1
    buffer_load_dwordx4 v[180:183], v1, s[8:11], s38 offen offset:0 sc1
    ds_write_b128 v10, v[192:195] offset:0
    ds_write_b128 v10, v[196:199] offset:1024
    ds_write_b128 v10, v[200:203] offset:2048
    ds_write_b128 v10, v[204:207] offset:3072
    s_waitcnt vmcnt(13)
    v_mfma_f32_32x32x16_bf16 a[0:15], a[176:179], v[128:131], a[0:15]
    v_mfma_f32_32x32x16_bf16 a[16:31], a[180:183], v[128:131], a[16:31]
    s_waitcnt vmcnt(12)
    v_mfma_f32_32x32x16_bf16 a[32:47], a[176:179], v[132:135], a[32:47]
    v_mfma_f32_32x32x16_bf16 a[48:63], a[180:183], v[132:135], a[48:63]
    buffer_load_dwordx4 v[184:187], v1, s[8:11], s40 offen offset:1024 sc1
    buffer_load_dwordx4 v[188:191], v1, s[8:11], s38 offen offset:1024 sc1
    ds_write_b128 v10, v[224:227] offset:4096
    ds_write_b128 v10, v[228:231] offset:5120
    s_waitcnt vmcnt(13)
    v_mfma_f32_32x32x16_bf16 a[0:15], a[184:187], v[136:139], a[0:15]
    v_mfma_f32_32x32x16_bf16 a[16:31], a[188:191], v[136:139], a[16:31]
    s_waitcnt vmcnt(12)
    v_mfma_f32_32x32x16_bf16 a[32:47], a[184:187], v[140:143], a[32:47]
    v_mfma_f32_32x32x16_bf16 a[48:63], a[188:191], v[140:143], a[48:63]
    buffer_load_dwordx4 v[192:195], v1, s[8:11], s40 offen offset:2048 sc1
    buffer_load_dwordx4 v[196:199], v1, s[8:11], s38 offen offset:2048 sc1
    s_waitcnt vmcnt(13)
    v_mfma_f32_32x32x16_bf16 a[0:15], a[192:195], v[144:147], a[0:15]
    v_mfma_f32_32x32x16_bf16 a[16:31], a[196:199], v[144:147], a[16:31]
    s_waitcnt vmcnt(12)
    v_mfma_f32_32x32x16_bf16 a[32:47], a[192:195], v[148:151], a[32:47]
    v_mfma_f32_32x32x16_bf16 a[48:63], a[196:199], v[148:151], a[48:63]
    buffer_load_dwordx4 v[200:203], v1, s[8:11], s40 offen offset:3072 sc1
    buffer_load_dwordx4 v[204:207], v1, s[8:11], s38 offen offset:3072 sc1
    s_waitcnt vmcnt(13)
    v_mfma_f32_32x32x16_bf16 a[0:15], a[200:203], v[152:155], a[0:15]
    v_mfma_f32_32x32x16_bf16 a[16:31], a[204:207], v[152:155], a[16:31]
    s_waitcnt vmcnt(12)
    v_mfma_f32_32x32x16_bf16 a[32:47], a[200:203], v[156:159], a[32:47]
    v_mfma_f32_32x32x16_bf16 a[48:63], a[204:207], v[156:159], a[48:63]
    s_add_u32 s96, s96, 4096
    s_cmp_eq_u32 s96, 28672
    s_cmov_b32 s96, 0
    s_add_u32 s40, s39, s96
    s_add_u32 s38, s40, 114688
    buffer_load_dwordx4 v[208:211], v1, s[8:11], s40 offen offset:0 sc1
    buffer_load_dwordx4 v[212:215], v1, s[8:11], s38 offen offset:0 sc1
    s_waitcnt vmcnt(13)
    v_mfma_f32_32x32x16_bf16 a[0:15], a[208:211], v[160:163], a[0:15]
    v_mfma_f32_32x32x16_bf16 a[16:31], a[212:215], v[160:163], a[16:31]
    s_waitcnt vmcnt(12)
    v_mfma_f32_32x32x16_bf16 a[32:47], a[208:211], v[164:167], a[32:47]
    v_mfma_f32_32x32x16_bf16 a[48:63], a[212:215], v[164:167], a[48:63]
    buffer_load_dwordx4 v[216:219], v1, s[8:11], s40 offen offset:1024 sc1
    buffer_load_dwordx4 v[220:223], v1, s[8:11], s38 offen offset:1024 sc1
    s_waitcnt vmcnt(13)
    v_mfma_f32_32x32x16_bf16 a[0:15], a[216:219], v[168:171], a[0:15]
    v_mfma_f32_32x32x16_bf16 a[16:31], a[220:223], v[168:171], a[16:31]
    s_waitcnt vmcnt(12)
    v_mfma_f32_32x32x16_bf16 a[32:47], a[216:219], v[172:175], a[32:47]
    v_mfma_f32_32x32x16_bf16 a[48:63], a[220:223], v[172:175], a[48:63]
    buffer_load_dwordx4 v[224:227], v1, s[8:11], s40 offen offset:2048 sc1
    buffer_load_dwordx4 v[228:231], v1, s[8:11], s38 offen offset:2048 sc1
    s_waitcnt vmcnt(13)
    v_mfma_f32_32x32x16_bf16 a[0:15], a[224:227], v[176:179], a[0:15]
    v_mfma_f32_32x32x16_bf16 a[16:31], a[228:231], v[176:179], a[16:31]
    s_waitcnt vmcnt(12)
    v_mfma_f32_32x32x16_bf16 a[32:47], a[224:227], v[180:183], a[32:47]
    v_mfma_f32_32x32x16_bf16 a[48:63], a[228:231], v[180:183], a[48:63]
    buffer_load_dwordx4 v[232:235], v1, s[8:11], s40 offen offset:3072 sc1
    buffer_load_dwordx4 v[236:239], v1, s[8:11], s38 offen offset:3072 sc1
    s_waitcnt vmcnt(13)
    v_mfma_f32_32x32x16_bf16 a[0:15], a[232:235], v[184:187], a[0:15]
    v_mfma_f32_32x32x16_bf16 a[16:31], a[236:239], v[184:187], a[16:31]
    s_waitcnt vmcnt(12)
    v_mfma_f32_32x32x16_bf16 a[32:47], a[232:235], v[188:191], a[32:47]
    v_mfma_f32_32x32x16_bf16 a[48:63], a[236:239], v[188:191], a[48:63]
    s_waitcnt vmcnt(11)
    v_mfma_f32_32x32x16_bf16 a[0:15], a[240:243], v[192:195], a[0:15]
    v_mfma_f32_32x32x16_bf16 a[16:31], a[244:247], v[192:195], a[16:31]
    s_waitcnt vmcnt(10)
    v_mfma_f32_32x32x16_bf16 a[32:47], a[240:243], v[196:199], a[32:47]
    v_mfma_f32_32x32x16_bf16 a[48:63], a[244:247], v[196:199], a[48:63]
    s_waitcnt vmcnt(9)
    v_mfma_f32_32x32x16_bf16 a[0:15], a[248:251], v[200:203], a[0:15]
    v_mfma_f32_32x32x16_bf16 a[16:31], a[252:255], v[200:203], a[16:31]
    s_waitcnt vmcnt(8)
    v_mfma_f32_32x32x16_bf16 a[32:47], a[248:251], v[204:207], a[32:47]
    v_mfma_f32_32x32x16_bf16 a[48:63], a[252:255], v[204:207], a[48:63]
    s_waitcnt vmcnt(7)
    v_mfma_f32_32x32x16_bf16 a[0:15], v[240:243], v[208:211], a[0:15]
    v_mfma_f32_32x32x16_bf16 a[16:31], v[244:247], v[208:211], a[16:31]
    s_waitcnt vmcnt(6)
    v_mfma_f32_32x32x16_bf16 a[32:47], v[240:243], v[212:215], a[32:47]
    v_mfma_f32_32x32x16_bf16 a[48:63], v[244:247], v[212:215], a[48:63]
    s_waitcnt vmcnt(5)
    v_mfma_f32_32x32x16_bf16 a[0:15], v[248:251], v[216:219], a[0:15]
    v_mfma_f32_32x32x16_bf16 a[16:31], v[252:255], v[216:219], a[16:31]
    s_waitcnt vmcnt(4)
    v_mfma_f32_32x32x16_bf16 a[32:47], v[248:251], v[220:223], a[32:47]
    v_mfma_f32_32x32x16_bf16 a[48:63], v[252:255], v[220:223], a[48:63]
    s_waitcnt vmcnt(3)
    v_mfma_f32_32x32x16_bf16 a[0:15], v[16:19], v[224:227], a[0:15]
    v_mfma_f32_32x32x16_bf16 a[16:31], v[20:23], v[224:227], a[16:31]
    s_waitcnt vmcnt(2)
    v_mfma_f32_32x32x16_bf16 a[32:47], v[16:19], v[228:231], a[32:47]
    v_mfma_f32_32x32x16_bf16 a[48:63], v[20:23], v[228:231], a[48:63]
    s_waitcnt vmcnt(1)
    v_mfma_f32_32x32x16_bf16 a[0:15], v[24:27], v[232:235], a[0:15]
    v_mfma_f32_32x32x16_bf16 a[16:31], v[28:31], v[232:235], a[16:31]
    s_waitcnt vmcnt(0)
    v_mfma_f32_32x32x16_bf16 a[32:47], v[24:27], v[236:239], a[32:47]
    v_mfma_f32_32x32x16_bf16 a[48:63], v[28:31], v[236:239], a[48:63]
    s_lshl_b32 s38, s3, 14
    v_add_u32 v6, s38, v1
    s_cmp_lg_u32 s3, 0
    s_cbranch_scc0 adaLN_cond__linear_kernel_hedgehog__glu_gated_bilinear__prompt_kernel_skip_60
    s_nop 3
    ds_write_b128 v6, a[0:3] offset:0
    ds_write_b128 v6, a[4:7] offset:1024
    ds_write_b128 v6, a[8:11] offset:2048
    ds_write_b128 v6, a[12:15] offset:3072
adaLN_cond__linear_kernel_hedgehog__glu_gated_bilinear__prompt_kernel_skip_60:
    s_cmp_lg_u32 s3, 1
    s_cbranch_scc0 adaLN_cond__linear_kernel_hedgehog__glu_gated_bilinear__prompt_kernel_skip_61
    s_nop 2
    ds_write_b128 v6, a[16:19] offset:4096
    ds_write_b128 v6, a[20:23] offset:5120
    ds_write_b128 v6, a[24:27] offset:6144
    ds_write_b128 v6, a[28:31] offset:7168
adaLN_cond__linear_kernel_hedgehog__glu_gated_bilinear__prompt_kernel_skip_61:
    s_cmp_lg_u32 s3, 2
    s_cbranch_scc0 adaLN_cond__linear_kernel_hedgehog__glu_gated_bilinear__prompt_kernel_skip_62
    s_nop 2
    ds_write_b128 v6, a[32:35] offset:8192
    ds_write_b128 v6, a[36:39] offset:9216
    ds_write_b128 v6, a[40:43] offset:10240
    ds_write_b128 v6, a[44:47] offset:11264
adaLN_cond__linear_kernel_hedgehog__glu_gated_bilinear__prompt_kernel_skip_62:
    s_cmp_lg_u32 s3, 3
    s_cbranch_scc0 adaLN_cond__linear_kernel_hedgehog__glu_gated_bilinear__prompt_kernel_skip_63
    s_nop 1
    ds_write_b128 v6, a[48:51] offset:12288
    ds_write_b128 v6, a[52:55] offset:13312
    ds_write_b128 v6, a[56:59] offset:14336
    ds_write_b128 v6, a[60:63] offset:15360
adaLN_cond__linear_kernel_hedgehog__glu_gated_bilinear__prompt_kernel_skip_63:
    s_cmp_eq_u32 s3, 0
    s_cbranch_scc0 adaLN_cond__linear_kernel_hedgehog__glu_gated_bilinear__prompt_kernel_skip_64
    v_accvgpr_read_b32 v144, a0
    v_accvgpr_read_b32 v145, a1
    v_accvgpr_read_b32 v146, a2
    v_accvgpr_read_b32 v147, a3
    v_accvgpr_read_b32 v148, a4
    v_accvgpr_read_b32 v149, a5
    v_accvgpr_read_b32 v150, a6
    v_accvgpr_read_b32 v151, a7
    v_accvgpr_read_b32 v152, a8
    v_accvgpr_read_b32 v153, a9
    v_accvgpr_read_b32 v154, a10
    v_accvgpr_read_b32 v155, a11
    v_accvgpr_read_b32 v156, a12
    v_accvgpr_read_b32 v157, a13
    v_accvgpr_read_b32 v158, a14
    v_accvgpr_read_b32 v159, a15
adaLN_cond__linear_kernel_hedgehog__glu_gated_bilinear__prompt_kernel_skip_64:
    s_cmp_eq_u32 s3, 1
    s_cbranch_scc0 adaLN_cond__linear_kernel_hedgehog__glu_gated_bilinear__prompt_kernel_skip_65
    v_accvgpr_read_b32 v144, a16
    v_accvgpr_read_b32 v145, a17
    v_accvgpr_read_b32 v146, a18
    v_accvgpr_read_b32 v147, a19
    v_accvgpr_read_b32 v148, a20
    v_accvgpr_read_b32 v149, a21
    v_accvgpr_read_b32 v150, a22
    v_accvgpr_read_b32 v151, a23
    v_accvgpr_read_b32 v152, a24
    v_accvgpr_read_b32 v153, a25
    v_accvgpr_read_b32 v154, a26
    v_accvgpr_read_b32 v155, a27
    v_accvgpr_read_b32 v156, a28
    v_accvgpr_read_b32 v157, a29
    v_accvgpr_read_b32 v158, a30
    v_accvgpr_read_b32 v159, a31
adaLN_cond__linear_kernel_hedgehog__glu_gated_bilinear__prompt_kernel_skip_65:
    s_cmp_eq_u32 s3, 2
    s_cbranch_scc0 adaLN_cond__linear_kernel_hedgehog__glu_gated_bilinear__prompt_kernel_skip_66
    v_accvgpr_read_b32 v144, a32
    v_accvgpr_read_b32 v145, a33
    v_accvgpr_read_b32 v146, a34
    v_accvgpr_read_b32 v147, a35
    v_accvgpr_read_b32 v148, a36
    v_accvgpr_read_b32 v149, a37
    v_accvgpr_read_b32 v150, a38
    v_accvgpr_read_b32 v151, a39
    v_accvgpr_read_b32 v152, a40
    v_accvgpr_read_b32 v153, a41
    v_accvgpr_read_b32 v154, a42
    v_accvgpr_read_b32 v155, a43
    v_accvgpr_read_b32 v156, a44
    v_accvgpr_read_b32 v157, a45
    v_accvgpr_read_b32 v158, a46
    v_accvgpr_read_b32 v159, a47
adaLN_cond__linear_kernel_hedgehog__glu_gated_bilinear__prompt_kernel_skip_66:
    s_cmp_eq_u32 s3, 3
    s_cbranch_scc0 adaLN_cond__linear_kernel_hedgehog__glu_gated_bilinear__prompt_kernel_skip_67
    v_accvgpr_read_b32 v144, a48
    v_accvgpr_read_b32 v145, a49
    v_accvgpr_read_b32 v146, a50
    v_accvgpr_read_b32 v147, a51
    v_accvgpr_read_b32 v148, a52
    v_accvgpr_read_b32 v149, a53
    v_accvgpr_read_b32 v150, a54
    v_accvgpr_read_b32 v151, a55
    v_accvgpr_read_b32 v152, a56
    v_accvgpr_read_b32 v153, a57
    v_accvgpr_read_b32 v154, a58
    v_accvgpr_read_b32 v155, a59
    v_accvgpr_read_b32 v156, a60
    v_accvgpr_read_b32 v157, a61
    v_accvgpr_read_b32 v158, a62
    v_accvgpr_read_b32 v159, a63
adaLN_cond__linear_kernel_hedgehog__glu_gated_bilinear__prompt_kernel_skip_67:
    ds_read_b128 v[112:115], v10 offset:0
    ds_read_b128 v[116:119], v10 offset:1024
    ds_read_b128 v[120:123], v10 offset:2048
    ds_read_b128 v[124:127], v10 offset:3072
    ds_read_b128 v[128:131], v10 offset:4096
    ds_read_b128 v[132:135], v10 offset:5120
    s_waitcnt lgkmcnt(1)
    v_lshlrev_b32 v208, 16, v128
    v_and_b32 v209, 0xffff0000, v128
    v_lshlrev_b32 v210, 16, v129
    v_and_b32 v211, 0xffff0000, v129
    v_lshlrev_b32 v212, 16, v130
    v_and_b32 v213, 0xffff0000, v130
    v_lshlrev_b32 v214, 16, v131
    v_and_b32 v215, 0xffff0000, v131
    s_waitcnt lgkmcnt(0)
    v_lshlrev_b32 v216, 16, v132
    v_and_b32 v217, 0xffff0000, v132
    v_lshlrev_b32 v218, 16, v133
    v_and_b32 v219, 0xffff0000, v133
    v_lshlrev_b32 v220, 16, v134
    v_and_b32 v221, 0xffff0000, v134
    v_lshlrev_b32 v222, 16, v135
    v_and_b32 v223, 0xffff0000, v135
    s_waitcnt lgkmcnt(0)
    s_barrier
    s_lshl_b32 s38, s3, 12
    v_add_u32 v6, s38, v1
    s_add_u32 s38, s3, 1
    s_and_b32 s38, s38, 3
    s_lshl_b32 s38, s38, 14
    v_add_u32 v8, s38, v6
    ds_read_b128 v[160:163], v8 offset:0
    ds_read_b128 v[164:167], v8 offset:1024
    ds_read_b128 v[168:171], v8 offset:2048
    ds_read_b128 v[172:175], v8 offset:3072
    s_add_u32 s38, s3, 2
    s_and_b32 s38, s38, 3
    s_lshl_b32 s38, s38, 14
    v_add_u32 v8, s38, v6
    ds_read_b128 v[176:179], v8 offset:0
    ds_read_b128 v[180:183], v8 offset:1024
    ds_read_b128 v[184:187], v8 offset:2048
    ds_read_b128 v[188:191], v8 offset:3072
    s_add_u32 s38, s3, 3
    s_and_b32 s38, s38, 3
    s_lshl_b32 s38, s38, 14
    v_add_u32 v8, s38, v6
    ds_read_b128 v[192:195], v8 offset:0
    ds_read_b128 v[196:199], v8 offset:1024
    ds_read_b128 v[200:203], v8 offset:2048
    ds_read_b128 v[204:207], v8 offset:3072
    s_waitcnt lgkmcnt(11)
    v_pk_add_f32 v[144:145], v[144:145], v[160:161]
    v_pk_add_f32 v[146:147], v[146:147], v[162:163]
    s_waitcnt lgkmcnt(10)
    v_pk_add_f32 v[148:149], v[148:149], v[164:165]
    v_pk_add_f32 v[150:151], v[150:151], v[166:167]
    s_waitcnt lgkmcnt(9)
    v_pk_add_f32 v[152:153], v[152:153], v[168:169]
    v_pk_add_f32 v[154:155], v[154:155], v[170:171]
    s_waitcnt lgkmcnt(8)
    v_pk_add_f32 v[156:157], v[156:157], v[172:173]
    v_pk_add_f32 v[158:159], v[158:159], v[174:175]
    s_waitcnt lgkmcnt(7)
    v_pk_add_f32 v[144:145], v[144:145], v[176:177]
    v_pk_add_f32 v[146:147], v[146:147], v[178:179]
    s_waitcnt lgkmcnt(6)
    v_pk_add_f32 v[148:149], v[148:149], v[180:181]
    v_pk_add_f32 v[150:151], v[150:151], v[182:183]
    s_waitcnt lgkmcnt(5)
    v_pk_add_f32 v[152:153], v[152:153], v[184:185]
    v_pk_add_f32 v[154:155], v[154:155], v[186:187]
    s_waitcnt lgkmcnt(4)
    v_pk_add_f32 v[156:157], v[156:157], v[188:189]
    v_pk_add_f32 v[158:159], v[158:159], v[190:191]
    s_waitcnt lgkmcnt(3)
    v_pk_add_f32 v[144:145], v[144:145], v[192:193]
    v_pk_add_f32 v[146:147], v[146:147], v[194:195]
    s_waitcnt lgkmcnt(2)
    v_pk_add_f32 v[148:149], v[148:149], v[196:197]
    v_pk_add_f32 v[150:151], v[150:151], v[198:199]
    s_waitcnt lgkmcnt(1)
    v_pk_add_f32 v[152:153], v[152:153], v[200:201]
    v_pk_add_f32 v[154:155], v[154:155], v[202:203]
    s_waitcnt lgkmcnt(0)
    v_pk_add_f32 v[156:157], v[156:157], v[204:205]
    v_pk_add_f32 v[158:159], v[158:159], v[206:207]
    v_pk_fma_f32 v[208:209], v[144:145], v[112:113], v[208:209]
    v_pk_fma_f32 v[210:211], v[146:147], v[114:115], v[210:211]
    v_pk_fma_f32 v[212:213], v[148:149], v[116:117], v[212:213]
    v_pk_fma_f32 v[214:215], v[150:151], v[118:119], v[214:215]
    v_pk_fma_f32 v[216:217], v[152:153], v[120:121], v[216:217]
    v_pk_fma_f32 v[218:219], v[154:155], v[122:123], v[218:219]
    v_pk_fma_f32 v[220:221], v[156:157], v[124:125], v[220:221]
    v_pk_fma_f32 v[222:223], v[158:159], v[126:127], v[222:223]
    v_cvt_pk_bf16_f32 v224, v208, v209
    v_cvt_pk_bf16_f32 v225, v210, v211
    v_cvt_pk_bf16_f32 v226, v212, v213
    v_cvt_pk_bf16_f32 v227, v214, v215
    v_cvt_pk_bf16_f32 v228, v216, v217
    v_cvt_pk_bf16_f32 v229, v218, v219
    v_cvt_pk_bf16_f32 v230, v220, v221
    v_cvt_pk_bf16_f32 v231, v222, v223
    v_permlane32_swap_b32 v224, v226
    v_permlane32_swap_b32 v225, v227
    v_permlane32_swap_b32 v228, v230
    v_permlane32_swap_b32 v229, v231
    s_mul_i32 s38, s45, 28672
    s_lshl_b32 s39, s44, 6
    s_add_u32 s38, s38, s39
    buffer_store_dwordx4 v[224:227], v7, s[24:27], s38 offen
    buffer_store_dwordx4 v[228:231], v7, s[24:27], s38 offen offset:32
adaLN_cond__linear_kernel_hedgehog__glu_gated_bilinear__prompt_kernel_skip_54:
    s_endpgm
adaLN_cond__linear_kernel_hedgehog__glu_gated_bilinear__prompt_kernel_path_1:
    s_nop 4
    s_endpgm
L_code_end:
.section .rodata,"a"
.p2align 6
.amdhsa_kernel adaLN_cond__linear_kernel_hedgehog__glu_gated_bilinear__prompt_kernel
  .amdhsa_next_free_vgpr 512
  .amdhsa_next_free_sgpr 102
  .amdhsa_accum_offset 256
  .amdhsa_group_segment_fixed_size 0
  .amdhsa_kernarg_size 104
  .amdhsa_user_sgpr_count 2
  .amdhsa_user_sgpr_kernarg_segment_ptr 1
  .amdhsa_system_sgpr_workgroup_id_x 1
.end_amdhsa_kernel
```
